```python
import torch

def _softmax(x, axis=-1):
    return torch.softmax(x, dim=axis)

def _gelu(x):
    return torch.nn.functional.gelu(x, approximate='tanh')

def _silu(x):
    return torch.nn.functional.silu(x)

def _sigmoid(x):
    return torch.sigmoid(x)

def _layernorm(x, axis=-1, eps=1e-05):
    m = x.mean(dim=axis, keepdim=True)
    v = x.var(dim=axis, keepdim=True, unbiased=False)
    return (x - m) / torch.sqrt(v + eps)

def _scatter_add(tgt, idx, src, axis=0):
    return tgt.clone().index_add_(axis, idx, src)

def _segment_sum(src, seg, n):
    out = torch.zeros((n,) + src.shape[1:], dtype=src.dtype)
    return out.index_add_(0, seg, src)

def _pad(x, pw):
    flat = tuple((v for pair in reversed(pw) for v in pair))
    return torch.nn.functional.pad(x, flat)
kernel_name = 'concat_heads__memory_aug_recurrent_mem_tr__memory_aug_recurrent_mem_tr__prompt'

def setup_inputs():

    _w = lambda a: (lambda t: t.to(torch.bfloat16) if t.is_floating_point() else t)(torch.as_tensor(a))

    def _A_setup():
        B, S, Dm = (1, 2048, 640)
        H, Dh = (32, 192)
        M, seg = (8, 32)
        seg = min(seg, S)
        S = S // seg * seg
        return {'x': _w((lambda *s: torch.randn(*s, dtype=torch.bfloat16) * 0.05)(B, S, Dm)), 'mem0': _w((lambda *s: torch.randn(*s, dtype=torch.bfloat16) * 0.4)(B, M, Dm)), 'Wq': _w((lambda *s: torch.randn(*s, dtype=torch.bfloat16) * 6.4)(Dm, H, Dh) * Dm ** (-0.5)), 'Wk': _w((lambda *s: torch.randn(*s, dtype=torch.bfloat16) * 6.4)(Dm, H, Dh) * Dm ** (-0.5)), 'Wv': _w((lambda *s: torch.randn(*s, dtype=torch.bfloat16) * 0.4)(Dm, H, Dh) * Dm ** (-0.5)), 'Wo': _w((lambda *s: torch.randn(*s, dtype=torch.bfloat16) * 0.4)(H, Dh, Dm) * (H * Dh) ** (-0.5)), 'seg_len': seg}
    _A_in = _A_setup()

    def _B_setup():
        B, S, Dm = (1, 2048, 640)
        H, Dh = (32, 192)
        M, seg = (8, 32)
        seg = min(seg, S)
        S = S // seg * seg
        return {'x': _w((lambda *s: torch.randn(*s, dtype=torch.bfloat16) * 0.05)(B, S, Dm)), 'mem0': _w((lambda *s: torch.randn(*s, dtype=torch.bfloat16) * 0.4)(B, M, Dm)), 'Wq': _w((lambda *s: torch.randn(*s, dtype=torch.bfloat16) * 6.4)(Dm, H, Dh) * Dm ** (-0.5)), 'Wk': _w((lambda *s: torch.randn(*s, dtype=torch.bfloat16) * 6.4)(Dm, H, Dh) * Dm ** (-0.5)), 'Wv': _w((lambda *s: torch.randn(*s, dtype=torch.bfloat16) * 0.4)(Dm, H, Dh) * Dm ** (-0.5)), 'Wo': _w((lambda *s: torch.randn(*s, dtype=torch.bfloat16) * 0.4)(H, Dh, Dm) * (H * Dh) ** (-0.5)), 'seg_len': seg}
    _B_in = _B_setup()
    return {'A_x': _A_in['x'], 'A_mem0': _A_in['mem0'], 'A_Wq': _A_in['Wq'], 'A_Wk': _A_in['Wk'], 'A_Wv': _A_in['Wv'], 'A_Wo': _A_in['Wo'], 'A_seg_len': _A_in['seg_len'], 'B_x': _B_in['x'], 'B_mem0': _B_in['mem0'], 'B_Wq': _B_in['Wq'], 'B_Wk': _B_in['Wk'], 'B_Wv': _B_in['Wv'], 'B_Wo': _B_in['Wo'], 'B_seg_len': _B_in['seg_len']}

def reference(A_x, A_mem0, A_Wq, A_Wk, A_Wv, A_Wo, A_seg_len, B_x, B_mem0, B_Wq, B_Wk, B_Wv, B_Wo, B_seg_len):

    def _A_ref(x, mem0, Wq, Wk, Wv, Wo, seg_len):
        B, S, Dm = x.shape
        H, Dh = (Wq.shape[1], Wq.shape[2])
        M = mem0.shape[1]
        scale = Dh ** (-0.5)
        n_seg = S // seg_len
        L = M + seg_len
        idx = torch.arange(L)
        mask = (idx[:, None] < M) | (idx[:, None] >= idx[None, :])
        mem = mem0
        outs = []
        for s in range(n_seg):
            xs = x[:, s * seg_len:(s + 1) * seg_len, :].clone()
            h = torch.concatenate([mem, xs], axis=1)
            q = torch.einsum('btd,dhe->bhte', h, Wq)
            k = torch.einsum('btd,dhe->bhte', h, Wk)
            v = torch.einsum('btd,dhe->bhte', h, Wv)
            scores = torch.einsum('bhqe,bhke->bhqk', q, k) * scale
            scores = torch.where(mask[None, None], scores, -1000000000.0)
            p = _softmax(scores, axis=-1)
            o = torch.einsum('bhqk,bhke->bhqe', p, v)
            o = torch.einsum('bhte,hed->btd', o, Wo)
            mem = o[:, :M, :].clone()
            outs.append(o[:, M:, :])
        return torch.concatenate(outs, axis=1)

    def _B_ref(x, mem0, Wq, Wk, Wv, Wo, seg_len):
        B, S, Dm = x.shape
        H, Dh = (Wq.shape[1], Wq.shape[2])
        M = mem0.shape[1]
        scale = Dh ** (-0.5)
        n_seg = S // seg_len
        L = M + seg_len
        idx = torch.arange(L)
        mask = (idx[:, None] < M) | (idx[:, None] >= idx[None, :])
        mem = mem0
        outs = []
        for s in range(n_seg):
            xs = x[:, s * seg_len:(s + 1) * seg_len, :].clone()
            h = torch.concatenate([mem, xs], axis=1)
            q = torch.einsum('btd,dhe->bhte', h, Wq)
            k = torch.einsum('btd,dhe->bhte', h, Wk)
            v = torch.einsum('btd,dhe->bhte', h, Wv)
            scores = torch.einsum('bhqe,bhke->bhqk', q, k) * scale
            scores = torch.where(mask[None, None], scores, -1000000000.0)
            p = _softmax(scores, axis=-1)
            o = torch.einsum('bhqk,bhke->bhqe', p, v)
            o = torch.einsum('bhte,hed->btd', o, Wo)
            mem = o[:, :M, :].clone()
            outs.append(o[:, M:, :])
        return torch.concatenate(outs, axis=1)
    a = _A_ref(A_x, A_mem0, A_Wq, A_Wk, A_Wv, A_Wo, A_seg_len)
    b = _B_ref(B_x, B_mem0, B_Wq, B_Wk, B_Wv, B_Wo, B_seg_len)
    return torch.concatenate([a, b], axis=-1)
```

```asm
; @launch grid=(256,1,1) block=(256,1,1) lds=163840
.amdgcn_target "amdgcn-amd-amdhsa--gfx950"
.text
.globl concat_heads__memory_aug_recurrent_mem_tr__memory_aug_recurrent_mem_tr__prompt_kernel
.p2align 8
.type concat_heads__memory_aug_recurrent_mem_tr__memory_aug_recurrent_mem_tr__prompt_kernel,@function
concat_heads__memory_aug_recurrent_mem_tr__memory_aug_recurrent_mem_tr__prompt_kernel:
    s_cmp_ge_u32 s2, 256
    s_cbranch_scc1 L_end
    s_mov_b32 s3, 0
    s_load_dwordx2 s[4:5], s[0:1], 128
    s_load_dwordx2 s[12:13], s[0:1], 120
    v_lshrrev_b32 v1, 6, v0
    v_and_b32 v0, 63, v0
    s_getreg_b32 s32, hwreg(HW_REG_XCC_ID)
    v_readfirstlane_b32 s16, v1
    s_and_b32 s32, s32, 7
    s_mov_b32 s6, 0x10000000
    s_mov_b32 s7, 0x20000
    s_mov_b32 s14, 256
    s_mov_b32 s15, 0x20000
    s_waitcnt lgkmcnt(0)
    s_cmp_lg_u32 s16, 0
    s_cbranch_scc1 L_tk_done
    s_mov_b64 exec, 1
    s_lshl_b32 s29, s32, 2
    v_mov_b32 v1, 1
    v_mov_b32 v2, s29
    v_mov_b32 v3, 38912
    buffer_atomic_add v1, v2, s[12:15], 0 offen sc0
    s_waitcnt vmcnt(0)
    ds_write_b32 v3, v1
    s_waitcnt lgkmcnt(0)
    s_mov_b64 exec, -1
L_tk_done:
    s_barrier
    v_mov_b32 v3, 38912
    ds_read_b32 v1, v3
    s_waitcnt lgkmcnt(0)
    v_readfirstlane_b32 s19, v1
    s_nop 3
    s_cmp_lt_u32 s19, 32
    s_cbranch_scc1 L_role_ok
    s_barrier
    s_cmp_lg_u32 s16, 0
    s_cbranch_scc1 L_ov_1
    s_mov_b64 exec, 1
    v_mov_b32 v1, 1
    v_mov_b32 v2, 32
    buffer_atomic_add v1, v2, s[12:15], 0 offen sc0
    s_waitcnt vmcnt(0)
    ds_write_b32 v3, v1
    s_waitcnt lgkmcnt(0)
    s_mov_b64 exec, -1
L_ov_1:
    s_barrier
    ds_read_b32 v1, v3
    s_waitcnt lgkmcnt(0)
    v_readfirstlane_b32 s29, v1
    v_lshlrev_b32 v2, 2, v0
L_ov_2:
    buffer_load_dword v1, v2, s[12:15], 0 offen sc1
    s_waitcnt vmcnt(0)
    v_readlane_b32 s64, v1, 0
    v_readlane_b32 s65, v1, 1
    v_readlane_b32 s66, v1, 2
    v_readlane_b32 s67, v1, 3
    v_readlane_b32 s68, v1, 4
    v_readlane_b32 s69, v1, 5
    v_readlane_b32 s70, v1, 6
    v_readlane_b32 s71, v1, 7
    s_nop 3
    s_mov_b32 s30, 0
    s_add_u32 s30, s30, s64
    s_add_u32 s30, s30, s65
    s_add_u32 s30, s30, s66
    s_add_u32 s30, s30, s67
    s_add_u32 s30, s30, s68
    s_add_u32 s30, s30, s69
    s_add_u32 s30, s30, s70
    s_add_u32 s30, s30, s71
    s_cmp_ge_u32 s30, 256
    s_cbranch_scc1 L_ov_3
    s_sleep 8
    s_branch L_spin_1
L_ov_3:
    s_min_u32 s30, s64, 32
    s_add_u32 s19, s30, s29
    s_mov_b32 s32, 0
    s_cmp_lt_u32 s19, 32
    s_cbranch_scc1 L_role_ok
    s_sub_u32 s29, s19, 32
    s_min_u32 s30, s65, 32
    s_add_u32 s19, s30, s29
    s_mov_b32 s32, 1
    s_cmp_lt_u32 s19, 32
    s_cbranch_scc1 L_role_ok
    s_sub_u32 s29, s19, 32
    s_min_u32 s30, s66, 32
    s_add_u32 s19, s30, s29
    s_mov_b32 s32, 2
    s_cmp_lt_u32 s19, 32
    s_cbranch_scc1 L_role_ok
    s_sub_u32 s29, s19, 32
    s_min_u32 s30, s67, 32
    s_add_u32 s19, s30, s29
    s_mov_b32 s32, 3
    s_cmp_lt_u32 s19, 32
    s_cbranch_scc1 L_role_ok
    s_sub_u32 s29, s19, 32
    s_min_u32 s30, s68, 32
    s_add_u32 s19, s30, s29
    s_mov_b32 s32, 4
    s_cmp_lt_u32 s19, 32
    s_cbranch_scc1 L_role_ok
    s_sub_u32 s29, s19, 32
    s_min_u32 s30, s69, 32
    s_add_u32 s19, s30, s29
    s_mov_b32 s32, 5
    s_cmp_lt_u32 s19, 32
    s_cbranch_scc1 L_role_ok
    s_sub_u32 s29, s19, 32
    s_min_u32 s30, s70, 32
    s_add_u32 s19, s30, s29
    s_mov_b32 s32, 6
    s_cmp_lt_u32 s19, 32
    s_cbranch_scc1 L_role_ok
    s_sub_u32 s29, s19, 32
    s_min_u32 s30, s71, 32
    s_add_u32 s19, s30, s29
    s_mov_b32 s32, 7
    s_cmp_lt_u32 s19, 32
    s_cbranch_scc1 L_role_ok
    s_sub_u32 s29, s19, 32
    s_branch L_end
L_role_ok:
    s_mov_b32 s100, s32
    s_mov_b32 s101, s19
    s_cmp_ge_u32 s32, 4
    s_cbranch_scc1 L_bulk
    s_lshr_b32 s17, s32, 1
    s_and_b32 s18, s32, 1
    s_lshr_b32 s30, s19, 1
    s_mul_i32 s20, s18, 16
    s_add_u32 s20, s20, s30
    s_and_b32 s21, s19, 1
    s_mul_i32 s33, s16, 32
    s_add_u32 s33, s33, s19
    s_mul_i32 s39, s17, 2482176
    s_add_u32 s39, s39, 176881664
    s_mul_i32 s27, s18, 32
    s_add_u32 s27, s27, s19
    s_max_u32 s40, s16, 1
    s_sub_u32 s40, s40, 1
    s_mov_b32 s38, 0x3dd53b95
    s_mov_b32 s44, 0x55555555
    s_mov_b32 s45, 0x55555555
    s_mul_i32 s29, s17, 56
    s_add_u32 s88, s0, s29
    s_addc_u32 s89, s1, 0
    s_load_dwordx2 s[64:65], s[88:89], 8
    s_load_dwordx4 s[68:71], s[88:89], 16
    s_load_dwordx4 s[72:75], s[88:89], 32
    s_mov_b32 s48, s39
    s_mul_i32 s29, s27, 2048
    s_add_u32 s48, s48, s29
    s_mul_i32 s29, s16, 512
    s_add_u32 s48, s48, s29
    s_xor_b32 s30, s27, 1
    s_mov_b32 s49, s39
    s_mul_i32 s29, s30, 2048
    s_add_u32 s49, s49, s29
    s_mov_b32 s50, s39
    s_mul_i32 s29, s27, 10240
    s_add_u32 s50, s50, s29
    s_mul_i32 s29, s16, 2048
    s_add_u32 s50, s50, s29
    s_add_u32 s50, s50, 131072
    s_mov_b32 s51, s39
    s_mul_i32 s29, s27, 10240
    s_add_u32 s51, s51, s29
    s_mul_i32 s29, s16, 512
    s_add_u32 s51, s51, s29
    s_add_u32 s51, s51, 139264
    s_mov_b32 s52, s39
    s_mul_i32 s29, s18, 327680
    s_add_u32 s52, s52, s29
    s_mul_i32 s29, s33, 128
    s_add_u32 s52, s52, s29
    s_add_u32 s52, s52, 131072
    s_mov_b32 s53, s52
    s_add_u32 s53, s53, 81920
    s_mov_b32 s54, s52
    s_add_u32 s54, s54, 163840
    s_mov_b32 s55, s52
    s_add_u32 s55, s55, 245760
    s_mov_b32 s56, s39
    s_mul_i32 s29, s18, 10240
    s_add_u32 s56, s56, s29
    s_mul_i32 s29, s33, 128
    s_add_u32 s56, s56, s29
    s_add_u32 s56, s56, 786432
    s_mul_i32 s57, s17, 1310720
    s_mul_i32 s29, s18, 10240
    s_add_u32 s57, s57, s29
    s_mul_i32 s29, s33, 128
    s_add_u32 s57, s57, s29
    s_add_u32 s57, s57, 181878784
    s_mov_b32 s58, s39
    s_mul_i32 s29, s18, 10240
    s_add_u32 s58, s58, s29
    s_mul_i32 s29, s16, 2048
    s_add_u32 s58, s58, s29
    s_add_u32 s58, s58, 786432
    s_mov_b32 s59, s39
    s_mul_i32 s29, s18, 10240
    s_add_u32 s59, s59, s29
    s_mul_i32 s29, s16, 512
    s_add_u32 s59, s59, s29
    s_add_u32 s59, s59, 794624
    s_xor_b32 s30, s18, 1
    s_mul_i32 s60, s17, 1310720
    s_mul_i32 s29, s30, 10240
    s_add_u32 s60, s60, s29
    s_mul_i32 s29, s16, 2048
    s_add_u32 s60, s60, s29
    s_add_u32 s60, s60, 181878784
    s_mul_i32 s61, s17, 1310720
    s_mul_i32 s29, s30, 10240
    s_add_u32 s61, s61, s29
    s_mul_i32 s29, s16, 512
    s_add_u32 s61, s61, s29
    s_add_u32 s61, s61, 181886976
    s_mov_b32 s62, 0x3f80
    s_mov_b32 s63, 0x3f800000
    s_mul_i32 s31, s17, 32
    s_add_u32 s31, s31, s20
    s_mul_i32 s36, s31, 197888
    s_mul_i32 s29, s21, 1536
    s_add_u32 s36, s36, s29
    s_add_u32 s36, s36, 151552000
    s_mul_i32 s37, s31, 197888
    s_mul_i32 s29, s21, 1536
    s_add_u32 s37, s37, s29
    s_add_u32 s37, s37, 164216832
    s_mul_i32 s34, s31, 790784
    s_mul_i32 s29, s21, 6144
    s_add_u32 s34, s34, s29
    s_mul_i32 s29, s16, 1536
    s_add_u32 s34, s34, s29
    s_mov_b32 s35, s34
    s_add_u32 s35, s35, 50610176
    v_and_b32 v10, 15, v0
    v_lshrrev_b32 v11, 4, v0
    v_lshlrev_b32 v3, 4, v0
    v_lshrrev_b32 v4, 1, v10
    v_mul_u32_u24 v4, 1344, v4
    v_and_b32 v5, 1, v10
    v_lshl_add_u32 v6, v11, 1, v5
    v_lshl_add_u32 v1, v6, 4, v4
    v_add_u32 v1, 0, v1
    v_cmp_eq_u32 vcc, 1, v5
    v_mov_b32 v6, 0x4444
    v_mov_b32 v7, 0xeeee
    v_cndmask_b32 v16, v6, v7, vcc
    v_mov_b32 v6, 0x8888
    v_mov_b32 v7, 0xdddd
    v_cndmask_b32 v17, v6, v7, vcc
    v_mov_b32 v6, 0x3f80
    v_mov_b32 v7, 0x3f800000
    v_cndmask_b32 v6, v6, v7, vcc
    v_lshrrev_b32 v7, 1, v10
    v_cmp_eq_u32 vcc, 0, v7
    s_nop 1
    v_cndmask_b32 v12, 0, v6, vcc
    v_cmp_eq_u32 vcc, 1, v7
    s_nop 1
    v_cndmask_b32 v13, 0, v6, vcc
    v_cmp_eq_u32 vcc, 2, v7
    s_nop 1
    v_cndmask_b32 v14, 0, v6, vcc
    v_cmp_eq_u32 vcc, 3, v7
    s_nop 1
    v_cndmask_b32 v15, 0, v6, vcc
    v_lshl_add_u32 v4, v11, 3, v7
    v_lshlrev_b32 v21, 4, v4
    v_lshlrev_b32 v24, 3, v0
    s_lshr_b32 s30, s16, 1
    s_and_b32 s31, s16, 1
    s_mul_i32 s30, s30, 1792
    s_mul_i32 s29, s31, 96
    s_add_u32 s30, s30, s29
    s_add_u32 s30, s30, 10752
    v_mul_u32_u24 v4, 448, v11
    v_add_u32 v4, s30, v4
    v_lshl_add_u32 v18, v10, 1, v4
    v_mul_u32_u24 v4, 224, v7
    v_lshl_add_u32 v19, v11, 4, v4
    v_add_u32 v19, 10752, v19
    v_and_b32 v4, 1, v11
    v_lshlrev_b32 v4, 8, v4
    v_lshl_add_u32 v27, v10, 4, v4
    v_add_u32 v27, 38976, v27
    v_lshlrev_b32 v4, 4, v10
    v_lshl_add_u32 v23, v11, 9, v4
    v_lshrrev_b32 v5, 3, v10
    v_lshl_add_u32 v5, v5, 2, v11
    v_mul_u32_u24 v5, 10240, v5
    v_and_b32 v6, 7, v10
    v_lshl_add_u32 v25, v6, 4, v5
    v_lshl_add_u32 v26, v11, 3, v4
    s_cmp_eq_u32 s16, 0
    s_cbranch_scc1 L_2
    v_lshrrev_b32 v5, 1, v11
    v_lshl_add_u32 v5, v5, 8, v4
    v_and_b32 v22, 1, v11
    v_lshl_add_u32 v22, v22, 2, v5
    s_mul_i32 s30, s40, 512
    v_add_u32 v22, s30, v22
    s_mul_i32 s30, s40, 4096
    s_add_u32 s30, s30, 40960
    v_add_u32 v20, s30, v3
    s_branch L_3
L_2:
    v_lshlrev_b32 v5, 4, v6
    v_lshl_add_u32 v22, v11, 7, v5
    v_mul_u32_u24 v4, 224, v6
    v_lshl_add_u32 v20, v11, 4, v4
    v_add_u32 v20, 12544, v20
L_3:
    v_add_u32 v28, 16384, v3
    v_lshlrev_b32 v29, 7, v0
    s_mul_i32 s30, s16, 320
    v_mul_u32_u24 v4, 2688, v11
    v_add_u32 v4, s30, v4
    v_lshl_add_u32 v30, v10, 4, v4
    v_lshl_add_u32 v31, v10, 2, v4
    v_add_u32 v31, 256, v31
    v_cmp_lt_u32 vcc, 1, v11
    v_mov_b32 v4, 0
    v_mov_b32 v5, 0xf149f2ca
    v_cndmask_b32 v2, v4, v5, vcc
    s_mul_i32 s30, s20, 384
    s_mul_i32 s29, s21, 192
    s_add_u32 s30, s30, s29
    v_add_u32 v4, 0, v0
    v_mul_u32_u24 v5, 171, v4
    v_lshrrev_b32 v5, 11, v5
    v_mul_u32_u24 v6, 12, v5
    v_sub_u32 v6, v4, v6
    v_mul_u32_u24 v5, 12288, v5
    v_lshl_add_u32 v5, v6, 4, v5
    v_add_u32 v32, s30, v5
    v_add_u32 v4, 64, v0
    v_mul_u32_u24 v5, 171, v4
    v_lshrrev_b32 v5, 11, v5
    v_mul_u32_u24 v6, 12, v5
    v_sub_u32 v6, v4, v6
    v_mul_u32_u24 v5, 12288, v5
    v_lshl_add_u32 v5, v6, 4, v5
    v_add_u32 v33, s30, v5
    v_add_u32 v4, 128, v0
    v_mul_u32_u24 v5, 171, v4
    v_lshrrev_b32 v5, 11, v5
    v_mul_u32_u24 v6, 12, v5
    v_sub_u32 v6, v4, v6
    v_mul_u32_u24 v5, 12288, v5
    v_lshl_add_u32 v5, v6, 4, v5
    v_add_u32 v34, s30, v5
    v_lshrrev_b32 v4, 1, v11
    v_and_b32 v5, 1, v11
    v_lshlrev_b32 v5, 2, v5
    v_lshl_add_u32 v4, v4, 4, v5
    v_lshrrev_b32 v5, 3, v10
    v_lshl_add_u32 v4, v5, 3, v4
    v_bfe_u32 v5, v10, 2, 1
    v_add_u32 v4, v4, v5
    v_mul_u32_u24 v9, 192, v4
    v_and_b32 v8, 3, v10
    v_add_u32 v9, 40960, v9
    v_lshl_add_u32 v38, v8, 3, v9
    s_and_b32 s31, s16, 1
    s_mul_i32 s31, s31, 48
    v_lshl_add_u32 v4, v8, 2, s31
    v_add_u32 v4, 0, v4
    v_bfe_u32 v7, v4, 2, 1
    v_lshrrev_b32 v6, 5, v4
    v_cmp_eq_u32 vcc, 2, v6
    v_mad_u32_u24 v5, v6, 3, v7
    v_mad_u32_u24 v7, v7, 3, 2
    v_cndmask_b32 v5, v5, v7, vcc
    v_lshlrev_b32 v5, 4, v5
    v_bfe_u32 v7, v4, 3, 2
    v_lshl_add_u32 v5, v7, 2, v5
    v_lshl_add_u32 v35, v5, 1, v9
    v_lshl_add_u32 v4, v8, 2, s31
    v_add_u32 v4, 16, v4
    v_bfe_u32 v7, v4, 2, 1
    v_lshrrev_b32 v6, 5, v4
    v_cmp_eq_u32 vcc, 2, v6
    v_mad_u32_u24 v5, v6, 3, v7
    v_mad_u32_u24 v7, v7, 3, 2
    v_cndmask_b32 v5, v5, v7, vcc
    v_lshlrev_b32 v5, 4, v5
    v_bfe_u32 v7, v4, 3, 2
    v_lshl_add_u32 v5, v7, 2, v5
    v_lshl_add_u32 v36, v5, 1, v9
    v_lshl_add_u32 v4, v8, 2, s31
    v_add_u32 v4, 32, v4
    v_bfe_u32 v7, v4, 2, 1
    v_lshrrev_b32 v6, 5, v4
    v_cmp_eq_u32 vcc, 2, v6
    v_mad_u32_u24 v5, v6, 3, v7
    v_mad_u32_u24 v7, v7, 3, 2
    v_cndmask_b32 v5, v5, v7, vcc
    v_lshlrev_b32 v5, 4, v5
    v_bfe_u32 v7, v4, 3, 2
    v_lshl_add_u32 v5, v7, 2, v5
    v_lshl_add_u32 v37, v5, 1, v9
    s_waitcnt lgkmcnt(0)
    s_mov_b32 s8, s68
    s_mov_b32 s9, s69
    s_mov_b32 s10, 7864320
    s_mov_b32 s11, 0x20000
    s_mov_b32 s84, s70
    s_mov_b32 s85, s71
    s_mov_b32 s86, 7864320
    s_mov_b32 s87, 0x20000
    s_mov_b32 s92, s72
    s_mov_b32 s93, s73
    s_mov_b32 s94, 7864320
    s_mov_b32 s95, 0x20000
    s_mul_i32 s22, s16, 393216
    s_mul_i32 s23, s16, 6144
    s_add_u32 s23, s23, 40960
    s_add_u32 s29, s22, 0
    s_add_u32 m0, s23, 0
    s_nop 0
    buffer_load_dwordx4 v32, s[8:11], s29 offen nt lds
    s_add_u32 s29, s22, 0
    s_add_u32 m0, s23, 1024
    s_nop 0
    buffer_load_dwordx4 v33, s[8:11], s29 offen nt lds
    s_add_u32 s29, s22, 0
    s_add_u32 m0, s23, 2048
    s_nop 0
    buffer_load_dwordx4 v34, s[8:11], s29 offen nt lds
    s_add_u32 s29, s22, 196608
    s_add_u32 m0, s23, 3072
    s_nop 0
    buffer_load_dwordx4 v32, s[8:11], s29 offen nt lds
    s_add_u32 s29, s22, 196608
    s_add_u32 m0, s23, 4096
    s_nop 0
    buffer_load_dwordx4 v33, s[8:11], s29 offen nt lds
    s_add_u32 s29, s22, 196608
    s_add_u32 m0, s23, 5120
    s_nop 0
    buffer_load_dwordx4 v34, s[8:11], s29 offen nt lds
    s_add_u32 s29, s22, 0
    s_add_u32 m0, s23, 24576
    s_nop 0
    buffer_load_dwordx4 v32, s[84:87], s29 offen nt lds
    s_add_u32 s29, s22, 0
    s_add_u32 m0, s23, 25600
    s_nop 0
    buffer_load_dwordx4 v33, s[84:87], s29 offen nt lds
    s_add_u32 s29, s22, 0
    s_add_u32 m0, s23, 26624
    s_nop 0
    buffer_load_dwordx4 v34, s[84:87], s29 offen nt lds
    s_add_u32 s29, s22, 196608
    s_add_u32 m0, s23, 27648
    s_nop 0
    buffer_load_dwordx4 v32, s[84:87], s29 offen nt lds
    s_add_u32 s29, s22, 196608
    s_add_u32 m0, s23, 28672
    s_nop 0
    buffer_load_dwordx4 v33, s[84:87], s29 offen nt lds
    s_add_u32 s29, s22, 196608
    s_add_u32 m0, s23, 29696
    s_nop 0
    buffer_load_dwordx4 v34, s[84:87], s29 offen nt lds
    s_add_u32 s29, s22, 1572864
    s_add_u32 m0, s23, 49152
    s_nop 0
    buffer_load_dwordx4 v32, s[8:11], s29 offen nt lds
    s_add_u32 s29, s22, 1572864
    s_add_u32 m0, s23, 50176
    s_nop 0
    buffer_load_dwordx4 v33, s[8:11], s29 offen nt lds
    s_add_u32 s29, s22, 1572864
    s_add_u32 m0, s23, 51200
    s_nop 0
    buffer_load_dwordx4 v34, s[8:11], s29 offen nt lds
    s_add_u32 s29, s22, 1769472
    s_add_u32 m0, s23, 52224
    s_nop 0
    buffer_load_dwordx4 v32, s[8:11], s29 offen nt lds
    s_add_u32 s29, s22, 1769472
    s_add_u32 m0, s23, 53248
    s_nop 0
    buffer_load_dwordx4 v33, s[8:11], s29 offen nt lds
    s_add_u32 s29, s22, 1769472
    s_add_u32 m0, s23, 54272
    s_nop 0
    buffer_load_dwordx4 v34, s[8:11], s29 offen nt lds
    s_add_u32 s29, s22, 1572864
    s_add_u32 m0, s23, 73728
    s_nop 0
    buffer_load_dwordx4 v32, s[84:87], s29 offen nt lds
    s_add_u32 s29, s22, 1572864
    s_add_u32 m0, s23, 74752
    s_nop 0
    buffer_load_dwordx4 v33, s[84:87], s29 offen nt lds
    s_add_u32 s29, s22, 1572864
    s_add_u32 m0, s23, 75776
    s_nop 0
    buffer_load_dwordx4 v34, s[84:87], s29 offen nt lds
    s_add_u32 s29, s22, 1769472
    s_add_u32 m0, s23, 76800
    s_nop 0
    buffer_load_dwordx4 v32, s[84:87], s29 offen nt lds
    s_add_u32 s29, s22, 1769472
    s_add_u32 m0, s23, 77824
    s_nop 0
    buffer_load_dwordx4 v33, s[84:87], s29 offen nt lds
    s_add_u32 s29, s22, 1769472
    s_add_u32 m0, s23, 78848
    s_nop 0
    buffer_load_dwordx4 v34, s[84:87], s29 offen nt lds
    s_add_u32 s29, s22, 3145728
    s_add_u32 m0, s23, 98304
    s_nop 0
    buffer_load_dwordx4 v32, s[8:11], s29 offen nt lds
    s_add_u32 s29, s22, 3145728
    s_add_u32 m0, s23, 99328
    s_nop 0
    buffer_load_dwordx4 v33, s[8:11], s29 offen nt lds
    s_add_u32 s29, s22, 3145728
    s_add_u32 m0, s23, 100352
    s_nop 0
    buffer_load_dwordx4 v34, s[8:11], s29 offen nt lds
    s_add_u32 s29, s22, 3342336
    s_add_u32 m0, s23, 101376
    s_nop 0
    buffer_load_dwordx4 v32, s[8:11], s29 offen nt lds
    s_add_u32 s29, s22, 3342336
    s_add_u32 m0, s23, 102400
    s_nop 0
    buffer_load_dwordx4 v33, s[8:11], s29 offen nt lds
    s_add_u32 s29, s22, 3342336
    s_add_u32 m0, s23, 103424
    s_nop 0
    buffer_load_dwordx4 v34, s[8:11], s29 offen nt lds
    s_mov_b32 s96, s74
    s_mov_b32 s97, s75
    s_mov_b32 s98, 7864320
    s_mov_b32 s99, 0x20000
    v_and_b32 v4, 1, v11
    v_lshrrev_b32 v5, 1, v11
    v_lshlrev_b32 v5, 2, v5
    v_lshl_add_u32 v4, v4, 4, v5
    v_mul_u32_u24 v4, 1280, v4
    s_mul_i32 s30, s27, 122880
    s_mul_i32 s29, s16, 320
    s_add_u32 s30, s30, s29
    v_add_u32 v4, s30, v4
    v_lshl_add_u32 v5, v10, 4, v4
    v_lshl_add_u32 v6, v10, 2, v4
    v_add_u32 v6, 256, v6
    s_mov_b32 s29, 0
    buffer_load_dwordx4 v[40:43], v5, s[96:99], s29 offen nt
    buffer_load_dword v232, v6, s[96:99], s29 offen nt
    s_mov_b32 s29, 1280
    buffer_load_dwordx4 v[44:47], v5, s[96:99], s29 offen nt
    buffer_load_dword v233, v6, s[96:99], s29 offen nt
    s_mov_b32 s29, 2560
    buffer_load_dwordx4 v[48:51], v5, s[96:99], s29 offen nt
    buffer_load_dword v234, v6, s[96:99], s29 offen nt
    s_mov_b32 s29, 3840
    buffer_load_dwordx4 v[52:55], v5, s[96:99], s29 offen nt
    buffer_load_dword v235, v6, s[96:99], s29 offen nt
    s_mov_b32 s29, 10240
    buffer_load_dwordx4 v[56:59], v5, s[96:99], s29 offen nt
    buffer_load_dword v236, v6, s[96:99], s29 offen nt
    s_mov_b32 s29, 11520
    buffer_load_dwordx4 v[60:63], v5, s[96:99], s29 offen nt
    buffer_load_dword v237, v6, s[96:99], s29 offen nt
    s_mov_b32 s29, 12800
    buffer_load_dwordx4 v[64:67], v5, s[96:99], s29 offen nt
    buffer_load_dword v238, v6, s[96:99], s29 offen nt
    s_mov_b32 s29, 14080
    buffer_load_dwordx4 v[68:71], v5, s[96:99], s29 offen nt
    buffer_load_dword v239, v6, s[96:99], s29 offen nt
    s_mov_b32 s29, 40960
    buffer_load_dwordx4 v[72:75], v5, s[96:99], s29 offen nt
    buffer_load_dword v240, v6, s[96:99], s29 offen nt
    s_mov_b32 s29, 42240
    buffer_load_dwordx4 v[76:79], v5, s[96:99], s29 offen nt
    buffer_load_dword v241, v6, s[96:99], s29 offen nt
    s_mov_b32 s29, 43520
    buffer_load_dwordx4 v[80:83], v5, s[96:99], s29 offen nt
    buffer_load_dword v242, v6, s[96:99], s29 offen nt
    s_mov_b32 s29, 44800
    buffer_load_dwordx4 v[84:87], v5, s[96:99], s29 offen nt
    buffer_load_dword v243, v6, s[96:99], s29 offen nt
    s_mov_b32 s29, 51200
    buffer_load_dwordx4 v[88:91], v5, s[96:99], s29 offen nt
    buffer_load_dword v244, v6, s[96:99], s29 offen nt
    s_mov_b32 s29, 52480
    buffer_load_dwordx4 v[92:95], v5, s[96:99], s29 offen nt
    buffer_load_dword v245, v6, s[96:99], s29 offen nt
    s_mov_b32 s29, 53760
    buffer_load_dwordx4 v[96:99], v5, s[96:99], s29 offen nt
    buffer_load_dword v246, v6, s[96:99], s29 offen nt
    s_mov_b32 s29, 55040
    buffer_load_dwordx4 v[100:103], v5, s[96:99], s29 offen nt
    buffer_load_dword v247, v6, s[96:99], s29 offen nt
    s_mov_b32 s29, 81920
    buffer_load_dwordx4 v[120:123], v5, s[96:99], s29 offen nt
    buffer_load_dword v248, v6, s[96:99], s29 offen nt
    s_mov_b32 s29, 83200
    buffer_load_dwordx4 v[124:127], v5, s[96:99], s29 offen nt
    buffer_load_dword v249, v6, s[96:99], s29 offen nt
    s_mov_b32 s29, 84480
    buffer_load_dwordx4 v[128:131], v5, s[96:99], s29 offen nt
    buffer_load_dword v250, v6, s[96:99], s29 offen nt
    s_mov_b32 s29, 85760
    buffer_load_dwordx4 v[132:135], v5, s[96:99], s29 offen nt
    buffer_load_dword v251, v6, s[96:99], s29 offen nt
    s_mov_b32 s29, 92160
    buffer_load_dwordx4 v[136:139], v5, s[96:99], s29 offen nt
    buffer_load_dword v252, v6, s[96:99], s29 offen nt
    s_mov_b32 s29, 93440
    buffer_load_dwordx4 v[140:143], v5, s[96:99], s29 offen nt
    buffer_load_dword v253, v6, s[96:99], s29 offen nt
    s_mov_b32 s29, 94720
    buffer_load_dwordx4 v[144:147], v5, s[96:99], s29 offen nt
    buffer_load_dword v254, v6, s[96:99], s29 offen nt
    s_mov_b32 s29, 96000
    buffer_load_dwordx4 v[148:151], v5, s[96:99], s29 offen nt
    buffer_load_dword v255, v6, s[96:99], s29 offen nt
    s_mov_b32 s76, s64
    s_mov_b32 s77, s65
    s_mov_b32 s78, 10240
    s_mov_b32 s79, 0x20000
    s_mul_i32 s30, s16, 2688
    s_mul_i32 s31, s16, 2560
    s_mov_b32 m0, s30
    s_nop 0
    buffer_load_dwordx4 v3, s[76:79], s31 offen lds
    s_mov_b64 exec, 0xffff
    buffer_load_dwordx4 v3, s[76:79], s31 offen offset:1024 lds
    s_mov_b64 exec, -1
    s_mul_i32 s30, s16, 2688
    s_add_u32 s30, s30, 1344
    s_mul_i32 s31, s16, 2560
    s_add_u32 s31, s31, 1280
    s_mov_b32 m0, s30
    s_nop 0
    buffer_load_dwordx4 v3, s[76:79], s31 offen lds
    s_mov_b64 exec, 0xffff
    buffer_load_dwordx4 v3, s[76:79], s31 offen offset:1024 lds
    s_mov_b64 exec, -1
    v_mov_b32 v104, 1
    v_mov_b32 v105, 1
    v_mov_b32 v106, 1
    v_mov_b32 v107, 1
    s_add_u32 s29, s48, 0
    buffer_store_dwordx4 v[104:107], v21, s[4:7], s29 offen sc1
    s_add_u32 s29, s50, 0
    buffer_store_dwordx4 v[104:107], v23, s[4:7], s29 offen sc1
    buffer_store_dwordx4 v[104:107], v23, s[4:7], s29 offen offset:256 sc1
    s_add_u32 s29, s51, 0
    buffer_store_dwordx2 v[104:105], v24, s[4:7], s29 offen sc1
    s_cmp_ge_u32 s33, 80
    s_cbranch_scc1 L_4
    s_mov_b64 exec, 0x00ff00ff
    s_add_u32 s29, s56, 0
    buffer_store_dwordx2 v[104:105], v26, s[4:7], s29 offen sc1
    s_mov_b64 exec, -1
    v_mul_u32_u24 v4, 20480, v11
    v_and_b32 v5, 7, v10
    v_lshl_add_u32 v4, v5, 4, v4
    v_and_b32 v108, 1, v11
    v_xor_b32 v108, 1, v108
    v_mov_b32 v109, v108
    v_mov_b32 v110, v108
    v_mov_b32 v111, v108
    s_mov_b32 exec_lo, 0x00ff00ff
    s_mov_b32 exec_hi, 0x00ff00ff
    s_add_u32 s29, s57, 0
    buffer_store_dwordx4 v[108:111], v4, s[4:7], s29 offen sc1
    s_add_u32 s29, s57, 81920
    buffer_store_dwordx4 v[108:111], v4, s[4:7], s29 offen sc1
    s_add_u32 s29, s57, 163840
    buffer_store_dwordx4 v[108:111], v4, s[4:7], s29 offen sc1
    s_add_u32 s29, s57, 245760
    buffer_store_dwordx4 v[108:111], v4, s[4:7], s29 offen sc1
    s_add_u32 s29, s57, 327680
    buffer_store_dwordx4 v[108:111], v4, s[4:7], s29 offen sc1
    s_add_u32 s29, s57, 409600
    buffer_store_dwordx4 v[108:111], v4, s[4:7], s29 offen sc1
    s_add_u32 s29, s57, 491520
    buffer_store_dwordx4 v[108:111], v4, s[4:7], s29 offen sc1
    s_add_u32 s29, s57, 573440
    buffer_store_dwordx4 v[108:111], v4, s[4:7], s29 offen sc1
    s_add_u32 s29, s57, 655360
    buffer_store_dwordx4 v[108:111], v4, s[4:7], s29 offen sc1
    s_add_u32 s29, s57, 737280
    buffer_store_dwordx4 v[108:111], v4, s[4:7], s29 offen sc1
    s_add_u32 s29, s57, 819200
    buffer_store_dwordx4 v[108:111], v4, s[4:7], s29 offen sc1
    s_add_u32 s29, s57, 901120
    buffer_store_dwordx4 v[108:111], v4, s[4:7], s29 offen sc1
    s_add_u32 s29, s57, 983040
    buffer_store_dwordx4 v[108:111], v4, s[4:7], s29 offen sc1
    s_add_u32 s29, s57, 1064960
    buffer_store_dwordx4 v[108:111], v4, s[4:7], s29 offen sc1
    s_add_u32 s29, s57, 1146880
    buffer_store_dwordx4 v[108:111], v4, s[4:7], s29 offen sc1
    s_add_u32 s29, s57, 1228800
    buffer_store_dwordx4 v[108:111], v4, s[4:7], s29 offen sc1
    s_mov_b64 exec, -1
L_4:
    s_nop 1
    v_mov_b32 v104, 0
    v_mov_b32 v105, 0
    v_mov_b32 v106, 0
    v_mov_b32 v107, 0
    s_add_u32 s29, s48, 827392
    buffer_store_dwordx4 v[104:107], v21, s[4:7], s29 offen sc1
    s_add_u32 s29, s50, 827392
    buffer_store_dwordx4 v[104:107], v23, s[4:7], s29 offen sc1
    buffer_store_dwordx4 v[104:107], v23, s[4:7], s29 offen offset:256 sc1
    s_add_u32 s29, s51, 827392
    buffer_store_dwordx2 v[104:105], v24, s[4:7], s29 offen sc1
    s_cmp_ge_u32 s33, 80
    s_cbranch_scc1 L_5
    s_mov_b64 exec, 0x00ff00ff
    s_add_u32 s29, s56, 827392
    buffer_store_dwordx2 v[104:105], v26, s[4:7], s29 offen sc1
    s_mov_b64 exec, -1
L_5:
    s_nop 1
    v_mov_b32 v104, 1
    v_mov_b32 v105, 1
    v_mov_b32 v106, 1
    v_mov_b32 v107, 1
    s_add_u32 s29, s48, 1654784
    buffer_store_dwordx4 v[104:107], v21, s[4:7], s29 offen sc1
    s_add_u32 s29, s50, 1654784
    buffer_store_dwordx4 v[104:107], v23, s[4:7], s29 offen sc1
    buffer_store_dwordx4 v[104:107], v23, s[4:7], s29 offen offset:256 sc1
    s_add_u32 s29, s51, 1654784
    buffer_store_dwordx2 v[104:105], v24, s[4:7], s29 offen sc1
    s_cmp_ge_u32 s33, 80
    s_cbranch_scc1 L_6
    s_mov_b64 exec, 0x00ff00ff
    s_add_u32 s29, s56, 1654784
    buffer_store_dwordx2 v[104:105], v26, s[4:7], s29 offen sc1
    s_mov_b64 exec, -1
L_6:
    s_nop 1
    s_mul_i32 s28, s17, 8192
    s_mul_i32 s29, s27, 128
    s_add_u32 s28, s28, s29
    s_add_u32 s28, s28, 181862400
    s_mul_i32 s42, s17, 8192
    s_mul_i32 s29, s20, 256
    s_add_u32 s42, s42, s29
    s_add_u32 s42, s42, 181846016
    v_mov_b32 v4, 0
    s_mov_b64 exec, 1
    buffer_store_dword v4, v4, s[4:7], s28 offen sc1
    s_mov_b64 exec, -1
    s_waitcnt vmcnt(60)
    s_barrier
    s_cmp_ge_u32 s16, 2
    s_cbranch_scc1 L_7
    ds_read_b64_tr_b16 a[0:1], v35 offset:0
    ds_read_b64_tr_b16 a[2:3], v35 offset:384
    ds_read_b64_tr_b16 a[4:5], v35 offset:6144
    ds_read_b64_tr_b16 a[6:7], v35 offset:6528
    ds_read_b64_tr_b16 a[80:81], v36 offset:0
    ds_read_b64_tr_b16 a[82:83], v36 offset:384
    ds_read_b64_tr_b16 a[84:85], v36 offset:6144
    ds_read_b64_tr_b16 a[86:87], v36 offset:6528
    ds_read_b64_tr_b16 a[160:161], v37 offset:0
    ds_read_b64_tr_b16 a[162:163], v37 offset:384
    ds_read_b64_tr_b16 a[164:165], v37 offset:6144
    ds_read_b64_tr_b16 a[166:167], v37 offset:6528
    ds_read_b64_tr_b16 a[8:9], v35 offset:12288
    ds_read_b64_tr_b16 a[10:11], v35 offset:12672
    ds_read_b64_tr_b16 a[12:13], v35 offset:18432
    ds_read_b64_tr_b16 a[14:15], v35 offset:18816
    ds_read_b64_tr_b16 a[88:89], v36 offset:12288
    ds_read_b64_tr_b16 a[90:91], v36 offset:12672
    ds_read_b64_tr_b16 a[92:93], v36 offset:18432
    ds_read_b64_tr_b16 a[94:95], v36 offset:18816
    ds_read_b64_tr_b16 a[168:169], v37 offset:12288
    ds_read_b64_tr_b16 a[170:171], v37 offset:12672
    ds_read_b64_tr_b16 a[172:173], v37 offset:18432
    ds_read_b64_tr_b16 a[174:175], v37 offset:18816
L_7:
    s_waitcnt lgkmcnt(0)
    s_barrier
    s_add_u32 s29, s22, 3145728
    s_add_u32 m0, s23, 0
    s_nop 0
    buffer_load_dwordx4 v32, s[84:87], s29 offen nt lds
    s_add_u32 s29, s22, 3145728
    s_add_u32 m0, s23, 1024
    s_nop 0
    buffer_load_dwordx4 v33, s[84:87], s29 offen nt lds
    s_add_u32 s29, s22, 3145728
    s_add_u32 m0, s23, 2048
    s_nop 0
    buffer_load_dwordx4 v34, s[84:87], s29 offen nt lds
    s_add_u32 s29, s22, 3342336
    s_add_u32 m0, s23, 3072
    s_nop 0
    buffer_load_dwordx4 v32, s[84:87], s29 offen nt lds
    s_add_u32 s29, s22, 3342336
    s_add_u32 m0, s23, 4096
    s_nop 0
    buffer_load_dwordx4 v33, s[84:87], s29 offen nt lds
    s_add_u32 s29, s22, 3342336
    s_add_u32 m0, s23, 5120
    s_nop 0
    buffer_load_dwordx4 v34, s[84:87], s29 offen nt lds
    s_waitcnt vmcnt(60)
    s_barrier
    s_cmp_lt_u32 s16, 2
    s_cbranch_scc1 L_8
    v_add_u32 v35, 24576, v35
    v_add_u32 v36, 24576, v36
    v_add_u32 v37, 24576, v37
    ds_read_b64_tr_b16 a[0:1], v35 offset:0
    ds_read_b64_tr_b16 a[2:3], v35 offset:384
    ds_read_b64_tr_b16 a[4:5], v35 offset:6144
    ds_read_b64_tr_b16 a[6:7], v35 offset:6528
    ds_read_b64_tr_b16 a[80:81], v36 offset:0
    ds_read_b64_tr_b16 a[82:83], v36 offset:384
    ds_read_b64_tr_b16 a[84:85], v36 offset:6144
    ds_read_b64_tr_b16 a[86:87], v36 offset:6528
    ds_read_b64_tr_b16 a[160:161], v37 offset:0
    ds_read_b64_tr_b16 a[162:163], v37 offset:384
    ds_read_b64_tr_b16 a[164:165], v37 offset:6144
    ds_read_b64_tr_b16 a[166:167], v37 offset:6528
    ds_read_b64_tr_b16 a[8:9], v35 offset:12288
    ds_read_b64_tr_b16 a[10:11], v35 offset:12672
    ds_read_b64_tr_b16 a[12:13], v35 offset:18432
    ds_read_b64_tr_b16 a[14:15], v35 offset:18816
    ds_read_b64_tr_b16 a[88:89], v36 offset:12288
    ds_read_b64_tr_b16 a[90:91], v36 offset:12672
    ds_read_b64_tr_b16 a[92:93], v36 offset:18432
    ds_read_b64_tr_b16 a[94:95], v36 offset:18816
    ds_read_b64_tr_b16 a[168:169], v37 offset:12288
    ds_read_b64_tr_b16 a[170:171], v37 offset:12672
    ds_read_b64_tr_b16 a[172:173], v37 offset:18432
    ds_read_b64_tr_b16 a[174:175], v37 offset:18816
L_8:
    s_waitcnt lgkmcnt(0)
    s_barrier
    s_add_u32 s29, s22, 4718592
    s_add_u32 m0, s23, 24576
    s_nop 0
    buffer_load_dwordx4 v32, s[8:11], s29 offen nt lds
    s_add_u32 s29, s22, 4718592
    s_add_u32 m0, s23, 25600
    s_nop 0
    buffer_load_dwordx4 v33, s[8:11], s29 offen nt lds
    s_add_u32 s29, s22, 4718592
    s_add_u32 m0, s23, 26624
    s_nop 0
    buffer_load_dwordx4 v34, s[8:11], s29 offen nt lds
    s_add_u32 s29, s22, 4915200
    s_add_u32 m0, s23, 27648
    s_nop 0
    buffer_load_dwordx4 v32, s[8:11], s29 offen nt lds
    s_add_u32 s29, s22, 4915200
    s_add_u32 m0, s23, 28672
    s_nop 0
    buffer_load_dwordx4 v33, s[8:11], s29 offen nt lds
    s_add_u32 s29, s22, 4915200
    s_add_u32 m0, s23, 29696
    s_nop 0
    buffer_load_dwordx4 v34, s[8:11], s29 offen nt lds
    s_waitcnt vmcnt(60)
    s_barrier
    s_cmp_ge_u32 s16, 2
    s_cbranch_scc1 L_9
    v_add_u32 v35, 49152, v35
    v_add_u32 v36, 49152, v36
    v_add_u32 v37, 49152, v37
    ds_read_b64_tr_b16 a[16:17], v35 offset:0
    ds_read_b64_tr_b16 a[18:19], v35 offset:384
    ds_read_b64_tr_b16 a[20:21], v35 offset:6144
    ds_read_b64_tr_b16 a[22:23], v35 offset:6528
    ds_read_b64_tr_b16 a[96:97], v36 offset:0
    ds_read_b64_tr_b16 a[98:99], v36 offset:384
    ds_read_b64_tr_b16 a[100:101], v36 offset:6144
    ds_read_b64_tr_b16 a[102:103], v36 offset:6528
    ds_read_b64_tr_b16 a[176:177], v37 offset:0
    ds_read_b64_tr_b16 a[178:179], v37 offset:384
    ds_read_b64_tr_b16 a[180:181], v37 offset:6144
    ds_read_b64_tr_b16 a[182:183], v37 offset:6528
    ds_read_b64_tr_b16 a[24:25], v35 offset:12288
    ds_read_b64_tr_b16 a[26:27], v35 offset:12672
    ds_read_b64_tr_b16 a[28:29], v35 offset:18432
    ds_read_b64_tr_b16 a[30:31], v35 offset:18816
    ds_read_b64_tr_b16 a[104:105], v36 offset:12288
    ds_read_b64_tr_b16 a[106:107], v36 offset:12672
    ds_read_b64_tr_b16 a[108:109], v36 offset:18432
    ds_read_b64_tr_b16 a[110:111], v36 offset:18816
    ds_read_b64_tr_b16 a[184:185], v37 offset:12288
    ds_read_b64_tr_b16 a[186:187], v37 offset:12672
    ds_read_b64_tr_b16 a[188:189], v37 offset:18432
    ds_read_b64_tr_b16 a[190:191], v37 offset:18816
L_9:
    s_waitcnt lgkmcnt(0)
    s_barrier
    s_add_u32 s29, s22, 4718592
    s_add_u32 m0, s23, 49152
    s_nop 0
    buffer_load_dwordx4 v32, s[84:87], s29 offen nt lds
    s_add_u32 s29, s22, 4718592
    s_add_u32 m0, s23, 50176
    s_nop 0
    buffer_load_dwordx4 v33, s[84:87], s29 offen nt lds
    s_add_u32 s29, s22, 4718592
    s_add_u32 m0, s23, 51200
    s_nop 0
    buffer_load_dwordx4 v34, s[84:87], s29 offen nt lds
    s_add_u32 s29, s22, 4915200
    s_add_u32 m0, s23, 52224
    s_nop 0
    buffer_load_dwordx4 v32, s[84:87], s29 offen nt lds
    s_add_u32 s29, s22, 4915200
    s_add_u32 m0, s23, 53248
    s_nop 0
    buffer_load_dwordx4 v33, s[84:87], s29 offen nt lds
    s_add_u32 s29, s22, 4915200
    s_add_u32 m0, s23, 54272
    s_nop 0
    buffer_load_dwordx4 v34, s[84:87], s29 offen nt lds
    s_waitcnt vmcnt(60)
    s_barrier
    s_cmp_lt_u32 s16, 2
    s_cbranch_scc1 L_10
    v_add_u32 v35, 49152, v35
    v_add_u32 v36, 49152, v36
    v_add_u32 v37, 49152, v37
    ds_read_b64_tr_b16 a[16:17], v35 offset:0
    ds_read_b64_tr_b16 a[18:19], v35 offset:384
    ds_read_b64_tr_b16 a[20:21], v35 offset:6144
    ds_read_b64_tr_b16 a[22:23], v35 offset:6528
    ds_read_b64_tr_b16 a[96:97], v36 offset:0
    ds_read_b64_tr_b16 a[98:99], v36 offset:384
    ds_read_b64_tr_b16 a[100:101], v36 offset:6144
    ds_read_b64_tr_b16 a[102:103], v36 offset:6528
    ds_read_b64_tr_b16 a[176:177], v37 offset:0
    ds_read_b64_tr_b16 a[178:179], v37 offset:384
    ds_read_b64_tr_b16 a[180:181], v37 offset:6144
    ds_read_b64_tr_b16 a[182:183], v37 offset:6528
    ds_read_b64_tr_b16 a[24:25], v35 offset:12288
    ds_read_b64_tr_b16 a[26:27], v35 offset:12672
    ds_read_b64_tr_b16 a[28:29], v35 offset:18432
    ds_read_b64_tr_b16 a[30:31], v35 offset:18816
    ds_read_b64_tr_b16 a[104:105], v36 offset:12288
    ds_read_b64_tr_b16 a[106:107], v36 offset:12672
    ds_read_b64_tr_b16 a[108:109], v36 offset:18432
    ds_read_b64_tr_b16 a[110:111], v36 offset:18816
    ds_read_b64_tr_b16 a[184:185], v37 offset:12288
    ds_read_b64_tr_b16 a[186:187], v37 offset:12672
    ds_read_b64_tr_b16 a[188:189], v37 offset:18432
    ds_read_b64_tr_b16 a[190:191], v37 offset:18816
L_10:
    s_waitcnt lgkmcnt(0)
    s_barrier
    s_add_u32 s29, s22, 6291456
    s_add_u32 m0, s23, 73728
    s_nop 0
    buffer_load_dwordx4 v32, s[8:11], s29 offen nt lds
    s_add_u32 s29, s22, 6291456
    s_add_u32 m0, s23, 74752
    s_nop 0
    buffer_load_dwordx4 v33, s[8:11], s29 offen nt lds
    s_add_u32 s29, s22, 6291456
    s_add_u32 m0, s23, 75776
    s_nop 0
    buffer_load_dwordx4 v34, s[8:11], s29 offen nt lds
    s_add_u32 s29, s22, 6488064
    s_add_u32 m0, s23, 76800
    s_nop 0
    buffer_load_dwordx4 v32, s[8:11], s29 offen nt lds
    s_add_u32 s29, s22, 6488064
    s_add_u32 m0, s23, 77824
    s_nop 0
    buffer_load_dwordx4 v33, s[8:11], s29 offen nt lds
    s_add_u32 s29, s22, 6488064
    s_add_u32 m0, s23, 78848
    s_nop 0
    buffer_load_dwordx4 v34, s[8:11], s29 offen nt lds
    s_waitcnt vmcnt(60)
    s_barrier
    s_cmp_ge_u32 s16, 2
    s_cbranch_scc1 L_11
    v_add_u32 v35, 49152, v35
    v_add_u32 v36, 49152, v36
    v_add_u32 v37, 49152, v37
    ds_read_b64_tr_b16 a[32:33], v35 offset:0
    ds_read_b64_tr_b16 a[34:35], v35 offset:384
    ds_read_b64_tr_b16 a[36:37], v35 offset:6144
    ds_read_b64_tr_b16 a[38:39], v35 offset:6528
    ds_read_b64_tr_b16 a[112:113], v36 offset:0
    ds_read_b64_tr_b16 a[114:115], v36 offset:384
    ds_read_b64_tr_b16 a[116:117], v36 offset:6144
    ds_read_b64_tr_b16 a[118:119], v36 offset:6528
    ds_read_b64_tr_b16 a[192:193], v37 offset:0
    ds_read_b64_tr_b16 a[194:195], v37 offset:384
    ds_read_b64_tr_b16 a[196:197], v37 offset:6144
    ds_read_b64_tr_b16 a[198:199], v37 offset:6528
    ds_read_b64_tr_b16 a[40:41], v35 offset:12288
    ds_read_b64_tr_b16 a[42:43], v35 offset:12672
    ds_read_b64_tr_b16 a[44:45], v35 offset:18432
    ds_read_b64_tr_b16 a[46:47], v35 offset:18816
    ds_read_b64_tr_b16 a[120:121], v36 offset:12288
    ds_read_b64_tr_b16 a[122:123], v36 offset:12672
    ds_read_b64_tr_b16 a[124:125], v36 offset:18432
    ds_read_b64_tr_b16 a[126:127], v36 offset:18816
    ds_read_b64_tr_b16 a[200:201], v37 offset:12288
    ds_read_b64_tr_b16 a[202:203], v37 offset:12672
    ds_read_b64_tr_b16 a[204:205], v37 offset:18432
    ds_read_b64_tr_b16 a[206:207], v37 offset:18816
L_11:
    s_waitcnt lgkmcnt(0)
    s_barrier
    s_add_u32 s29, s22, 6291456
    s_add_u32 m0, s23, 98304
    s_nop 0
    buffer_load_dwordx4 v32, s[84:87], s29 offen nt lds
    s_add_u32 s29, s22, 6291456
    s_add_u32 m0, s23, 99328
    s_nop 0
    buffer_load_dwordx4 v33, s[84:87], s29 offen nt lds
    s_add_u32 s29, s22, 6291456
    s_add_u32 m0, s23, 100352
    s_nop 0
    buffer_load_dwordx4 v34, s[84:87], s29 offen nt lds
    s_add_u32 s29, s22, 6488064
    s_add_u32 m0, s23, 101376
    s_nop 0
    buffer_load_dwordx4 v32, s[84:87], s29 offen nt lds
    s_add_u32 s29, s22, 6488064
    s_add_u32 m0, s23, 102400
    s_nop 0
    buffer_load_dwordx4 v33, s[84:87], s29 offen nt lds
    s_add_u32 s29, s22, 6488064
    s_add_u32 m0, s23, 103424
    s_nop 0
    buffer_load_dwordx4 v34, s[84:87], s29 offen nt lds
    s_waitcnt vmcnt(24)
    s_barrier
    s_cmp_lt_u32 s16, 2
    s_cbranch_scc1 L_12
    v_add_u32 v35, 4294893568, v35
    v_add_u32 v36, 4294893568, v36
    v_add_u32 v37, 4294893568, v37
    ds_read_b64_tr_b16 a[32:33], v35 offset:0
    ds_read_b64_tr_b16 a[34:35], v35 offset:384
    ds_read_b64_tr_b16 a[36:37], v35 offset:6144
    ds_read_b64_tr_b16 a[38:39], v35 offset:6528
    ds_read_b64_tr_b16 a[112:113], v36 offset:0
    ds_read_b64_tr_b16 a[114:115], v36 offset:384
    ds_read_b64_tr_b16 a[116:117], v36 offset:6144
    ds_read_b64_tr_b16 a[118:119], v36 offset:6528
    ds_read_b64_tr_b16 a[192:193], v37 offset:0
    ds_read_b64_tr_b16 a[194:195], v37 offset:384
    ds_read_b64_tr_b16 a[196:197], v37 offset:6144
    ds_read_b64_tr_b16 a[198:199], v37 offset:6528
    ds_read_b64_tr_b16 a[40:41], v35 offset:12288
    ds_read_b64_tr_b16 a[42:43], v35 offset:12672
    ds_read_b64_tr_b16 a[44:45], v35 offset:18432
    ds_read_b64_tr_b16 a[46:47], v35 offset:18816
    ds_read_b64_tr_b16 a[120:121], v36 offset:12288
    ds_read_b64_tr_b16 a[122:123], v36 offset:12672
    ds_read_b64_tr_b16 a[124:125], v36 offset:18432
    ds_read_b64_tr_b16 a[126:127], v36 offset:18816
    ds_read_b64_tr_b16 a[200:201], v37 offset:12288
    ds_read_b64_tr_b16 a[202:203], v37 offset:12672
    ds_read_b64_tr_b16 a[204:205], v37 offset:18432
    ds_read_b64_tr_b16 a[206:207], v37 offset:18816
L_12:
    s_waitcnt lgkmcnt(0)
    s_barrier
    s_add_u32 s29, s22, 0
    s_add_u32 m0, s23, 0
    s_nop 0
    buffer_load_dwordx4 v32, s[92:95], s29 offen nt lds
    s_add_u32 s29, s22, 0
    s_add_u32 m0, s23, 1024
    s_nop 0
    buffer_load_dwordx4 v33, s[92:95], s29 offen nt lds
    s_add_u32 s29, s22, 0
    s_add_u32 m0, s23, 2048
    s_nop 0
    buffer_load_dwordx4 v34, s[92:95], s29 offen nt lds
    s_add_u32 s29, s22, 196608
    s_add_u32 m0, s23, 3072
    s_nop 0
    buffer_load_dwordx4 v32, s[92:95], s29 offen nt lds
    s_add_u32 s29, s22, 196608
    s_add_u32 m0, s23, 4096
    s_nop 0
    buffer_load_dwordx4 v33, s[92:95], s29 offen nt lds
    s_add_u32 s29, s22, 196608
    s_add_u32 m0, s23, 5120
    s_nop 0
    buffer_load_dwordx4 v34, s[92:95], s29 offen nt lds
    s_cmp_lg_u32 s16, 0
    s_cbranch_scc1 L_ch_rdy
    s_mov_b64 exec, 1
    v_mov_b32 v5, 1
    v_mov_b32 v4, 0
    buffer_atomic_add v5, v4, s[12:15], 0 offen offset:40
    s_mov_b64 exec, -1
L_ch_rdy:
    s_waitcnt vmcnt(24)
    s_barrier
    s_cmp_ge_u32 s16, 2
    s_cbranch_scc1 L_13
    v_add_u32 v35, 4294893568, v35
    v_add_u32 v36, 4294893568, v36
    v_add_u32 v37, 4294893568, v37
    ds_read_b64_tr_b16 a[48:49], v35 offset:0
    ds_read_b64_tr_b16 a[50:51], v35 offset:384
    ds_read_b64_tr_b16 a[52:53], v35 offset:6144
    ds_read_b64_tr_b16 a[54:55], v35 offset:6528
    ds_read_b64_tr_b16 a[128:129], v36 offset:0
    ds_read_b64_tr_b16 a[130:131], v36 offset:384
    ds_read_b64_tr_b16 a[132:133], v36 offset:6144
    ds_read_b64_tr_b16 a[134:135], v36 offset:6528
    ds_read_b64_tr_b16 a[208:209], v37 offset:0
    ds_read_b64_tr_b16 a[210:211], v37 offset:384
    ds_read_b64_tr_b16 a[212:213], v37 offset:6144
    ds_read_b64_tr_b16 a[214:215], v37 offset:6528
    ds_read_b64_tr_b16 a[56:57], v35 offset:12288
    ds_read_b64_tr_b16 a[58:59], v35 offset:12672
    ds_read_b64_tr_b16 a[60:61], v35 offset:18432
    ds_read_b64_tr_b16 a[62:63], v35 offset:18816
    ds_read_b64_tr_b16 a[136:137], v36 offset:12288
    ds_read_b64_tr_b16 a[138:139], v36 offset:12672
    ds_read_b64_tr_b16 a[140:141], v36 offset:18432
    ds_read_b64_tr_b16 a[142:143], v36 offset:18816
    ds_read_b64_tr_b16 a[216:217], v37 offset:12288
    ds_read_b64_tr_b16 a[218:219], v37 offset:12672
    ds_read_b64_tr_b16 a[220:221], v37 offset:18432
    ds_read_b64_tr_b16 a[222:223], v37 offset:18816
L_13:
    s_waitcnt lgkmcnt(0)
    s_barrier
    s_add_u32 s29, s22, 1572864
    s_add_u32 m0, s23, 24576
    s_nop 0
    buffer_load_dwordx4 v32, s[92:95], s29 offen nt lds
    s_add_u32 s29, s22, 1572864
    s_add_u32 m0, s23, 25600
    s_nop 0
    buffer_load_dwordx4 v33, s[92:95], s29 offen nt lds
    s_add_u32 s29, s22, 1572864
    s_add_u32 m0, s23, 26624
    s_nop 0
    buffer_load_dwordx4 v34, s[92:95], s29 offen nt lds
    s_add_u32 s29, s22, 1769472
    s_add_u32 m0, s23, 27648
    s_nop 0
    buffer_load_dwordx4 v32, s[92:95], s29 offen nt lds
    s_add_u32 s29, s22, 1769472
    s_add_u32 m0, s23, 28672
    s_nop 0
    buffer_load_dwordx4 v33, s[92:95], s29 offen nt lds
    s_add_u32 s29, s22, 1769472
    s_add_u32 m0, s23, 29696
    s_nop 0
    buffer_load_dwordx4 v34, s[92:95], s29 offen nt lds
    s_waitcnt vmcnt(24)
    s_barrier
    s_cmp_lt_u32 s16, 2
    s_cbranch_scc1 L_14
    v_add_u32 v35, 49152, v35
    v_add_u32 v36, 49152, v36
    v_add_u32 v37, 49152, v37
    ds_read_b64_tr_b16 a[48:49], v35 offset:0
    ds_read_b64_tr_b16 a[50:51], v35 offset:384
    ds_read_b64_tr_b16 a[52:53], v35 offset:6144
    ds_read_b64_tr_b16 a[54:55], v35 offset:6528
    ds_read_b64_tr_b16 a[128:129], v36 offset:0
    ds_read_b64_tr_b16 a[130:131], v36 offset:384
    ds_read_b64_tr_b16 a[132:133], v36 offset:6144
    ds_read_b64_tr_b16 a[134:135], v36 offset:6528
    ds_read_b64_tr_b16 a[208:209], v37 offset:0
    ds_read_b64_tr_b16 a[210:211], v37 offset:384
    ds_read_b64_tr_b16 a[212:213], v37 offset:6144
    ds_read_b64_tr_b16 a[214:215], v37 offset:6528
    ds_read_b64_tr_b16 a[56:57], v35 offset:12288
    ds_read_b64_tr_b16 a[58:59], v35 offset:12672
    ds_read_b64_tr_b16 a[60:61], v35 offset:18432
    ds_read_b64_tr_b16 a[62:63], v35 offset:18816
    ds_read_b64_tr_b16 a[136:137], v36 offset:12288
    ds_read_b64_tr_b16 a[138:139], v36 offset:12672
    ds_read_b64_tr_b16 a[140:141], v36 offset:18432
    ds_read_b64_tr_b16 a[142:143], v36 offset:18816
    ds_read_b64_tr_b16 a[216:217], v37 offset:12288
    ds_read_b64_tr_b16 a[218:219], v37 offset:12672
    ds_read_b64_tr_b16 a[220:221], v37 offset:18432
    ds_read_b64_tr_b16 a[222:223], v37 offset:18816
L_14:
    s_waitcnt lgkmcnt(0)
    s_barrier
    s_add_u32 s29, s22, 3145728
    s_add_u32 m0, s23, 49152
    s_nop 0
    buffer_load_dwordx4 v32, s[92:95], s29 offen nt lds
    s_add_u32 s29, s22, 3145728
    s_add_u32 m0, s23, 50176
    s_nop 0
    buffer_load_dwordx4 v33, s[92:95], s29 offen nt lds
    s_add_u32 s29, s22, 3145728
    s_add_u32 m0, s23, 51200
    s_nop 0
    buffer_load_dwordx4 v34, s[92:95], s29 offen nt lds
    s_add_u32 s29, s22, 3342336
    s_add_u32 m0, s23, 52224
    s_nop 0
    buffer_load_dwordx4 v32, s[92:95], s29 offen nt lds
    s_add_u32 s29, s22, 3342336
    s_add_u32 m0, s23, 53248
    s_nop 0
    buffer_load_dwordx4 v33, s[92:95], s29 offen nt lds
    s_add_u32 s29, s22, 3342336
    s_add_u32 m0, s23, 54272
    s_nop 0
    buffer_load_dwordx4 v34, s[92:95], s29 offen nt lds
    s_waitcnt vmcnt(24)
    s_barrier
    s_cmp_ge_u32 s16, 2
    s_cbranch_scc1 L_15
    v_add_u32 v35, 49152, v35
    v_add_u32 v36, 49152, v36
    v_add_u32 v37, 49152, v37
    ds_read_b64_tr_b16 a[64:65], v35 offset:0
    ds_read_b64_tr_b16 a[66:67], v35 offset:384
    ds_read_b64_tr_b16 a[68:69], v35 offset:6144
    ds_read_b64_tr_b16 a[70:71], v35 offset:6528
    ds_read_b64_tr_b16 a[144:145], v36 offset:0
    ds_read_b64_tr_b16 a[146:147], v36 offset:384
    ds_read_b64_tr_b16 a[148:149], v36 offset:6144
    ds_read_b64_tr_b16 a[150:151], v36 offset:6528
    ds_read_b64_tr_b16 a[224:225], v37 offset:0
    ds_read_b64_tr_b16 a[226:227], v37 offset:384
    ds_read_b64_tr_b16 a[228:229], v37 offset:6144
    ds_read_b64_tr_b16 a[230:231], v37 offset:6528
    ds_read_b64_tr_b16 a[72:73], v35 offset:12288
    ds_read_b64_tr_b16 a[74:75], v35 offset:12672
    ds_read_b64_tr_b16 a[76:77], v35 offset:18432
    ds_read_b64_tr_b16 a[78:79], v35 offset:18816
    ds_read_b64_tr_b16 a[152:153], v36 offset:12288
    ds_read_b64_tr_b16 a[154:155], v36 offset:12672
    ds_read_b64_tr_b16 a[156:157], v36 offset:18432
    ds_read_b64_tr_b16 a[158:159], v36 offset:18816
    ds_read_b64_tr_b16 a[232:233], v37 offset:12288
    ds_read_b64_tr_b16 a[234:235], v37 offset:12672
    ds_read_b64_tr_b16 a[236:237], v37 offset:18432
    ds_read_b64_tr_b16 a[238:239], v37 offset:18816
L_15:
    s_waitcnt lgkmcnt(0)
    s_barrier
    s_add_u32 s29, s22, 4718592
    s_add_u32 m0, s23, 73728
    s_nop 0
    buffer_load_dwordx4 v32, s[92:95], s29 offen nt lds
    s_add_u32 s29, s22, 4718592
    s_add_u32 m0, s23, 74752
    s_nop 0
    buffer_load_dwordx4 v33, s[92:95], s29 offen nt lds
    s_add_u32 s29, s22, 4718592
    s_add_u32 m0, s23, 75776
    s_nop 0
    buffer_load_dwordx4 v34, s[92:95], s29 offen nt lds
    s_add_u32 s29, s22, 4915200
    s_add_u32 m0, s23, 76800
    s_nop 0
    buffer_load_dwordx4 v32, s[92:95], s29 offen nt lds
    s_add_u32 s29, s22, 4915200
    s_add_u32 m0, s23, 77824
    s_nop 0
    buffer_load_dwordx4 v33, s[92:95], s29 offen nt lds
    s_add_u32 s29, s22, 4915200
    s_add_u32 m0, s23, 78848
    s_nop 0
    buffer_load_dwordx4 v34, s[92:95], s29 offen nt lds
    s_waitcnt vmcnt(24)
    s_barrier
    s_cmp_lt_u32 s16, 2
    s_cbranch_scc1 L_16
    v_add_u32 v35, 49152, v35
    v_add_u32 v36, 49152, v36
    v_add_u32 v37, 49152, v37
    ds_read_b64_tr_b16 a[64:65], v35 offset:0
    ds_read_b64_tr_b16 a[66:67], v35 offset:384
    ds_read_b64_tr_b16 a[68:69], v35 offset:6144
    ds_read_b64_tr_b16 a[70:71], v35 offset:6528
    ds_read_b64_tr_b16 a[144:145], v36 offset:0
    ds_read_b64_tr_b16 a[146:147], v36 offset:384
    ds_read_b64_tr_b16 a[148:149], v36 offset:6144
    ds_read_b64_tr_b16 a[150:151], v36 offset:6528
    ds_read_b64_tr_b16 a[224:225], v37 offset:0
    ds_read_b64_tr_b16 a[226:227], v37 offset:384
    ds_read_b64_tr_b16 a[228:229], v37 offset:6144
    ds_read_b64_tr_b16 a[230:231], v37 offset:6528
    ds_read_b64_tr_b16 a[72:73], v35 offset:12288
    ds_read_b64_tr_b16 a[74:75], v35 offset:12672
    ds_read_b64_tr_b16 a[76:77], v35 offset:18432
    ds_read_b64_tr_b16 a[78:79], v35 offset:18816
    ds_read_b64_tr_b16 a[152:153], v36 offset:12288
    ds_read_b64_tr_b16 a[154:155], v36 offset:12672
    ds_read_b64_tr_b16 a[156:157], v36 offset:18432
    ds_read_b64_tr_b16 a[158:159], v36 offset:18816
    ds_read_b64_tr_b16 a[232:233], v37 offset:12288
    ds_read_b64_tr_b16 a[234:235], v37 offset:12672
    ds_read_b64_tr_b16 a[236:237], v37 offset:18432
    ds_read_b64_tr_b16 a[238:239], v37 offset:18816
L_16:
    s_waitcnt lgkmcnt(0)
    s_barrier
    s_add_u32 s29, s22, 6291456
    s_add_u32 m0, s23, 98304
    s_nop 0
    buffer_load_dwordx4 v32, s[92:95], s29 offen nt lds
    s_add_u32 s29, s22, 6291456
    s_add_u32 m0, s23, 99328
    s_nop 0
    buffer_load_dwordx4 v33, s[92:95], s29 offen nt lds
    s_add_u32 s29, s22, 6291456
    s_add_u32 m0, s23, 100352
    s_nop 0
    buffer_load_dwordx4 v34, s[92:95], s29 offen nt lds
    s_add_u32 s29, s22, 6488064
    s_add_u32 m0, s23, 101376
    s_nop 0
    buffer_load_dwordx4 v32, s[92:95], s29 offen nt lds
    s_add_u32 s29, s22, 6488064
    s_add_u32 m0, s23, 102400
    s_nop 0
    buffer_load_dwordx4 v33, s[92:95], s29 offen nt lds
    s_add_u32 s29, s22, 6488064
    s_add_u32 m0, s23, 103424
    s_nop 0
    buffer_load_dwordx4 v34, s[92:95], s29 offen nt lds
    s_mul_i32 s47, s16, 1536
    s_add_u32 s47, s47, 16384
    s_mul_i32 s41, s16, 1536
    s_add_u32 s41, s41, 32768
    s_mov_b32 s43, 0
    s_mov_b32 s40, 3
    v_mov_b32 v4, 0
L_ch_wait:
    buffer_load_dword v5, v4, s[12:15], 0 offen offset:40 sc1
    s_waitcnt vmcnt(0)
    v_cmp_gt_u32 vcc, 256, v5
    s_cbranch_vccz L_ch_go0
    s_sleep 8
    s_branch L_spin_17
L_ch_go0:
    s_add_u32 s29, s49, 0
    buffer_load_dwordx4 v[32:35], v21, s[4:7], s29 offen offset:0 sc1
    buffer_load_dwordx4 v[32:35], v21, s[4:7], s29 offen offset:512 sc1
    buffer_load_dwordx4 v[32:35], v21, s[4:7], s29 offen offset:1024 sc1
    s_add_u32 s29, s52, 0
    buffer_load_dwordx4 v[32:35], v25, s[4:7], s29 offen sc1
    s_add_u32 s29, s53, 0
    buffer_load_dwordx4 v[32:35], v25, s[4:7], s29 offen sc1
    s_add_u32 s29, s54, 0
    buffer_load_dwordx4 v[32:35], v25, s[4:7], s29 offen sc1
    s_add_u32 s29, s55, 0
    buffer_load_dwordx4 v[32:35], v25, s[4:7], s29 offen sc1
    s_add_u32 s29, s58, 0
    buffer_load_dwordx4 v[32:35], v23, s[4:7], s29 offen offset:0 sc1
    buffer_load_dwordx4 v[32:35], v23, s[4:7], s29 offen offset:256 sc1
    s_add_u32 s29, s59, 0
    buffer_load_dwordx2 v[32:33], v24, s[4:7], s29 offen sc1
    s_add_u32 s29, s49, 827392
    buffer_load_dwordx4 v[32:35], v21, s[4:7], s29 offen offset:0 sc1
    buffer_load_dwordx4 v[32:35], v21, s[4:7], s29 offen offset:512 sc1
    buffer_load_dwordx4 v[32:35], v21, s[4:7], s29 offen offset:1024 sc1
    s_add_u32 s29, s52, 827392
    buffer_load_dwordx4 v[32:35], v25, s[4:7], s29 offen sc1
    s_add_u32 s29, s53, 827392
    buffer_load_dwordx4 v[32:35], v25, s[4:7], s29 offen sc1
    s_add_u32 s29, s54, 827392
    buffer_load_dwordx4 v[32:35], v25, s[4:7], s29 offen sc1
    s_add_u32 s29, s55, 827392
    buffer_load_dwordx4 v[32:35], v25, s[4:7], s29 offen sc1
    s_add_u32 s29, s58, 827392
    buffer_load_dwordx4 v[32:35], v23, s[4:7], s29 offen offset:0 sc1
    buffer_load_dwordx4 v[32:35], v23, s[4:7], s29 offen offset:256 sc1
    s_add_u32 s29, s59, 827392
    buffer_load_dwordx2 v[32:33], v24, s[4:7], s29 offen sc1
    s_add_u32 s29, s49, 1654784
    buffer_load_dwordx4 v[32:35], v21, s[4:7], s29 offen offset:0 sc1
    buffer_load_dwordx4 v[32:35], v21, s[4:7], s29 offen offset:512 sc1
    buffer_load_dwordx4 v[32:35], v21, s[4:7], s29 offen offset:1024 sc1
    s_add_u32 s29, s52, 1654784
    buffer_load_dwordx4 v[32:35], v25, s[4:7], s29 offen sc1
    s_add_u32 s29, s53, 1654784
    buffer_load_dwordx4 v[32:35], v25, s[4:7], s29 offen sc1
    s_add_u32 s29, s54, 1654784
    buffer_load_dwordx4 v[32:35], v25, s[4:7], s29 offen sc1
    s_add_u32 s29, s55, 1654784
    buffer_load_dwordx4 v[32:35], v25, s[4:7], s29 offen sc1
    s_add_u32 s29, s58, 1654784
    buffer_load_dwordx4 v[32:35], v23, s[4:7], s29 offen offset:0 sc1
    buffer_load_dwordx4 v[32:35], v23, s[4:7], s29 offen offset:256 sc1
    s_add_u32 s29, s59, 1654784
    buffer_load_dwordx2 v[32:33], v24, s[4:7], s29 offen sc1
    s_mov_b32 s24, 0
    s_add_u32 s40, s24, 1
    s_min_u32 s40, s40, 64
    s_cmp_ge_u32 s43, s40
    s_cbranch_scc1 L_18
    v_lshlrev_b32 v6, 7, v0
    s_cmp_ge_u32 s43, s40
    s_cbranch_scc1 L_20
    s_mov_b64 exec, 3
L_19:
    buffer_load_dword v7, v6, s[4:7], s42 offen sc1
    s_waitcnt vmcnt(0)
    v_cmp_gt_u32 vcc, s40, v7
    s_cbranch_vccz L_21
    s_sleep 4
    s_branch L_spin_22
L_21:
    v_readlane_b32 s43, v7, 0
    v_readlane_b32 s29, v7, 1
    s_nop 3
    s_min_u32 s43, s43, s29
    s_mov_b64 exec, -1
L_20:
L_18:
    s_mov_b32 m0, s47
    s_xor_b32 s47, s47, 8192
    buffer_load_dwordx4 v3, s[4:7], s34 offen sc1 lds
    s_mov_b32 exec_hi, 0
    buffer_load_dwordx4 v3, s[4:7], s34 offen offset:1024 sc1 lds
    s_mov_b32 exec_hi, -1
    s_add_u32 s34, s34, 12288
    s_mov_b32 m0, s41
    s_nop 0
    buffer_load_dwordx4 v3, s[4:7], s35 offen sc1 lds
    s_mov_b32 exec_hi, 0
    buffer_load_dwordx4 v3, s[4:7], s35 offen offset:1024 sc1 lds
    s_mov_b32 exec_hi, -1
    s_add_u32 s35, s35, 12288
    s_add_u32 s40, s24, 3
    s_min_u32 s40, s40, 64
    s_cmp_ge_u32 s43, s40
    s_cbranch_scc1 L_23
    v_lshlrev_b32 v6, 7, v0
    s_cmp_ge_u32 s43, s40
    s_cbranch_scc1 L_25
    s_mov_b64 exec, 3
L_24:
    buffer_load_dword v7, v6, s[4:7], s42 offen sc1
    s_waitcnt vmcnt(0)
    v_cmp_gt_u32 vcc, s40, v7
    s_cbranch_vccz L_26
    s_sleep 4
    s_branch L_spin_27
L_26:
    v_readlane_b32 s43, v7, 0
    v_readlane_b32 s29, v7, 1
    s_nop 3
    s_min_u32 s43, s43, s29
    s_mov_b64 exec, -1
L_25:
L_23:
    s_mov_b32 m0, s47
    s_xor_b32 s47, s47, 8192
    buffer_load_dwordx4 v3, s[4:7], s34 offen sc1 lds
    s_mov_b32 exec_hi, 0
    buffer_load_dwordx4 v3, s[4:7], s34 offen offset:1024 sc1 lds
    s_mov_b32 exec_hi, -1
    s_add_u32 s34, s34, 12288
    s_barrier
    v_accvgpr_write_b32 a240, v40
    v_mov_b32 v160, v41
    v_mov_b32 v184, v42
    v_mov_b32 v208, v43
    v_accvgpr_write_b32 a241, v44
    v_mov_b32 v161, v45
    v_mov_b32 v185, v46
    v_mov_b32 v209, v47
    v_accvgpr_write_b32 a242, v48
    v_mov_b32 v162, v49
    v_mov_b32 v186, v50
    v_mov_b32 v210, v51
    v_accvgpr_write_b32 a243, v52
    v_mov_b32 v163, v53
    v_mov_b32 v187, v54
    v_mov_b32 v211, v55
    v_accvgpr_write_b32 a244, v56
    v_mov_b32 v164, v57
    v_mov_b32 v188, v58
    v_mov_b32 v212, v59
    v_accvgpr_write_b32 a245, v60
    v_mov_b32 v165, v61
    v_mov_b32 v189, v62
    v_mov_b32 v213, v63
    v_accvgpr_write_b32 a246, v64
    v_mov_b32 v166, v65
    v_mov_b32 v190, v66
    v_mov_b32 v214, v67
    v_accvgpr_write_b32 a247, v68
    v_mov_b32 v167, v69
    v_mov_b32 v191, v70
    v_mov_b32 v215, v71
    v_accvgpr_write_b32 a248, v72
    v_mov_b32 v168, v73
    v_mov_b32 v192, v74
    v_mov_b32 v216, v75
    v_accvgpr_write_b32 a249, v76
    v_mov_b32 v169, v77
    v_mov_b32 v193, v78
    v_mov_b32 v217, v79
    v_accvgpr_write_b32 a250, v80
    v_mov_b32 v170, v81
    v_mov_b32 v194, v82
    v_mov_b32 v218, v83
    v_accvgpr_write_b32 a251, v84
    v_mov_b32 v171, v85
    v_mov_b32 v195, v86
    v_mov_b32 v219, v87
    v_accvgpr_write_b32 a252, v88
    v_mov_b32 v172, v89
    v_mov_b32 v196, v90
    v_mov_b32 v220, v91
    v_accvgpr_write_b32 a253, v92
    v_mov_b32 v173, v93
    v_mov_b32 v197, v94
    v_mov_b32 v221, v95
    v_accvgpr_write_b32 a254, v96
    v_mov_b32 v174, v97
    v_mov_b32 v198, v98
    v_mov_b32 v222, v99
    v_accvgpr_write_b32 a255, v100
    v_mov_b32 v175, v101
    v_mov_b32 v199, v102
    v_mov_b32 v223, v103
    v_mov_b32 v152, v120
    v_mov_b32 v176, v121
    v_mov_b32 v200, v122
    v_mov_b32 v224, v123
    v_mov_b32 v153, v124
    v_mov_b32 v177, v125
    v_mov_b32 v201, v126
    v_mov_b32 v225, v127
    v_mov_b32 v154, v128
    v_mov_b32 v178, v129
    v_mov_b32 v202, v130
    v_mov_b32 v226, v131
    v_mov_b32 v155, v132
    v_mov_b32 v179, v133
    v_mov_b32 v203, v134
    v_mov_b32 v227, v135
    v_mov_b32 v156, v136
    v_mov_b32 v180, v137
    v_mov_b32 v204, v138
    v_mov_b32 v228, v139
    v_mov_b32 v157, v140
    v_mov_b32 v181, v141
    v_mov_b32 v205, v142
    v_mov_b32 v229, v143
    v_mov_b32 v158, v144
    v_mov_b32 v182, v145
    v_mov_b32 v206, v146
    v_mov_b32 v230, v147
    v_mov_b32 v159, v148
    v_mov_b32 v183, v149
    v_mov_b32 v207, v150
    v_mov_b32 v231, v151
    s_mov_b32 s31, s16
L_wv_loop:
    s_mul_i32 s29, s31, 12288
    v_add_u32 v4, s29, v38
    v_add_u32 v5, s29, v3
    v_add_u32 v5, 40960, v5
    ds_read_b64_tr_b16 v[72:73], v4 offset:0
    ds_read_b64_tr_b16 v[74:75], v4 offset:384
    ds_read_b64_tr_b16 v[76:77], v4 offset:6144
    ds_read_b64_tr_b16 v[78:79], v4 offset:6528
    ds_read_b64_tr_b16 v[80:81], v4 offset:32
    ds_read_b64_tr_b16 v[82:83], v4 offset:416
    ds_read_b64_tr_b16 v[84:85], v4 offset:6176
    ds_read_b64_tr_b16 v[86:87], v4 offset:6560
    ds_read_b64_tr_b16 v[88:89], v4 offset:64
    ds_read_b64_tr_b16 v[90:91], v4 offset:448
    ds_read_b64_tr_b16 v[92:93], v4 offset:6208
    ds_read_b64_tr_b16 v[94:95], v4 offset:6592
    ds_read_b64_tr_b16 v[96:97], v4 offset:96
    ds_read_b64_tr_b16 v[98:99], v4 offset:480
    ds_read_b64_tr_b16 v[100:101], v4 offset:6240
    ds_read_b64_tr_b16 v[102:103], v4 offset:6624
    ds_read_b64_tr_b16 v[104:105], v4 offset:128
    ds_read_b64_tr_b16 v[106:107], v4 offset:512
    ds_read_b64_tr_b16 v[108:109], v4 offset:6272
    ds_read_b64_tr_b16 v[110:111], v4 offset:6656
    ds_read_b64_tr_b16 v[112:113], v4 offset:160
    ds_read_b64_tr_b16 v[114:115], v4 offset:544
    ds_read_b64_tr_b16 v[116:117], v4 offset:6304
    ds_read_b64_tr_b16 v[118:119], v4 offset:6688
    s_waitcnt lgkmcnt(0)
    ds_write_b128 v5, v[72:75] offset:0
    ds_write_b128 v5, v[76:79] offset:1024
    ds_write_b128 v5, v[80:83] offset:2048
    ds_write_b128 v5, v[84:87] offset:3072
    ds_write_b128 v5, v[88:91] offset:4096
    ds_write_b128 v5, v[92:95] offset:5120
    ds_write_b128 v5, v[96:99] offset:6144
    ds_write_b128 v5, v[100:103] offset:7168
    ds_write_b128 v5, v[104:107] offset:8192
    ds_write_b128 v5, v[108:111] offset:9216
    ds_write_b128 v5, v[112:115] offset:10240
    ds_write_b128 v5, v[116:119] offset:11264
    s_waitcnt lgkmcnt(0)
    s_add_u32 s31, s31, 4
    s_cmp_lt_u32 s31, 10
    s_cbranch_scc1 L_wv_loop
    s_waitcnt vmcnt(0)
L_ch_go:
    s_mov_b32 s24, 0
    s_mov_b32 s25, 0
    s_mov_b32 s26, 0
    s_waitcnt lgkmcnt(0)
    v_mov_b32 v132, 0
    v_mov_b32 v133, 0
    v_mov_b32 v134, 0
    v_mov_b32 v135, 0
    v_mov_b32 v136, 0
    v_mov_b32 v137, 0
    v_mov_b32 v138, 0
    v_mov_b32 v139, 0
    v_mov_b32 v140, 0
    v_mov_b32 v141, 0
    v_mov_b32 v142, 0
    v_mov_b32 v143, 0
    v_mov_b32 v144, 0
    v_mov_b32 v145, 0
    v_mov_b32 v146, 0
    v_mov_b32 v147, 0
    v_mov_b32 v148, 0
    v_mov_b32 v149, 0
    v_mov_b32 v150, 0
    v_mov_b32 v151, 0
    v_lshlrev_b32 v4, 2, v0
    s_mov_b64 exec, 0xff
    buffer_load_dword v5, v4, s[12:15], 0 offen sc1
    s_waitcnt vmcnt(0)
    v_cmp_ne_u32 vcc, 32, v5
    s_mov_b64 exec, -1
    s_cbranch_vccnz L_step_S
.p2align 6
L_step:
    s_barrier
    ds_read_b128 v[32:35], v1 offset:0
    ds_read_b128 v[36:39], v1 offset:128
    ds_read_b128 v[40:43], v1 offset:256
    ds_read_b128 v[44:47], v1 offset:384
    ds_read_b128 v[48:51], v1 offset:512
    ds_read_b128 v[52:55], v1 offset:640
    ds_read_b128 v[56:59], v1 offset:768
    ds_read_b128 v[60:63], v1 offset:896
    ds_read_b128 v[64:67], v1 offset:1024
    ds_read_b128 v[68:71], v1 offset:1152
    s_cmp_eq_u32 s16, 2
    s_cbranch_scc1 L_28
    ds_read_b128 v[120:123], v28 offset:0
    ds_read_b128 v[124:127], v28 offset:1024
    ds_read_b64 v[128:129], v28 offset:4096
    ds_read_b64 v[130:131], v28 offset:5120
    s_branch L_29
L_28:
    ds_read_b128 v[120:123], v28 offset:2048
    ds_read_b128 v[124:127], v28 offset:3072
    ds_read_b64 v[128:129], v28 offset:4104
    ds_read_b64 v[130:131], v28 offset:5128
L_29:
    s_waitcnt lgkmcnt(13)
    v_smfmac_f32_16x16x64_bf16 v[132:135], v[32:35], a[0:7], v16
    v_smfmac_f32_16x16x64_bf16 v[136:139], v[32:35], a[80:87], v16
    v_smfmac_f32_16x16x64_bf16 v[140:143], v[32:35], a[160:167], v16
    s_waitcnt lgkmcnt(12)
    v_smfmac_f32_16x16x64_bf16 v[132:135], v[36:39], a[8:15], v16
    v_smfmac_f32_16x16x64_bf16 v[136:139], v[36:39], a[88:95], v16
    v_smfmac_f32_16x16x64_bf16 v[140:143], v[36:39], a[168:175], v16
    s_waitcnt lgkmcnt(11)
    v_smfmac_f32_16x16x64_bf16 v[132:135], v[40:43], a[16:23], v16
    v_smfmac_f32_16x16x64_bf16 v[136:139], v[40:43], a[96:103], v16
    v_smfmac_f32_16x16x64_bf16 v[140:143], v[40:43], a[176:183], v16
    s_waitcnt lgkmcnt(10)
    v_smfmac_f32_16x16x64_bf16 v[132:135], v[44:47], a[24:31], v16
    ds_read_b128 v[72:75], v3 offset:32768
    ds_read_b128 v[76:79], v3 offset:33792
    v_smfmac_f32_16x16x64_bf16 v[136:139], v[44:47], a[104:111], v16
    ds_read_b128 v[80:83], v3 offset:34816
    ds_read_b128 v[84:87], v3 offset:35840
    v_smfmac_f32_16x16x64_bf16 v[140:143], v[44:47], a[184:191], v16
    ds_read_b128 v[88:91], v3 offset:36864
    ds_read_b128 v[92:95], v3 offset:37888
    s_waitcnt lgkmcnt(15)
    v_smfmac_f32_16x16x64_bf16 v[132:135], v[48:51], a[32:39], v16
    v_smfmac_f32_16x16x64_bf16 v[136:139], v[48:51], a[112:119], v16
    v_smfmac_f32_16x16x64_bf16 v[140:143], v[48:51], a[192:199], v16
    s_waitcnt lgkmcnt(14)
    v_smfmac_f32_16x16x64_bf16 v[132:135], v[52:55], a[40:47], v16
    v_xor_b32 v28, 8192, v28
    v_smfmac_f32_16x16x64_bf16 v[136:139], v[52:55], a[120:127], v16
    v_smfmac_f32_16x16x64_bf16 v[140:143], v[52:55], a[200:207], v16
    s_waitcnt lgkmcnt(13)
    v_smfmac_f32_16x16x64_bf16 v[132:135], v[56:59], a[48:55], v16
    v_smfmac_f32_16x16x64_bf16 v[136:139], v[56:59], a[128:135], v16
    v_smfmac_f32_16x16x64_bf16 v[140:143], v[56:59], a[208:215], v16
    s_waitcnt lgkmcnt(12)
    v_smfmac_f32_16x16x64_bf16 v[132:135], v[60:63], a[56:63], v16
    v_smfmac_f32_16x16x64_bf16 v[136:139], v[60:63], a[136:143], v16
    v_smfmac_f32_16x16x64_bf16 v[140:143], v[60:63], a[216:223], v16
    s_waitcnt lgkmcnt(11)
    v_smfmac_f32_16x16x64_bf16 v[132:135], v[64:67], a[64:71], v16
    v_smfmac_f32_16x16x64_bf16 v[136:139], v[64:67], a[144:151], v16
    v_smfmac_f32_16x16x64_bf16 v[140:143], v[64:67], a[224:231], v16
    s_waitcnt lgkmcnt(10)
    v_smfmac_f32_16x16x64_bf16 v[132:135], v[68:71], a[72:79], v16
    ds_read_b128 v[96:99], v20 offset:0
    ds_read_b128 v[100:103], v20 offset:1024
    v_smfmac_f32_16x16x64_bf16 v[136:139], v[68:71], a[152:159], v16
    ds_read_b128 v[104:107], v20 offset:2048
    ds_read_b128 v[108:111], v20 offset:3072
    v_smfmac_f32_16x16x64_bf16 v[140:143], v[68:71], a[232:239], v16
    ds_read_b128 v[112:115], v20 offset:12288
    ds_read_b128 v[116:119], v20 offset:13312
    s_mov_b32 s29, 827392
    s_cmp_eq_u32 s25, 2
    s_cselect_b32 s46, 4293312512, s29
    v_add_f32 v132, v132, v133
    v_add_f32 v134, v134, v135
    v_cvt_pk_bf16_f32 v4, v132, v134
    ds_write_b16 v18, v4 offset:0
    ds_write_b16_d16_hi v18, v4 offset:224
    v_add_f32 v136, v136, v137
    v_add_f32 v138, v138, v139
    v_cvt_pk_bf16_f32 v5, v136, v138
    ds_write_b16 v18, v5 offset:32
    ds_write_b16_d16_hi v18, v5 offset:256
    s_nop 0
    v_add_f32 v140, v140, v141
    v_add_f32 v142, v142, v143
    v_cvt_pk_bf16_f32 v6, v140, v142
    ds_write_b16 v18, v6 offset:64
    ds_write_b16_d16_hi v18, v6 offset:288
    s_waitcnt lgkmcnt(0)
    s_barrier
    s_cmp_eq_u32 s16, 3
    s_cbranch_scc1 L_w3
    ds_read_b128 v[132:135], v19 offset:0
    ds_read_b128 v[136:139], v19 offset:64
    ds_read_b128 v[140:143], v19 offset:128
    s_cmp_lg_u32 s16, 0
    s_cbranch_scc1 L_sc_x
    ds_read_b128 v[120:123], v20 offset:0
    ds_read_b128 v[124:127], v20 offset:64
    ds_read_b128 v[128:131], v20 offset:128
L_sc_x:
    s_lshl_b32 s29, s16, 9
    v_add_u32 v4, s29, v21
    s_waitcnt lgkmcnt(0)
    v_mfma_f32_16x16x32_bf16 v[8:11], v[120:123], v[132:135], 0
    v_mfma_f32_16x16x32_bf16 v[8:11], v[124:127], v[136:139], v[8:11]
    v_mfma_f32_16x16x32_bf16 v[8:11], v[128:131], v[140:143], v[8:11]
    s_mov_b64 exec, s[44:45]
    s_nop 6
    v_and_or_b32 v8, v8, -2, s26
    v_and_or_b32 v9, v9, -2, s26
    v_and_or_b32 v10, v10, -2, s26
    v_and_or_b32 v11, v11, -2, s26
    buffer_store_dwordx4 v[8:11], v21, s[4:7], s48 offen
    ds_write_b128 v4, v[8:11] offset:0
    s_mov_b64 exec, -1
    s_cmp_eq_u32 s16, 0
    s_cbranch_scc1 L_w0
    s_waitcnt lgkmcnt(0)
    ds_read_b128 v[120:123], v20 offset:14336
    ds_read_b128 v[124:127], v20 offset:15360
    ds_read_b128 v[128:131], v20 offset:24576
    ds_read_b128 v[132:135], v20 offset:25600
    ds_read_b128 v[136:139], v20 offset:26624
    ds_read_b128 v[140:143], v20 offset:27648
    s_waitcnt lgkmcnt(10)
    v_smfmac_f32_16x16x64_bf16 v[144:147], v[32:35], v[96:103], v16
    ds_read_b128 v[96:99], v20 offset:36864
    ds_read_b128 v[100:103], v20 offset:37888
    s_waitcnt lgkmcnt(10)
    v_smfmac_f32_16x16x64_bf16 v[148:151], v[32:35], v[104:111], v16
    ds_read_b128 v[104:107], v20 offset:38912
    ds_read_b128 v[108:111], v20 offset:39936
    s_waitcnt lgkmcnt(10)
    v_smfmac_f32_16x16x64_bf16 v[144:147], v[36:39], v[112:119], v16
    ds_read_b128 v[112:115], v20 offset:49152
    ds_read_b128 v[116:119], v20 offset:50176
    s_waitcnt lgkmcnt(10)
    v_smfmac_f32_16x16x64_bf16 v[148:151], v[36:39], v[120:127], v16
    ds_read_b128 v[120:123], v20 offset:51200
    ds_read_b128 v[124:127], v20 offset:52224
    s_waitcnt lgkmcnt(10)
    v_smfmac_f32_16x16x64_bf16 v[144:147], v[40:43], v[128:135], v16
    v_add_u32 v20, 61440, v20
    ds_read_b128 v[128:131], v20 offset:0
    ds_read_b128 v[132:135], v20 offset:1024
    s_waitcnt lgkmcnt(10)
    v_smfmac_f32_16x16x64_bf16 v[148:151], v[40:43], v[136:143], v16
    ds_read_b128 v[136:139], v20 offset:2048
    ds_read_b128 v[140:143], v20 offset:3072
    s_waitcnt lgkmcnt(10)
    v_smfmac_f32_16x16x64_bf16 v[144:147], v[44:47], v[96:103], v16
    ds_read_b128 v[96:99], v20 offset:12288
    ds_read_b128 v[100:103], v20 offset:13312
    s_waitcnt lgkmcnt(10)
    v_smfmac_f32_16x16x64_bf16 v[148:151], v[44:47], v[104:111], v16
    ds_read_b128 v[104:107], v20 offset:14336
    ds_read_b128 v[108:111], v20 offset:15360
    s_waitcnt lgkmcnt(10)
    v_smfmac_f32_16x16x64_bf16 v[144:147], v[48:51], v[112:119], v16
    ds_read_b128 v[112:115], v20 offset:24576
    ds_read_b128 v[116:119], v20 offset:25600
    s_waitcnt lgkmcnt(10)
    v_smfmac_f32_16x16x64_bf16 v[148:151], v[48:51], v[120:127], v16
    ds_read_b128 v[120:123], v20 offset:26624
    ds_read_b128 v[124:127], v20 offset:27648
    s_waitcnt lgkmcnt(10)
    v_smfmac_f32_16x16x64_bf16 v[144:147], v[52:55], v[128:135], v16
    ds_read_b128 v[128:131], v20 offset:36864
    ds_read_b128 v[132:135], v20 offset:37888
    s_waitcnt lgkmcnt(10)
    v_smfmac_f32_16x16x64_bf16 v[148:151], v[52:55], v[136:143], v16
    ds_read_b128 v[136:139], v20 offset:38912
    ds_read_b128 v[140:143], v20 offset:39936
    s_waitcnt lgkmcnt(10)
    v_smfmac_f32_16x16x64_bf16 v[144:147], v[56:59], v[96:103], v16
    ds_read_b128 v[96:99], v20 offset:49152
    ds_read_b128 v[100:103], v20 offset:50176
    s_waitcnt lgkmcnt(10)
    v_smfmac_f32_16x16x64_bf16 v[148:151], v[56:59], v[104:111], v16
    ds_read_b128 v[104:107], v20 offset:51200
    ds_read_b128 v[108:111], v20 offset:52224
    v_subrev_u32 v20, 61440, v20
    s_waitcnt lgkmcnt(10)
    v_smfmac_f32_16x16x64_bf16 v[144:147], v[60:63], v[112:119], v16
    s_waitcnt lgkmcnt(8)
    v_smfmac_f32_16x16x64_bf16 v[148:151], v[60:63], v[120:127], v16
    s_waitcnt lgkmcnt(6)
    v_smfmac_f32_16x16x64_bf16 v[144:147], v[64:67], v[128:135], v16
    s_waitcnt lgkmcnt(4)
    v_smfmac_f32_16x16x64_bf16 v[148:151], v[64:67], v[136:143], v16
    s_waitcnt lgkmcnt(2)
    v_smfmac_f32_16x16x64_bf16 v[144:147], v[68:71], v[96:103], v16
    s_waitcnt lgkmcnt(0)
    v_smfmac_f32_16x16x64_bf16 v[148:151], v[68:71], v[104:111], v16
    s_nop 7
    v_add_f32 v144, v144, v145
    v_add_f32 v146, v146, v147
    v_cvt_pk_bf16_f32 v4, v144, v146
    ds_write_b32 v22, v4 offset:38976
    v_add_f32 v148, v148, v149
    v_add_f32 v150, v150, v151
    v_cvt_pk_bf16_f32 v5, v148, v150
    ds_write_b32 v22, v5 offset:38984
    s_branch L_b2p
L_w3:
    ds_read_b128 v[120:123], v20 offset:14336
    ds_read_b128 v[124:127], v20 offset:15360
    ds_read_b128 v[128:131], v20 offset:24576
    ds_read_b128 v[132:135], v20 offset:25600
    ds_read_b128 v[136:139], v20 offset:26624
    ds_read_b128 v[140:143], v20 offset:27648
    s_waitcnt lgkmcnt(10)
    v_smfmac_f32_16x16x64_bf16 v[144:147], v[32:35], v[96:103], v16
    ds_read_b128 v[96:99], v20 offset:36864
    ds_read_b128 v[100:103], v20 offset:37888
    s_waitcnt lgkmcnt(10)
    v_smfmac_f32_16x16x64_bf16 v[148:151], v[32:35], v[104:111], v16
    ds_read_b128 v[104:107], v20 offset:38912
    ds_read_b128 v[108:111], v20 offset:39936
    s_waitcnt lgkmcnt(10)
    v_smfmac_f32_16x16x64_bf16 v[144:147], v[36:39], v[112:119], v16
    ds_read_b128 v[112:115], v20 offset:49152
    ds_read_b128 v[116:119], v20 offset:50176
    s_waitcnt lgkmcnt(10)
    v_smfmac_f32_16x16x64_bf16 v[148:151], v[36:39], v[120:127], v16
    ds_read_b128 v[120:123], v20 offset:51200
    ds_read_b128 v[124:127], v20 offset:52224
    s_waitcnt lgkmcnt(10)
    v_smfmac_f32_16x16x64_bf16 v[144:147], v[40:43], v[128:135], v16
    v_add_u32 v20, 61440, v20
    ds_read_b128 v[128:131], v20 offset:0
    ds_read_b128 v[132:135], v20 offset:1024
    s_waitcnt lgkmcnt(10)
    v_smfmac_f32_16x16x64_bf16 v[148:151], v[40:43], v[136:143], v16
    ds_read_b128 v[136:139], v20 offset:2048
    ds_read_b128 v[140:143], v20 offset:3072
    s_waitcnt lgkmcnt(10)
    v_smfmac_f32_16x16x64_bf16 v[144:147], v[44:47], v[96:103], v16
    ds_read_b128 v[96:99], v20 offset:12288
    ds_read_b128 v[100:103], v20 offset:13312
    s_waitcnt lgkmcnt(10)
    v_smfmac_f32_16x16x64_bf16 v[148:151], v[44:47], v[104:111], v16
    ds_read_b128 v[104:107], v20 offset:14336
    ds_read_b128 v[108:111], v20 offset:15360
    s_waitcnt lgkmcnt(10)
    v_smfmac_f32_16x16x64_bf16 v[144:147], v[48:51], v[112:119], v16
    ds_read_b128 v[112:115], v20 offset:24576
    ds_read_b128 v[116:119], v20 offset:25600
    s_waitcnt lgkmcnt(10)
    v_smfmac_f32_16x16x64_bf16 v[148:151], v[48:51], v[120:127], v16
    ds_read_b128 v[120:123], v20 offset:26624
    ds_read_b128 v[124:127], v20 offset:27648
    s_waitcnt lgkmcnt(10)
    v_smfmac_f32_16x16x64_bf16 v[144:147], v[52:55], v[128:135], v16
    ds_read_b128 v[128:131], v20 offset:36864
    ds_read_b128 v[132:135], v20 offset:37888
    s_waitcnt lgkmcnt(10)
    v_smfmac_f32_16x16x64_bf16 v[148:151], v[52:55], v[136:143], v16
    ds_read_b128 v[136:139], v20 offset:38912
    ds_read_b128 v[140:143], v20 offset:39936
    s_waitcnt lgkmcnt(10)
    v_smfmac_f32_16x16x64_bf16 v[144:147], v[56:59], v[96:103], v16
    ds_read_b128 v[96:99], v20 offset:49152
    ds_read_b128 v[100:103], v20 offset:50176
    s_waitcnt lgkmcnt(10)
    v_smfmac_f32_16x16x64_bf16 v[148:151], v[56:59], v[104:111], v16
    ds_read_b128 v[104:107], v20 offset:51200
    ds_read_b128 v[108:111], v20 offset:52224
    v_subrev_u32 v20, 61440, v20
    s_waitcnt lgkmcnt(10)
    v_smfmac_f32_16x16x64_bf16 v[144:147], v[60:63], v[112:119], v16
    s_waitcnt lgkmcnt(8)
    v_smfmac_f32_16x16x64_bf16 v[148:151], v[60:63], v[120:127], v16
    s_waitcnt lgkmcnt(6)
    v_smfmac_f32_16x16x64_bf16 v[144:147], v[64:67], v[128:135], v16
    s_waitcnt lgkmcnt(4)
    v_smfmac_f32_16x16x64_bf16 v[148:151], v[64:67], v[136:143], v16
    s_waitcnt lgkmcnt(2)
    v_smfmac_f32_16x16x64_bf16 v[144:147], v[68:71], v[96:103], v16
    s_waitcnt lgkmcnt(0)
    v_smfmac_f32_16x16x64_bf16 v[148:151], v[68:71], v[104:111], v16
    s_nop 7
    v_add_f32 v144, v144, v145
    v_add_f32 v146, v146, v147
    v_cvt_pk_bf16_f32 v4, v144, v146
    ds_write_b32 v22, v4 offset:38976
    v_add_f32 v148, v148, v149
    v_add_f32 v150, v150, v151
    v_cvt_pk_bf16_f32 v5, v148, v150
    ds_write_b32 v22, v5 offset:38984
    s_branch L_b2p
L_w0:
    s_cmp_eq_u32 s24, 63
    s_cbranch_scc1 L_b2p
    v_pk_add_f32 v[8:9], v[8:9], v[2:3] op_sel_hi:[1,0]
    v_pk_add_f32 v[10:11], v[10:11], v[2:3] op_sel_hi:[1,0]
    s_sleep 2
L_pa:
    buffer_load_dwordx4 v[32:35], v21, s[4:7], s49 offen offset:0 sc1
    buffer_load_dwordx4 v[36:39], v21, s[4:7], s49 offen offset:512 sc1
    buffer_load_dwordx4 v[40:43], v21, s[4:7], s49 offen offset:1024 sc1
    s_waitcnt vmcnt(0)
    s_cmp_eq_u32 s26, 0
    s_cbranch_scc1 L_31
    v_bitop3_b32 v4, v32, v33, v34 bitop3:0x80
    v_bitop3_b32 v4, v4, v35, v36 bitop3:0x80
    v_bitop3_b32 v4, v4, v37, v38 bitop3:0x80
    v_bitop3_b32 v4, v4, v39, v40 bitop3:0x80
    v_bitop3_b32 v4, v4, v41, v42 bitop3:0x80
    v_bitop3_b32 v4, v4, v43, v43 bitop3:0x80
    v_and_b32 v4, 1, v4
    v_cmp_ne_u32 vcc, 1, v4
    s_cbranch_vccnz L_spin_30
    s_branch L_32
L_31:
    v_or3_b32 v4, v32, v33, v34
    v_or3_b32 v4, v4, v35, v36
    v_or3_b32 v4, v4, v37, v38
    v_or3_b32 v4, v4, v39, v40
    v_or3_b32 v4, v4, v41, v42
    v_or3_b32 v4, v4, v43, v43
    v_and_b32 v4, 1, v4
    v_cmp_ne_u32 vcc, 0, v4
    s_cbranch_vccnz L_spin_30
L_32:
    v_pk_add_f32 v[32:33], v[32:33], v[8:9]
    v_pk_add_f32 v[34:35], v[34:35], v[10:11]
    s_mov_b64 exec, s[44:45]
    ds_write_b128 v21, v[36:39] offset:2560
    ds_write_b128 v21, v[40:43] offset:3072
    ds_write_b128 v21, v[32:35] offset:2048
    s_mov_b64 exec, -1
L_b2p:
    v_mov_b32 v132, 0
    v_mov_b32 v133, 0
    v_mov_b32 v134, 0
    v_mov_b32 v135, 0
    v_mov_b32 v136, 0
    v_mov_b32 v137, 0
    v_mov_b32 v138, 0
    v_mov_b32 v139, 0
    v_mov_b32 v140, 0
    v_mov_b32 v141, 0
    v_mov_b32 v142, 0
    v_mov_b32 v143, 0
    v_mov_b32 v144, 0
    v_mov_b32 v145, 0
    v_mov_b32 v146, 0
    v_mov_b32 v147, 0
    v_mov_b32 v148, 0
    v_mov_b32 v149, 0
    v_mov_b32 v150, 0
    v_mov_b32 v151, 0
    s_waitcnt lgkmcnt(0)
    s_barrier
    ds_read_b128 v[48:51], v21 offset:512
    ds_read_b128 v[36:39], v21 offset:2560
    ds_read_b128 v[52:55], v21 offset:1024
    ds_read_b128 v[40:43], v21 offset:3072
    ds_read_b128 v[44:47], v21 offset:2048
    ds_read_b128 v[60:63], v27 offset:0
    ds_read_b128 v[64:67], v27 offset:512
    ds_read_b128 v[68:71], v27 offset:1024
    s_cmp_eq_u32 s24, 63
    s_cbranch_scc1 L_ch_done
    s_mov_b32 m0, s41
    s_nop 0
    buffer_load_dwordx4 v3, s[4:7], s35 offen sc1 lds
    s_mov_b32 exec_hi, 0
    buffer_load_dwordx4 v3, s[4:7], s35 offen offset:1024 sc1 lds
    s_mov_b32 exec_hi, -1
    s_add_u32 s35, s35, 12288
    s_waitcnt lgkmcnt(6)
    v_pk_add_f32 v[48:49], v[48:49], v[36:37]
    v_pk_add_f32 v[50:51], v[50:51], v[38:39]
    s_waitcnt lgkmcnt(4)
    v_pk_add_f32 v[52:53], v[52:53], v[40:41]
    v_pk_add_f32 v[54:55], v[54:55], v[42:43]
    v_max3_f32 v4, v48, v49, v50
    v_max3_f32 v5, v51, v52, v53
    v_max3_f32 v4, v4, v54, v55
    s_waitcnt lgkmcnt(3)
    v_max3_f32 v5, v5, v44, v45
    v_max3_f32 v4, v4, v46, v47
    v_max_f32 v6, v4, v5
    v_max_f32 v4, v4, v5
    s_nop 1
    v_permlane32_swap_b32 v4, v6
    v_max_f32 v5, v4, v6
    v_max_f32 v4, v4, v6
    s_nop 1
    v_permlane16_swap_b32 v4, v5
    v_max_f32 v4, v4, v5
    v_mul_f32 v4, s38, v4
    v_pk_fma_f32 v[48:49], v[48:49], s[38:39], v[4:5] op_sel_hi:[1,0,0] neg_lo:[0,0,1] neg_hi:[0,0,1]
    v_pk_fma_f32 v[50:51], v[50:51], s[38:39], v[4:5] op_sel_hi:[1,0,0] neg_lo:[0,0,1] neg_hi:[0,0,1]
    v_pk_fma_f32 v[52:53], v[52:53], s[38:39], v[4:5] op_sel_hi:[1,0,0] neg_lo:[0,0,1] neg_hi:[0,0,1]
    v_pk_fma_f32 v[54:55], v[54:55], s[38:39], v[4:5] op_sel_hi:[1,0,0] neg_lo:[0,0,1] neg_hi:[0,0,1]
    v_exp_f32 v48, v48
    v_exp_f32 v49, v49
    v_exp_f32 v50, v50
    v_exp_f32 v51, v51
    v_exp_f32 v52, v52
    v_exp_f32 v53, v53
    v_exp_f32 v54, v54
    v_exp_f32 v55, v55
    v_pk_fma_f32 v[44:45], v[44:45], s[38:39], v[4:5] op_sel_hi:[1,0,0] neg_lo:[0,0,1] neg_hi:[0,0,1]
    v_pk_fma_f32 v[46:47], v[46:47], s[38:39], v[4:5] op_sel_hi:[1,0,0] neg_lo:[0,0,1] neg_hi:[0,0,1]
    v_cvt_pk_bf16_f32 v56, v48, v49
    v_cvt_pk_bf16_f32 v57, v50, v51
    v_cvt_pk_bf16_f32 v58, v52, v53
    v_cvt_pk_bf16_f32 v59, v54, v55
    v_exp_f32 v44, v44
    v_exp_f32 v45, v45
    v_mfma_f32_16x16x32_bf16 v[96:99], v[72:75], v[56:59], 0
    v_exp_f32 v46, v46
    v_exp_f32 v47, v47
    v_mfma_f32_16x16x32_bf16 v[100:103], v[76:79], v[56:59], 0
    v_pk_add_f32 v[48:49], v[48:49], v[50:51]
    v_pk_add_f32 v[52:53], v[52:53], v[54:55]
    v_cvt_pk_bf16_f32 v8, v44, v45
    v_mfma_f32_16x16x32_bf16 v[104:107], v[80:83], v[56:59], 0
    v_cvt_pk_bf16_f32 v9, v46, v47
    v_pk_add_f32 v[44:45], v[44:45], v[46:47]
    v_pk_add_f32 v[48:49], v[48:49], v[52:53]
    v_mfma_f32_16x16x32_bf16 v[108:111], v[84:87], v[56:59], 0
    v_pk_add_f32 v[44:45], v[44:45], v[48:49]
    v_add_f32 v4, v44, v45
    v_add_f32 v5, v44, v45
    s_nop 0
    v_mfma_f32_16x16x32_bf16 v[112:115], v[88:91], v[56:59], 0
    v_permlane32_swap_b32 v4, v5
    v_add_f32 v6, v4, v5
    v_add_f32 v4, v4, v5
    s_nop 0
    v_mfma_f32_16x16x32_bf16 v[116:119], v[92:95], v[56:59], 0
    v_permlane16_swap_b32 v4, v6
    v_add_f32 v4, v4, v6
    v_rcp_f32 v44, v4
    s_waitcnt lgkmcnt(0)
    v_mfma_f32_16x16x16_bf16 v[96:99], v[60:61], v[8:9], v[96:99]
    v_mfma_f32_16x16x16_bf16 v[100:103], v[62:63], v[8:9], v[100:103]
    v_mfma_f32_16x16x16_bf16 v[104:107], v[64:65], v[8:9], v[104:107]
    v_mfma_f32_16x16x16_bf16 v[108:111], v[66:67], v[8:9], v[108:111]
    v_mfma_f32_16x16x16_bf16 v[112:115], v[68:69], v[8:9], v[112:115]
    v_mfma_f32_16x16x16_bf16 v[116:119], v[70:71], v[8:9], v[116:119]
    s_nop 2
    v_pk_mul_f32 v[96:97], v[96:97], v[44:45] op_sel_hi:[1,0]
    v_cvt_pk_bf16_f32 v60, v96, v97
    v_pk_mul_f32 v[98:99], v[98:99], v[44:45] op_sel_hi:[1,0]
    v_cvt_pk_bf16_f32 v61, v98, v99
    v_pk_mul_f32 v[100:101], v[100:101], v[44:45] op_sel_hi:[1,0]
    v_cvt_pk_bf16_f32 v62, v100, v101
    v_pk_mul_f32 v[102:103], v[102:103], v[44:45] op_sel_hi:[1,0]
    v_cvt_pk_bf16_f32 v63, v102, v103
    v_pk_mul_f32 v[104:105], v[104:105], v[44:45] op_sel_hi:[1,0]
    v_cvt_pk_bf16_f32 v64, v104, v105
    v_pk_mul_f32 v[106:107], v[106:107], v[44:45] op_sel_hi:[1,0]
    v_cvt_pk_bf16_f32 v65, v106, v107
    v_smfmac_f32_16x16x64_bf16 v[132:135], v[60:63], a[240:247], v17
    v_pk_mul_f32 v[108:109], v[108:109], v[44:45] op_sel_hi:[1,0]
    v_cvt_pk_bf16_f32 v66, v108, v109
    v_pk_mul_f32 v[110:111], v[110:111], v[44:45] op_sel_hi:[1,0]
    v_cvt_pk_bf16_f32 v67, v110, v111
    v_smfmac_f32_16x16x64_bf16 v[136:139], v[60:63], v[160:167], v17
    v_pk_mul_f32 v[112:113], v[112:113], v[44:45] op_sel_hi:[1,0]
    v_cvt_pk_bf16_f32 v68, v112, v113
    v_pk_mul_f32 v[114:115], v[114:115], v[44:45] op_sel_hi:[1,0]
    v_cvt_pk_bf16_f32 v69, v114, v115
    v_smfmac_f32_16x16x64_bf16 v[140:143], v[60:63], v[184:191], v17
    v_pk_mul_f32 v[116:117], v[116:117], v[44:45] op_sel_hi:[1,0]
    v_cvt_pk_bf16_f32 v70, v116, v117
    v_pk_mul_f32 v[118:119], v[118:119], v[44:45] op_sel_hi:[1,0]
    v_cvt_pk_bf16_f32 v71, v118, v119
    v_smfmac_f32_16x16x64_bf16 v[144:147], v[60:63], v[208:215], v17
    v_smfmac_f32_16x16x64_bf16 v[132:135], v[64:67], a[248:255], v17
    s_add_u32 s48, s48, s46
    s_add_u32 s49, s49, s46
    v_smfmac_f32_16x16x64_bf16 v[136:139], v[64:67], v[168:175], v17
    v_smfmac_f32_16x16x64_bf16 v[140:143], v[64:67], v[192:199], v17
    v_smfmac_f32_16x16x64_bf16 v[144:147], v[64:67], v[216:223], v17
    v_smfmac_f32_16x16x64_bf16 v[132:135], v[68:71], v[152:159], v17
    v_smfmac_f32_16x16x64_bf16 v[136:139], v[68:71], v[176:183], v17
    v_smfmac_f32_16x16x64_bf16 v[140:143], v[68:71], v[200:207], v17
    v_smfmac_f32_16x16x64_bf16 v[144:147], v[68:71], v[224:231], v17
    v_smfmac_f32_16x16x64_bf16 v[148:151], v[60:63], v[232:239], v17
    v_smfmac_f32_16x16x64_bf16 v[148:151], v[64:67], v[240:247], v17
    v_smfmac_f32_16x16x64_bf16 v[148:151], v[68:71], v[248:255], v17
    s_nop 1
    v_cvt_pk_bf16_f32 v96, v132, v133
    v_cvt_pk_bf16_f32 v100, v134, v135
    v_cvt_pk_bf16_f32 v97, v136, v137
    v_cvt_pk_bf16_f32 v101, v138, v139
    v_cvt_pk_bf16_f32 v98, v140, v141
    v_cvt_pk_bf16_f32 v102, v142, v143
    v_cvt_pk_bf16_f32 v99, v144, v145
    v_cvt_pk_bf16_f32 v103, v146, v147
    v_and_or_b32 v96, v96, -2, s26
    v_and_or_b32 v98, v98, -2, s26
    v_and_or_b32 v100, v100, -2, s26
    v_and_or_b32 v102, v102, -2, s26
    buffer_store_dwordx4 v[96:99], v23, s[4:7], s50 offen
    buffer_store_dwordx4 v[100:103], v23, s[4:7], s50 offen offset:256
    v_cvt_pk_bf16_f32 v104, v148, v149
    v_cvt_pk_bf16_f32 v105, v150, v151
    v_and_or_b32 v104, v104, -2, s26
    buffer_store_dwordx2 v[104:105], v24, s[4:7], s51 offen
    s_cmp_ge_u32 s33, 80
    s_cbranch_scc1 L_nored
    s_sleep 7
    buffer_load_dwordx4 v[72:75], v25, s[4:7], s52 offen sc1
    buffer_load_dwordx4 v[76:79], v25, s[4:7], s53 offen sc1
    buffer_load_dwordx4 v[80:83], v25, s[4:7], s54 offen sc1
    buffer_load_dwordx4 v[84:87], v25, s[4:7], s55 offen sc1
    s_sleep 2
L_pb0:
    buffer_load_dwordx4 v[32:35], v25, s[4:7], s52 offen sc1
    buffer_load_dwordx4 v[36:39], v25, s[4:7], s53 offen sc1
    buffer_load_dwordx4 v[40:43], v25, s[4:7], s54 offen sc1
    buffer_load_dwordx4 v[44:47], v25, s[4:7], s55 offen sc1
    s_waitcnt vmcnt(4)
    v_mfma_f32_16x16x32_bf16 v[120:123], v[12:15], v[72:75], 0
    v_mfma_f32_16x16x32_bf16 v[120:123], v[12:15], v[76:79], v[120:123]
    v_mfma_f32_16x16x32_bf16 v[120:123], v[12:15], v[80:83], v[120:123]
    v_mfma_f32_16x16x32_bf16 v[120:123], v[12:15], v[84:87], v[120:123]
    s_cmp_eq_u32 s26, 0
    s_cbranch_scc1 L_34
    v_bitop3_b32 v5, v72, v74, v76 bitop3:0x80
    v_bitop3_b32 v5, v5, v78, v80 bitop3:0x80
    v_bitop3_b32 v5, v5, v82, v84 bitop3:0x80
    v_bitop3_b32 v5, v5, v86, v86 bitop3:0x80
    v_and_b32 v5, 1, v5
    v_cmp_ne_u32 vcc, 1, v5
    s_cbranch_vccnz L_spin_33
    s_branch L_35
L_34:
    v_or3_b32 v5, v72, v74, v76
    v_or3_b32 v5, v5, v78, v80
    v_or3_b32 v5, v5, v82, v84
    v_or3_b32 v5, v5, v86, v86
    v_and_b32 v5, 1, v5
    v_cmp_ne_u32 vcc, 0, v5
    s_cbranch_vccnz L_spin_33
L_35:
    s_branch L_pbok
L_pb1:
    buffer_load_dwordx4 v[72:75], v25, s[4:7], s52 offen sc1
    buffer_load_dwordx4 v[76:79], v25, s[4:7], s53 offen sc1
    buffer_load_dwordx4 v[80:83], v25, s[4:7], s54 offen sc1
    buffer_load_dwordx4 v[84:87], v25, s[4:7], s55 offen sc1
    s_waitcnt vmcnt(4)
    v_mfma_f32_16x16x32_bf16 v[120:123], v[12:15], v[32:35], 0
    v_mfma_f32_16x16x32_bf16 v[120:123], v[12:15], v[36:39], v[120:123]
    v_mfma_f32_16x16x32_bf16 v[120:123], v[12:15], v[40:43], v[120:123]
    v_mfma_f32_16x16x32_bf16 v[120:123], v[12:15], v[44:47], v[120:123]
    s_cmp_eq_u32 s26, 0
    s_cbranch_scc1 L_37
    v_bitop3_b32 v5, v32, v34, v36 bitop3:0x80
    v_bitop3_b32 v5, v5, v38, v40 bitop3:0x80
    v_bitop3_b32 v5, v5, v42, v44 bitop3:0x80
    v_bitop3_b32 v5, v5, v46, v46 bitop3:0x80
    v_and_b32 v5, 1, v5
    v_cmp_ne_u32 vcc, 1, v5
    s_cbranch_vccnz L_spin_36
    s_branch L_38
L_37:
    v_or3_b32 v5, v32, v34, v36
    v_or3_b32 v5, v5, v38, v40
    v_or3_b32 v5, v5, v42, v44
    v_or3_b32 v5, v5, v46, v46
    v_and_b32 v5, 1, v5
    v_cmp_ne_u32 vcc, 0, v5
    s_cbranch_vccnz L_spin_36
L_38:
L_pbok:
    v_add_f32_dpp v124, v120, v120 row_ror:8 row_mask:0xf bank_mask:0xf
    v_add_f32_dpp v125, v121, v121 row_ror:8 row_mask:0xf bank_mask:0xf
    v_add_f32_dpp v126, v122, v122 row_ror:8 row_mask:0xf bank_mask:0xf
    v_add_f32_dpp v127, v123, v123 row_ror:8 row_mask:0xf bank_mask:0xf
    s_mov_b64 exec, 0x00ff00ff
    v_cvt_pk_bf16_f32 v128, v124, v125
    v_cvt_pk_bf16_f32 v129, v126, v127
    v_and_or_b32 v128, v128, -2, s26
    buffer_store_dwordx2 v[128:129], v26, s[4:7], s57 offen sc1
    buffer_store_dwordx2 v[128:129], v26, s[4:7], s56 offen
    s_mov_b64 exec, -1
    s_sleep 10
    s_branch L_pc0
L_nored:
    s_cmp_lg_u32 s16, 3
    s_cbranch_scc1 L_39
    s_sleep 22
    v_and_b32 v4, 7, v0
    v_lshrrev_b32 v5, 4, v0
    v_mul_u32_u24 v6, 224, v4
    v_lshl_add_u32 v6, v5, 4, v6
    ds_read_b128 v[120:123], v6 offset:12544
    ds_read_b128 v[124:127], v6 offset:12608
    ds_read_b128 v[128:131], v6 offset:12672
    ds_read_b128 v[72:75], v27 offset:0
    ds_read_b128 v[76:79], v27 offset:512
    ds_read_b128 v[80:83], v27 offset:1024
    v_lshlrev_b32 v4, 4, v4
    v_lshl_add_u32 v4, v5, 7, v4
    s_mov_b32 exec_lo, 0x00ff00ff
    s_mov_b32 exec_hi, 0x00ff00ff
    s_waitcnt lgkmcnt(3)
    buffer_store_dwordx4 v[120:123], v4, s[4:7], s36 offen offset:0 sc1
    buffer_store_dwordx4 v[124:127], v4, s[4:7], s36 offen offset:512 sc1
    buffer_store_dwordx4 v[128:131], v4, s[4:7], s36 offen offset:1024 sc1
    s_mov_b32 exec_lo, -1
    s_mov_b32 exec_hi, 0
    s_waitcnt lgkmcnt(0)
    buffer_store_dwordx4 v[72:75], v3, s[4:7], s37 offen offset:0 sc1
    buffer_store_dwordx4 v[76:79], v3, s[4:7], s37 offen offset:512 sc1
    buffer_store_dwordx4 v[80:83], v3, s[4:7], s37 offen offset:1024 sc1
    v_mov_b32 v6, 0
    v_mov_b32 v7, s24
    s_mov_b64 exec, 1
    buffer_store_dword v7, v6, s[4:7], s28 offen sc1
    s_mov_b64 exec, -1
    s_add_u32 s36, s36, 3072
    s_add_u32 s37, s37, 3072
    s_add_u32 s40, s24, 4
    s_min_u32 s40, s40, 64
    s_cmp_ge_u32 s43, s40
    s_cbranch_scc1 L_40
    v_lshlrev_b32 v6, 7, v0
    s_cmp_ge_u32 s43, s40
    s_cbranch_scc1 L_42
    s_mov_b64 exec, 3
L_41:
    buffer_load_dword v7, v6, s[4:7], s42 offen sc1
    s_waitcnt vmcnt(0)
    v_cmp_gt_u32 vcc, s40, v7
    s_cbranch_vccz L_43
    s_sleep 4
    s_branch L_spin_44
L_43:
    v_readlane_b32 s43, v7, 0
    v_readlane_b32 s29, v7, 1
    s_nop 3
    s_min_u32 s43, s43, s29
    s_mov_b64 exec, -1
L_42:
L_40:
    s_branch L_pc0
L_39:
    s_sleep 26
L_pc0:
    s_add_u32 s50, s50, s46
    s_add_u32 s51, s51, s46
    s_add_u32 s52, s52, s46
    s_add_u32 s53, s53, s46
    s_add_u32 s54, s54, s46
    s_add_u32 s55, s55, s46
    s_add_u32 s56, s56, s46
    s_add_u32 s57, s57, 20480
    v_mov_b32 v132, 0
    v_mov_b32 v133, 0
    v_mov_b32 v134, 0
    v_mov_b32 v135, 0
    v_mov_b32 v136, 0
    v_mov_b32 v137, 0
    v_mov_b32 v138, 0
    v_mov_b32 v139, 0
    v_mov_b32 v140, 0
    v_mov_b32 v141, 0
    v_mov_b32 v142, 0
    v_mov_b32 v143, 0
    v_mov_b32 v144, 0
    v_mov_b32 v145, 0
    v_mov_b32 v146, 0
    v_mov_b32 v147, 0
    v_mov_b32 v148, 0
    v_mov_b32 v149, 0
    v_mov_b32 v150, 0
    v_mov_b32 v151, 0
L_pc:
    buffer_load_dwordx4 v[96:99], v23, s[4:7], s58 offen offset:0 sc1
    buffer_load_dwordx4 v[100:103], v23, s[4:7], s58 offen offset:256 sc1
    buffer_load_dwordx2 v[104:105], v24, s[4:7], s59 offen sc1
    s_waitcnt vmcnt(0)
L_pc1:
    s_cmp_eq_u32 s26, 0
    s_cbranch_scc1 L_46
    v_bitop3_b32 v5, v96, v98, v100 bitop3:0x80
    v_bitop3_b32 v5, v5, v102, v104 bitop3:0x80
    v_and_b32 v5, 1, v5
    v_cmp_ne_u32 vcc, 1, v5
    s_cbranch_vccnz L_spin_45
    s_branch L_47
L_46:
    v_or3_b32 v5, v96, v98, v100
    v_or3_b32 v5, v5, v102, v104
    v_and_b32 v5, 1, v5
    v_cmp_ne_u32 vcc, 0, v5
    s_cbranch_vccnz L_spin_45
L_47:
    buffer_load_dwordx4 v[108:111], v23, s[4:7], s60 offen offset:0 sc1
    buffer_load_dwordx4 v[112:115], v23, s[4:7], s60 offen offset:256 sc1
    buffer_load_dwordx2 v[116:117], v24, s[4:7], s61 offen sc1
    v_lshlrev_b32 v32, 16, v96
    v_and_b32 v33, 0xffff0000, v96
    v_lshlrev_b32 v34, 16, v97
    v_and_b32 v35, 0xffff0000, v97
    v_lshlrev_b32 v36, 16, v98
    v_and_b32 v37, 0xffff0000, v98
    v_lshlrev_b32 v38, 16, v99
    v_and_b32 v39, 0xffff0000, v99
    v_lshlrev_b32 v40, 16, v100
    v_and_b32 v41, 0xffff0000, v100
    v_lshlrev_b32 v42, 16, v101
    v_and_b32 v43, 0xffff0000, v101
    v_lshlrev_b32 v44, 16, v102
    v_and_b32 v45, 0xffff0000, v102
    v_lshlrev_b32 v46, 16, v103
    v_and_b32 v47, 0xffff0000, v103
    v_lshlrev_b32 v48, 16, v104
    v_and_b32 v49, 0xffff0000, v104
    v_lshlrev_b32 v50, 16, v105
    v_and_b32 v51, 0xffff0000, v105
    s_add_u32 s58, s58, s46
    s_add_u32 s59, s59, s46
    s_add_u32 s24, s24, 1
    s_add_u32 s25, s25, 1
    s_cmp_eq_u32 s25, 3
    s_cselect_b32 s25, 0, s25
    s_branch L_pr1
L_pr:
    buffer_load_dwordx4 v[108:111], v23, s[4:7], s60 offen offset:0 sc1
    buffer_load_dwordx4 v[112:115], v23, s[4:7], s60 offen offset:256 sc1
    buffer_load_dwordx2 v[116:117], v24, s[4:7], s61 offen sc1
L_pr1:
    s_waitcnt vmcnt(0)
    s_cmp_eq_u32 s26, 0
    s_cbranch_scc1 L_49
    v_bitop3_b32 v5, v108, v110, v112 bitop3:0x80
    v_bitop3_b32 v5, v5, v114, v116 bitop3:0x80
    v_and_b32 v5, 1, v5
    v_cmp_ne_u32 vcc, 1, v5
    s_cbranch_vccnz L_spin_48
    s_branch L_50
L_49:
    v_or3_b32 v5, v108, v110, v112
    v_or3_b32 v5, v5, v114, v116
    v_and_b32 v5, 1, v5
    v_cmp_ne_u32 vcc, 0, v5
    s_cbranch_vccnz L_spin_48
L_50:
    v_dot2_f32_bf16 v32, v108, s62, v32
    v_dot2_f32_bf16 v33, v108, s63, v33
    v_dot2_f32_bf16 v34, v109, s62, v34
    v_dot2_f32_bf16 v35, v109, s63, v35
    v_dot2_f32_bf16 v36, v110, s62, v36
    v_dot2_f32_bf16 v37, v110, s63, v37
    v_dot2_f32_bf16 v38, v111, s62, v38
    v_dot2_f32_bf16 v39, v111, s63, v39
    v_dot2_f32_bf16 v40, v112, s62, v40
    v_dot2_f32_bf16 v41, v112, s63, v41
    v_dot2_f32_bf16 v42, v113, s62, v42
    v_dot2_f32_bf16 v43, v113, s63, v43
    v_dot2_f32_bf16 v44, v114, s62, v44
    v_dot2_f32_bf16 v45, v114, s63, v45
    v_dot2_f32_bf16 v46, v115, s62, v46
    v_dot2_f32_bf16 v47, v115, s63, v47
    v_dot2_f32_bf16 v48, v116, s62, v48
    v_dot2_f32_bf16 v49, v116, s63, v49
    v_dot2_f32_bf16 v50, v117, s62, v50
    v_dot2_f32_bf16 v51, v117, s63, v51
    v_cvt_pk_bf16_f32 v96, v32, v33
    v_cvt_pk_bf16_f32 v97, v34, v35
    v_cvt_pk_bf16_f32 v98, v36, v37
    v_cvt_pk_bf16_f32 v99, v38, v39
    ds_write_b128 v30, v[96:99]
    v_cvt_pk_bf16_f32 v100, v40, v41
    v_cvt_pk_bf16_f32 v101, v42, v43
    v_cvt_pk_bf16_f32 v102, v44, v45
    v_cvt_pk_bf16_f32 v103, v46, v47
    ds_write_b128 v30, v[100:103] offset:1344
    v_cvt_pk_bf16_f32 v104, v48, v49
    v_cvt_pk_bf16_f32 v105, v50, v51
    ds_write_b32 v31, v104
    ds_write_b32 v31, v105 offset:1344
    s_mov_b32 m0, s47
    s_xor_b32 s47, s47, 8192
    buffer_load_dwordx4 v3, s[4:7], s34 offen sc1 lds
    s_mov_b32 exec_hi, 0
    buffer_load_dwordx4 v3, s[4:7], s34 offen offset:1024 sc1 lds
    s_mov_b32 exec_hi, -1
    s_add_u32 s34, s34, 12288
    s_add_u32 s60, s60, 20480
    s_add_u32 s61, s61, 20480
    s_xor_b32 s26, s26, 1
    s_waitcnt lgkmcnt(0)
    s_branch L_step
.p2align 6
L_step_S:
    s_barrier
    ds_read_b128 v[32:35], v1 offset:0
    ds_read_b128 v[36:39], v1 offset:128
    ds_read_b128 v[40:43], v1 offset:256
    ds_read_b128 v[44:47], v1 offset:384
    ds_read_b128 v[48:51], v1 offset:512
    ds_read_b128 v[52:55], v1 offset:640
    ds_read_b128 v[56:59], v1 offset:768
    ds_read_b128 v[60:63], v1 offset:896
    ds_read_b128 v[64:67], v1 offset:1024
    ds_read_b128 v[68:71], v1 offset:1152
    s_cmp_eq_u32 s16, 2
    s_cbranch_scc1 L_28_S
    ds_read_b128 v[120:123], v28 offset:0
    ds_read_b128 v[124:127], v28 offset:1024
    ds_read_b64 v[128:129], v28 offset:4096
    ds_read_b64 v[130:131], v28 offset:5120
    s_branch L_29_S
L_28_S:
    ds_read_b128 v[120:123], v28 offset:2048
    ds_read_b128 v[124:127], v28 offset:3072
    ds_read_b64 v[128:129], v28 offset:4104
    ds_read_b64 v[130:131], v28 offset:5128
L_29_S:
    s_waitcnt lgkmcnt(13)
    v_smfmac_f32_16x16x64_bf16 v[132:135], v[32:35], a[0:7], v16
    v_smfmac_f32_16x16x64_bf16 v[136:139], v[32:35], a[80:87], v16
    v_smfmac_f32_16x16x64_bf16 v[140:143], v[32:35], a[160:167], v16
    s_waitcnt lgkmcnt(12)
    v_smfmac_f32_16x16x64_bf16 v[132:135], v[36:39], a[8:15], v16
    v_smfmac_f32_16x16x64_bf16 v[136:139], v[36:39], a[88:95], v16
    v_smfmac_f32_16x16x64_bf16 v[140:143], v[36:39], a[168:175], v16
    s_waitcnt lgkmcnt(11)
    v_smfmac_f32_16x16x64_bf16 v[132:135], v[40:43], a[16:23], v16
    v_smfmac_f32_16x16x64_bf16 v[136:139], v[40:43], a[96:103], v16
    v_smfmac_f32_16x16x64_bf16 v[140:143], v[40:43], a[176:183], v16
    s_waitcnt lgkmcnt(10)
    v_smfmac_f32_16x16x64_bf16 v[132:135], v[44:47], a[24:31], v16
    ds_read_b128 v[72:75], v3 offset:32768
    ds_read_b128 v[76:79], v3 offset:33792
    v_smfmac_f32_16x16x64_bf16 v[136:139], v[44:47], a[104:111], v16
    ds_read_b128 v[80:83], v3 offset:34816
    ds_read_b128 v[84:87], v3 offset:35840
    v_smfmac_f32_16x16x64_bf16 v[140:143], v[44:47], a[184:191], v16
    ds_read_b128 v[88:91], v3 offset:36864
    ds_read_b128 v[92:95], v3 offset:37888
    s_waitcnt lgkmcnt(15)
    v_smfmac_f32_16x16x64_bf16 v[132:135], v[48:51], a[32:39], v16
    v_smfmac_f32_16x16x64_bf16 v[136:139], v[48:51], a[112:119], v16
    v_smfmac_f32_16x16x64_bf16 v[140:143], v[48:51], a[192:199], v16
    s_waitcnt lgkmcnt(14)
    v_smfmac_f32_16x16x64_bf16 v[132:135], v[52:55], a[40:47], v16
    v_xor_b32 v28, 8192, v28
    v_smfmac_f32_16x16x64_bf16 v[136:139], v[52:55], a[120:127], v16
    v_smfmac_f32_16x16x64_bf16 v[140:143], v[52:55], a[200:207], v16
    s_waitcnt lgkmcnt(13)
    v_smfmac_f32_16x16x64_bf16 v[132:135], v[56:59], a[48:55], v16
    v_smfmac_f32_16x16x64_bf16 v[136:139], v[56:59], a[128:135], v16
    v_smfmac_f32_16x16x64_bf16 v[140:143], v[56:59], a[208:215], v16
    s_waitcnt lgkmcnt(12)
    v_smfmac_f32_16x16x64_bf16 v[132:135], v[60:63], a[56:63], v16
    v_smfmac_f32_16x16x64_bf16 v[136:139], v[60:63], a[136:143], v16
    v_smfmac_f32_16x16x64_bf16 v[140:143], v[60:63], a[216:223], v16
    s_waitcnt lgkmcnt(11)
    v_smfmac_f32_16x16x64_bf16 v[132:135], v[64:67], a[64:71], v16
    v_smfmac_f32_16x16x64_bf16 v[136:139], v[64:67], a[144:151], v16
    v_smfmac_f32_16x16x64_bf16 v[140:143], v[64:67], a[224:231], v16
    s_waitcnt lgkmcnt(10)
    v_smfmac_f32_16x16x64_bf16 v[132:135], v[68:71], a[72:79], v16
    ds_read_b128 v[96:99], v20 offset:0
    ds_read_b128 v[100:103], v20 offset:1024
    v_smfmac_f32_16x16x64_bf16 v[136:139], v[68:71], a[152:159], v16
    ds_read_b128 v[104:107], v20 offset:2048
    ds_read_b128 v[108:111], v20 offset:3072
    v_smfmac_f32_16x16x64_bf16 v[140:143], v[68:71], a[232:239], v16
    ds_read_b128 v[112:115], v20 offset:12288
    ds_read_b128 v[116:119], v20 offset:13312
    s_mov_b32 s29, 827392
    s_cmp_eq_u32 s25, 2
    s_cselect_b32 s46, 4293312512, s29
    v_add_f32 v132, v132, v133
    v_add_f32 v134, v134, v135
    v_cvt_pk_bf16_f32 v4, v132, v134
    ds_write_b16 v18, v4 offset:0
    ds_write_b16_d16_hi v18, v4 offset:224
    v_add_f32 v136, v136, v137
    v_add_f32 v138, v138, v139
    v_cvt_pk_bf16_f32 v5, v136, v138
    ds_write_b16 v18, v5 offset:32
    ds_write_b16_d16_hi v18, v5 offset:256
    s_nop 0
    v_add_f32 v140, v140, v141
    v_add_f32 v142, v142, v143
    v_cvt_pk_bf16_f32 v6, v140, v142
    ds_write_b16 v18, v6 offset:64
    ds_write_b16_d16_hi v18, v6 offset:288
    s_waitcnt lgkmcnt(0)
    s_barrier
    s_cmp_eq_u32 s16, 3
    s_cbranch_scc1 L_w3_S
    ds_read_b128 v[132:135], v19 offset:0
    ds_read_b128 v[136:139], v19 offset:64
    ds_read_b128 v[140:143], v19 offset:128
    s_cmp_lg_u32 s16, 0
    s_cbranch_scc1 L_sc_x_S
    ds_read_b128 v[120:123], v20 offset:0
    ds_read_b128 v[124:127], v20 offset:64
    ds_read_b128 v[128:131], v20 offset:128
L_sc_x_S:
    s_lshl_b32 s29, s16, 9
    v_add_u32 v4, s29, v21
    s_waitcnt lgkmcnt(0)
    v_mfma_f32_16x16x32_bf16 v[8:11], v[120:123], v[132:135], 0
    v_mfma_f32_16x16x32_bf16 v[8:11], v[124:127], v[136:139], v[8:11]
    v_mfma_f32_16x16x32_bf16 v[8:11], v[128:131], v[140:143], v[8:11]
    s_mov_b64 exec, s[44:45]
    s_nop 6
    v_and_or_b32 v8, v8, -2, s26
    v_and_or_b32 v9, v9, -2, s26
    v_and_or_b32 v10, v10, -2, s26
    v_and_or_b32 v11, v11, -2, s26
    buffer_store_dwordx4 v[8:11], v21, s[4:7], s48 offen sc1
    ds_write_b128 v4, v[8:11] offset:0
    s_mov_b64 exec, -1
    s_cmp_eq_u32 s16, 0
    s_cbranch_scc1 L_w0_S
    s_waitcnt lgkmcnt(0)
    ds_read_b128 v[120:123], v20 offset:14336
    ds_read_b128 v[124:127], v20 offset:15360
    ds_read_b128 v[128:131], v20 offset:24576
    ds_read_b128 v[132:135], v20 offset:25600
    ds_read_b128 v[136:139], v20 offset:26624
    ds_read_b128 v[140:143], v20 offset:27648
    s_waitcnt lgkmcnt(10)
    v_smfmac_f32_16x16x64_bf16 v[144:147], v[32:35], v[96:103], v16
    ds_read_b128 v[96:99], v20 offset:36864
    ds_read_b128 v[100:103], v20 offset:37888
    s_waitcnt lgkmcnt(10)
    v_smfmac_f32_16x16x64_bf16 v[148:151], v[32:35], v[104:111], v16
    ds_read_b128 v[104:107], v20 offset:38912
    ds_read_b128 v[108:111], v20 offset:39936
    s_waitcnt lgkmcnt(10)
    v_smfmac_f32_16x16x64_bf16 v[144:147], v[36:39], v[112:119], v16
    ds_read_b128 v[112:115], v20 offset:49152
    ds_read_b128 v[116:119], v20 offset:50176
    s_waitcnt lgkmcnt(10)
    v_smfmac_f32_16x16x64_bf16 v[148:151], v[36:39], v[120:127], v16
    ds_read_b128 v[120:123], v20 offset:51200
    ds_read_b128 v[124:127], v20 offset:52224
    s_waitcnt lgkmcnt(10)
    v_smfmac_f32_16x16x64_bf16 v[144:147], v[40:43], v[128:135], v16
    v_add_u32 v20, 61440, v20
    ds_read_b128 v[128:131], v20 offset:0
    ds_read_b128 v[132:135], v20 offset:1024
    s_waitcnt lgkmcnt(10)
    v_smfmac_f32_16x16x64_bf16 v[148:151], v[40:43], v[136:143], v16
    ds_read_b128 v[136:139], v20 offset:2048
    ds_read_b128 v[140:143], v20 offset:3072
    s_waitcnt lgkmcnt(10)
    v_smfmac_f32_16x16x64_bf16 v[144:147], v[44:47], v[96:103], v16
    ds_read_b128 v[96:99], v20 offset:12288
    ds_read_b128 v[100:103], v20 offset:13312
    s_waitcnt lgkmcnt(10)
    v_smfmac_f32_16x16x64_bf16 v[148:151], v[44:47], v[104:111], v16
    ds_read_b128 v[104:107], v20 offset:14336
    ds_read_b128 v[108:111], v20 offset:15360
    s_waitcnt lgkmcnt(10)
    v_smfmac_f32_16x16x64_bf16 v[144:147], v[48:51], v[112:119], v16
    ds_read_b128 v[112:115], v20 offset:24576
    ds_read_b128 v[116:119], v20 offset:25600
    s_waitcnt lgkmcnt(10)
    v_smfmac_f32_16x16x64_bf16 v[148:151], v[48:51], v[120:127], v16
    ds_read_b128 v[120:123], v20 offset:26624
    ds_read_b128 v[124:127], v20 offset:27648
    s_waitcnt lgkmcnt(10)
    v_smfmac_f32_16x16x64_bf16 v[144:147], v[52:55], v[128:135], v16
    ds_read_b128 v[128:131], v20 offset:36864
    ds_read_b128 v[132:135], v20 offset:37888
    s_waitcnt lgkmcnt(10)
    v_smfmac_f32_16x16x64_bf16 v[148:151], v[52:55], v[136:143], v16
    ds_read_b128 v[136:139], v20 offset:38912
    ds_read_b128 v[140:143], v20 offset:39936
    s_waitcnt lgkmcnt(10)
    v_smfmac_f32_16x16x64_bf16 v[144:147], v[56:59], v[96:103], v16
    ds_read_b128 v[96:99], v20 offset:49152
    ds_read_b128 v[100:103], v20 offset:50176
    s_waitcnt lgkmcnt(10)
    v_smfmac_f32_16x16x64_bf16 v[148:151], v[56:59], v[104:111], v16
    ds_read_b128 v[104:107], v20 offset:51200
    ds_read_b128 v[108:111], v20 offset:52224
    v_subrev_u32 v20, 61440, v20
    s_waitcnt lgkmcnt(10)
    v_smfmac_f32_16x16x64_bf16 v[144:147], v[60:63], v[112:119], v16
    s_waitcnt lgkmcnt(8)
    v_smfmac_f32_16x16x64_bf16 v[148:151], v[60:63], v[120:127], v16
    s_waitcnt lgkmcnt(6)
    v_smfmac_f32_16x16x64_bf16 v[144:147], v[64:67], v[128:135], v16
    s_waitcnt lgkmcnt(4)
    v_smfmac_f32_16x16x64_bf16 v[148:151], v[64:67], v[136:143], v16
    s_waitcnt lgkmcnt(2)
    v_smfmac_f32_16x16x64_bf16 v[144:147], v[68:71], v[96:103], v16
    s_waitcnt lgkmcnt(0)
    v_smfmac_f32_16x16x64_bf16 v[148:151], v[68:71], v[104:111], v16
    s_nop 7
    v_add_f32 v144, v144, v145
    v_add_f32 v146, v146, v147
    v_cvt_pk_bf16_f32 v4, v144, v146
    ds_write_b32 v22, v4 offset:38976
    v_add_f32 v148, v148, v149
    v_add_f32 v150, v150, v151
    v_cvt_pk_bf16_f32 v5, v148, v150
    ds_write_b32 v22, v5 offset:38984
    s_branch L_b2p_S
L_w3_S:
    ds_read_b128 v[120:123], v20 offset:14336
    ds_read_b128 v[124:127], v20 offset:15360
    ds_read_b128 v[128:131], v20 offset:24576
    ds_read_b128 v[132:135], v20 offset:25600
    ds_read_b128 v[136:139], v20 offset:26624
    ds_read_b128 v[140:143], v20 offset:27648
    s_waitcnt lgkmcnt(10)
    v_smfmac_f32_16x16x64_bf16 v[144:147], v[32:35], v[96:103], v16
    ds_read_b128 v[96:99], v20 offset:36864
    ds_read_b128 v[100:103], v20 offset:37888
    s_waitcnt lgkmcnt(10)
    v_smfmac_f32_16x16x64_bf16 v[148:151], v[32:35], v[104:111], v16
    ds_read_b128 v[104:107], v20 offset:38912
    ds_read_b128 v[108:111], v20 offset:39936
    s_waitcnt lgkmcnt(10)
    v_smfmac_f32_16x16x64_bf16 v[144:147], v[36:39], v[112:119], v16
    ds_read_b128 v[112:115], v20 offset:49152
    ds_read_b128 v[116:119], v20 offset:50176
    s_waitcnt lgkmcnt(10)
    v_smfmac_f32_16x16x64_bf16 v[148:151], v[36:39], v[120:127], v16
    ds_read_b128 v[120:123], v20 offset:51200
    ds_read_b128 v[124:127], v20 offset:52224
    s_waitcnt lgkmcnt(10)
    v_smfmac_f32_16x16x64_bf16 v[144:147], v[40:43], v[128:135], v16
    v_add_u32 v20, 61440, v20
    ds_read_b128 v[128:131], v20 offset:0
    ds_read_b128 v[132:135], v20 offset:1024
    s_waitcnt lgkmcnt(10)
    v_smfmac_f32_16x16x64_bf16 v[148:151], v[40:43], v[136:143], v16
    ds_read_b128 v[136:139], v20 offset:2048
    ds_read_b128 v[140:143], v20 offset:3072
    s_waitcnt lgkmcnt(10)
    v_smfmac_f32_16x16x64_bf16 v[144:147], v[44:47], v[96:103], v16
    ds_read_b128 v[96:99], v20 offset:12288
    ds_read_b128 v[100:103], v20 offset:13312
    s_waitcnt lgkmcnt(10)
    v_smfmac_f32_16x16x64_bf16 v[148:151], v[44:47], v[104:111], v16
    ds_read_b128 v[104:107], v20 offset:14336
    ds_read_b128 v[108:111], v20 offset:15360
    s_waitcnt lgkmcnt(10)
    v_smfmac_f32_16x16x64_bf16 v[144:147], v[48:51], v[112:119], v16
    ds_read_b128 v[112:115], v20 offset:24576
    ds_read_b128 v[116:119], v20 offset:25600
    s_waitcnt lgkmcnt(10)
    v_smfmac_f32_16x16x64_bf16 v[148:151], v[48:51], v[120:127], v16
    ds_read_b128 v[120:123], v20 offset:26624
    ds_read_b128 v[124:127], v20 offset:27648
    s_waitcnt lgkmcnt(10)
    v_smfmac_f32_16x16x64_bf16 v[144:147], v[52:55], v[128:135], v16
    ds_read_b128 v[128:131], v20 offset:36864
    ds_read_b128 v[132:135], v20 offset:37888
    s_waitcnt lgkmcnt(10)
    v_smfmac_f32_16x16x64_bf16 v[148:151], v[52:55], v[136:143], v16
    ds_read_b128 v[136:139], v20 offset:38912
    ds_read_b128 v[140:143], v20 offset:39936
    s_waitcnt lgkmcnt(10)
    v_smfmac_f32_16x16x64_bf16 v[144:147], v[56:59], v[96:103], v16
    ds_read_b128 v[96:99], v20 offset:49152
    ds_read_b128 v[100:103], v20 offset:50176
    s_waitcnt lgkmcnt(10)
    v_smfmac_f32_16x16x64_bf16 v[148:151], v[56:59], v[104:111], v16
    ds_read_b128 v[104:107], v20 offset:51200
    ds_read_b128 v[108:111], v20 offset:52224
    v_subrev_u32 v20, 61440, v20
    s_waitcnt lgkmcnt(10)
    v_smfmac_f32_16x16x64_bf16 v[144:147], v[60:63], v[112:119], v16
    s_waitcnt lgkmcnt(8)
    v_smfmac_f32_16x16x64_bf16 v[148:151], v[60:63], v[120:127], v16
    s_waitcnt lgkmcnt(6)
    v_smfmac_f32_16x16x64_bf16 v[144:147], v[64:67], v[128:135], v16
    s_waitcnt lgkmcnt(4)
    v_smfmac_f32_16x16x64_bf16 v[148:151], v[64:67], v[136:143], v16
    s_waitcnt lgkmcnt(2)
    v_smfmac_f32_16x16x64_bf16 v[144:147], v[68:71], v[96:103], v16
    s_waitcnt lgkmcnt(0)
    v_smfmac_f32_16x16x64_bf16 v[148:151], v[68:71], v[104:111], v16
    s_nop 7
    v_add_f32 v144, v144, v145
    v_add_f32 v146, v146, v147
    v_cvt_pk_bf16_f32 v4, v144, v146
    ds_write_b32 v22, v4 offset:38976
    v_add_f32 v148, v148, v149
    v_add_f32 v150, v150, v151
    v_cvt_pk_bf16_f32 v5, v148, v150
    ds_write_b32 v22, v5 offset:38984
    s_branch L_b2p_S
L_w0_S:
    s_cmp_eq_u32 s24, 63
    s_cbranch_scc1 L_b2p_S
    v_pk_add_f32 v[8:9], v[8:9], v[2:3] op_sel_hi:[1,0]
    v_pk_add_f32 v[10:11], v[10:11], v[2:3] op_sel_hi:[1,0]
    s_sleep 2
L_pa_S:
    buffer_load_dwordx4 v[32:35], v21, s[4:7], s49 offen offset:0 sc1
    buffer_load_dwordx4 v[36:39], v21, s[4:7], s49 offen offset:512 sc1
    buffer_load_dwordx4 v[40:43], v21, s[4:7], s49 offen offset:1024 sc1
    s_waitcnt vmcnt(0)
    s_cmp_eq_u32 s26, 0
    s_cbranch_scc1 L_31_S
    v_bitop3_b32 v4, v32, v33, v34 bitop3:0x80
    v_bitop3_b32 v4, v4, v35, v36 bitop3:0x80
    v_bitop3_b32 v4, v4, v37, v38 bitop3:0x80
    v_bitop3_b32 v4, v4, v39, v40 bitop3:0x80
    v_bitop3_b32 v4, v4, v41, v42 bitop3:0x80
    v_bitop3_b32 v4, v4, v43, v43 bitop3:0x80
    v_and_b32 v4, 1, v4
    v_cmp_ne_u32 vcc, 1, v4
    s_cbranch_vccnz L_spin_30_S
    s_branch L_32_S
L_31_S:
    v_or3_b32 v4, v32, v33, v34
    v_or3_b32 v4, v4, v35, v36
    v_or3_b32 v4, v4, v37, v38
    v_or3_b32 v4, v4, v39, v40
    v_or3_b32 v4, v4, v41, v42
    v_or3_b32 v4, v4, v43, v43
    v_and_b32 v4, 1, v4
    v_cmp_ne_u32 vcc, 0, v4
    s_cbranch_vccnz L_spin_30_S
L_32_S:
    v_pk_add_f32 v[32:33], v[32:33], v[8:9]
    v_pk_add_f32 v[34:35], v[34:35], v[10:11]
    s_mov_b64 exec, s[44:45]
    ds_write_b128 v21, v[36:39] offset:2560
    ds_write_b128 v21, v[40:43] offset:3072
    ds_write_b128 v21, v[32:35] offset:2048
    s_mov_b64 exec, -1
L_b2p_S:
    v_mov_b32 v132, 0
    v_mov_b32 v133, 0
    v_mov_b32 v134, 0
    v_mov_b32 v135, 0
    v_mov_b32 v136, 0
    v_mov_b32 v137, 0
    v_mov_b32 v138, 0
    v_mov_b32 v139, 0
    v_mov_b32 v140, 0
    v_mov_b32 v141, 0
    v_mov_b32 v142, 0
    v_mov_b32 v143, 0
    v_mov_b32 v144, 0
    v_mov_b32 v145, 0
    v_mov_b32 v146, 0
    v_mov_b32 v147, 0
    v_mov_b32 v148, 0
    v_mov_b32 v149, 0
    v_mov_b32 v150, 0
    v_mov_b32 v151, 0
    s_waitcnt lgkmcnt(0)
    s_barrier
    ds_read_b128 v[48:51], v21 offset:512
    ds_read_b128 v[36:39], v21 offset:2560
    ds_read_b128 v[52:55], v21 offset:1024
    ds_read_b128 v[40:43], v21 offset:3072
    ds_read_b128 v[44:47], v21 offset:2048
    ds_read_b128 v[60:63], v27 offset:0
    ds_read_b128 v[64:67], v27 offset:512
    ds_read_b128 v[68:71], v27 offset:1024
    s_cmp_eq_u32 s24, 63
    s_cbranch_scc1 L_ch_done
    s_mov_b32 m0, s41
    s_nop 0
    buffer_load_dwordx4 v3, s[4:7], s35 offen sc1 lds
    s_mov_b32 exec_hi, 0
    buffer_load_dwordx4 v3, s[4:7], s35 offen offset:1024 sc1 lds
    s_mov_b32 exec_hi, -1
    s_add_u32 s35, s35, 12288
    s_waitcnt lgkmcnt(6)
    v_pk_add_f32 v[48:49], v[48:49], v[36:37]
    v_pk_add_f32 v[50:51], v[50:51], v[38:39]
    s_waitcnt lgkmcnt(4)
    v_pk_add_f32 v[52:53], v[52:53], v[40:41]
    v_pk_add_f32 v[54:55], v[54:55], v[42:43]
    v_max3_f32 v4, v48, v49, v50
    v_max3_f32 v5, v51, v52, v53
    v_max3_f32 v4, v4, v54, v55
    s_waitcnt lgkmcnt(3)
    v_max3_f32 v5, v5, v44, v45
    v_max3_f32 v4, v4, v46, v47
    v_max_f32 v6, v4, v5
    v_max_f32 v4, v4, v5
    s_nop 1
    v_permlane32_swap_b32 v4, v6
    v_max_f32 v5, v4, v6
    v_max_f32 v4, v4, v6
    s_nop 1
    v_permlane16_swap_b32 v4, v5
    v_max_f32 v4, v4, v5
    v_mul_f32 v4, s38, v4
    v_pk_fma_f32 v[48:49], v[48:49], s[38:39], v[4:5] op_sel_hi:[1,0,0] neg_lo:[0,0,1] neg_hi:[0,0,1]
    v_pk_fma_f32 v[50:51], v[50:51], s[38:39], v[4:5] op_sel_hi:[1,0,0] neg_lo:[0,0,1] neg_hi:[0,0,1]
    v_pk_fma_f32 v[52:53], v[52:53], s[38:39], v[4:5] op_sel_hi:[1,0,0] neg_lo:[0,0,1] neg_hi:[0,0,1]
    v_pk_fma_f32 v[54:55], v[54:55], s[38:39], v[4:5] op_sel_hi:[1,0,0] neg_lo:[0,0,1] neg_hi:[0,0,1]
    v_exp_f32 v48, v48
    v_exp_f32 v49, v49
    v_exp_f32 v50, v50
    v_exp_f32 v51, v51
    v_exp_f32 v52, v52
    v_exp_f32 v53, v53
    v_exp_f32 v54, v54
    v_exp_f32 v55, v55
    v_pk_fma_f32 v[44:45], v[44:45], s[38:39], v[4:5] op_sel_hi:[1,0,0] neg_lo:[0,0,1] neg_hi:[0,0,1]
    v_pk_fma_f32 v[46:47], v[46:47], s[38:39], v[4:5] op_sel_hi:[1,0,0] neg_lo:[0,0,1] neg_hi:[0,0,1]
    v_cvt_pk_bf16_f32 v56, v48, v49
    v_cvt_pk_bf16_f32 v57, v50, v51
    v_cvt_pk_bf16_f32 v58, v52, v53
    v_cvt_pk_bf16_f32 v59, v54, v55
    v_exp_f32 v44, v44
    v_exp_f32 v45, v45
    v_mfma_f32_16x16x32_bf16 v[96:99], v[72:75], v[56:59], 0
    v_exp_f32 v46, v46
    v_exp_f32 v47, v47
    v_mfma_f32_16x16x32_bf16 v[100:103], v[76:79], v[56:59], 0
    v_pk_add_f32 v[48:49], v[48:49], v[50:51]
    v_pk_add_f32 v[52:53], v[52:53], v[54:55]
    v_cvt_pk_bf16_f32 v8, v44, v45
    v_mfma_f32_16x16x32_bf16 v[104:107], v[80:83], v[56:59], 0
    v_cvt_pk_bf16_f32 v9, v46, v47
    v_pk_add_f32 v[44:45], v[44:45], v[46:47]
    v_pk_add_f32 v[48:49], v[48:49], v[52:53]
    v_mfma_f32_16x16x32_bf16 v[108:111], v[84:87], v[56:59], 0
    v_pk_add_f32 v[44:45], v[44:45], v[48:49]
    v_add_f32 v4, v44, v45
    v_add_f32 v5, v44, v45
    s_nop 0
    v_mfma_f32_16x16x32_bf16 v[112:115], v[88:91], v[56:59], 0
    v_permlane32_swap_b32 v4, v5
    v_add_f32 v6, v4, v5
    v_add_f32 v4, v4, v5
    s_nop 0
    v_mfma_f32_16x16x32_bf16 v[116:119], v[92:95], v[56:59], 0
    v_permlane16_swap_b32 v4, v6
    v_add_f32 v4, v4, v6
    v_rcp_f32 v44, v4
    s_waitcnt lgkmcnt(0)
    v_mfma_f32_16x16x16_bf16 v[96:99], v[60:61], v[8:9], v[96:99]
    v_mfma_f32_16x16x16_bf16 v[100:103], v[62:63], v[8:9], v[100:103]
    v_mfma_f32_16x16x16_bf16 v[104:107], v[64:65], v[8:9], v[104:107]
    v_mfma_f32_16x16x16_bf16 v[108:111], v[66:67], v[8:9], v[108:111]
    v_mfma_f32_16x16x16_bf16 v[112:115], v[68:69], v[8:9], v[112:115]
    v_mfma_f32_16x16x16_bf16 v[116:119], v[70:71], v[8:9], v[116:119]
    s_nop 2
    v_pk_mul_f32 v[96:97], v[96:97], v[44:45] op_sel_hi:[1,0]
    v_cvt_pk_bf16_f32 v60, v96, v97
    v_pk_mul_f32 v[98:99], v[98:99], v[44:45] op_sel_hi:[1,0]
    v_cvt_pk_bf16_f32 v61, v98, v99
    v_pk_mul_f32 v[100:101], v[100:101], v[44:45] op_sel_hi:[1,0]
    v_cvt_pk_bf16_f32 v62, v100, v101
    v_pk_mul_f32 v[102:103], v[102:103], v[44:45] op_sel_hi:[1,0]
    v_cvt_pk_bf16_f32 v63, v102, v103
    v_pk_mul_f32 v[104:105], v[104:105], v[44:45] op_sel_hi:[1,0]
    v_cvt_pk_bf16_f32 v64, v104, v105
    v_pk_mul_f32 v[106:107], v[106:107], v[44:45] op_sel_hi:[1,0]
    v_cvt_pk_bf16_f32 v65, v106, v107
    v_smfmac_f32_16x16x64_bf16 v[132:135], v[60:63], a[240:247], v17
    v_pk_mul_f32 v[108:109], v[108:109], v[44:45] op_sel_hi:[1,0]
    v_cvt_pk_bf16_f32 v66, v108, v109
    v_pk_mul_f32 v[110:111], v[110:111], v[44:45] op_sel_hi:[1,0]
    v_cvt_pk_bf16_f32 v67, v110, v111
    v_smfmac_f32_16x16x64_bf16 v[136:139], v[60:63], v[160:167], v17
    v_pk_mul_f32 v[112:113], v[112:113], v[44:45] op_sel_hi:[1,0]
    v_cvt_pk_bf16_f32 v68, v112, v113
    v_pk_mul_f32 v[114:115], v[114:115], v[44:45] op_sel_hi:[1,0]
    v_cvt_pk_bf16_f32 v69, v114, v115
    v_smfmac_f32_16x16x64_bf16 v[140:143], v[60:63], v[184:191], v17
    v_pk_mul_f32 v[116:117], v[116:117], v[44:45] op_sel_hi:[1,0]
    v_cvt_pk_bf16_f32 v70, v116, v117
    v_pk_mul_f32 v[118:119], v[118:119], v[44:45] op_sel_hi:[1,0]
    v_cvt_pk_bf16_f32 v71, v118, v119
    v_smfmac_f32_16x16x64_bf16 v[144:147], v[60:63], v[208:215], v17
    v_smfmac_f32_16x16x64_bf16 v[132:135], v[64:67], a[248:255], v17
    s_add_u32 s48, s48, s46
    s_add_u32 s49, s49, s46
    v_smfmac_f32_16x16x64_bf16 v[136:139], v[64:67], v[168:175], v17
    v_smfmac_f32_16x16x64_bf16 v[140:143], v[64:67], v[192:199], v17
    v_smfmac_f32_16x16x64_bf16 v[144:147], v[64:67], v[216:223], v17
    v_smfmac_f32_16x16x64_bf16 v[132:135], v[68:71], v[152:159], v17
    v_smfmac_f32_16x16x64_bf16 v[136:139], v[68:71], v[176:183], v17
    v_smfmac_f32_16x16x64_bf16 v[140:143], v[68:71], v[200:207], v17
    v_smfmac_f32_16x16x64_bf16 v[144:147], v[68:71], v[224:231], v17
    v_smfmac_f32_16x16x64_bf16 v[148:151], v[60:63], v[232:239], v17
    v_smfmac_f32_16x16x64_bf16 v[148:151], v[64:67], v[240:247], v17
    v_smfmac_f32_16x16x64_bf16 v[148:151], v[68:71], v[248:255], v17
    s_nop 1
    v_cvt_pk_bf16_f32 v96, v132, v133
    v_cvt_pk_bf16_f32 v100, v134, v135
    v_cvt_pk_bf16_f32 v97, v136, v137
    v_cvt_pk_bf16_f32 v101, v138, v139
    v_cvt_pk_bf16_f32 v98, v140, v141
    v_cvt_pk_bf16_f32 v102, v142, v143
    v_cvt_pk_bf16_f32 v99, v144, v145
    v_cvt_pk_bf16_f32 v103, v146, v147
    v_and_or_b32 v96, v96, -2, s26
    v_and_or_b32 v98, v98, -2, s26
    v_and_or_b32 v100, v100, -2, s26
    v_and_or_b32 v102, v102, -2, s26
    buffer_store_dwordx4 v[96:99], v23, s[4:7], s50 offen sc1
    buffer_store_dwordx4 v[100:103], v23, s[4:7], s50 offen offset:256 sc1
    v_cvt_pk_bf16_f32 v104, v148, v149
    v_cvt_pk_bf16_f32 v105, v150, v151
    v_and_or_b32 v104, v104, -2, s26
    buffer_store_dwordx2 v[104:105], v24, s[4:7], s51 offen sc1
    s_cmp_ge_u32 s33, 80
    s_cbranch_scc1 L_nored_S
    s_sleep 7
    buffer_load_dwordx4 v[72:75], v25, s[4:7], s52 offen sc1
    buffer_load_dwordx4 v[76:79], v25, s[4:7], s53 offen sc1
    buffer_load_dwordx4 v[80:83], v25, s[4:7], s54 offen sc1
    buffer_load_dwordx4 v[84:87], v25, s[4:7], s55 offen sc1
    s_sleep 2
L_pb0_S:
    buffer_load_dwordx4 v[32:35], v25, s[4:7], s52 offen sc1
    buffer_load_dwordx4 v[36:39], v25, s[4:7], s53 offen sc1
    buffer_load_dwordx4 v[40:43], v25, s[4:7], s54 offen sc1
    buffer_load_dwordx4 v[44:47], v25, s[4:7], s55 offen sc1
    s_waitcnt vmcnt(4)
    v_mfma_f32_16x16x32_bf16 v[120:123], v[12:15], v[72:75], 0
    v_mfma_f32_16x16x32_bf16 v[120:123], v[12:15], v[76:79], v[120:123]
    v_mfma_f32_16x16x32_bf16 v[120:123], v[12:15], v[80:83], v[120:123]
    v_mfma_f32_16x16x32_bf16 v[120:123], v[12:15], v[84:87], v[120:123]
    s_cmp_eq_u32 s26, 0
    s_cbranch_scc1 L_34_S
    v_bitop3_b32 v5, v72, v74, v76 bitop3:0x80
    v_bitop3_b32 v5, v5, v78, v80 bitop3:0x80
    v_bitop3_b32 v5, v5, v82, v84 bitop3:0x80
    v_bitop3_b32 v5, v5, v86, v86 bitop3:0x80
    v_and_b32 v5, 1, v5
    v_cmp_ne_u32 vcc, 1, v5
    s_cbranch_vccnz L_spin_33_S
    s_branch L_35_S
L_34_S:
    v_or3_b32 v5, v72, v74, v76
    v_or3_b32 v5, v5, v78, v80
    v_or3_b32 v5, v5, v82, v84
    v_or3_b32 v5, v5, v86, v86
    v_and_b32 v5, 1, v5
    v_cmp_ne_u32 vcc, 0, v5
    s_cbranch_vccnz L_spin_33_S
L_35_S:
    s_branch L_pbok_S
L_pb1_S:
    buffer_load_dwordx4 v[72:75], v25, s[4:7], s52 offen sc1
    buffer_load_dwordx4 v[76:79], v25, s[4:7], s53 offen sc1
    buffer_load_dwordx4 v[80:83], v25, s[4:7], s54 offen sc1
    buffer_load_dwordx4 v[84:87], v25, s[4:7], s55 offen sc1
    s_waitcnt vmcnt(4)
    v_mfma_f32_16x16x32_bf16 v[120:123], v[12:15], v[32:35], 0
    v_mfma_f32_16x16x32_bf16 v[120:123], v[12:15], v[36:39], v[120:123]
    v_mfma_f32_16x16x32_bf16 v[120:123], v[12:15], v[40:43], v[120:123]
    v_mfma_f32_16x16x32_bf16 v[120:123], v[12:15], v[44:47], v[120:123]
    s_cmp_eq_u32 s26, 0
    s_cbranch_scc1 L_37_S
    v_bitop3_b32 v5, v32, v34, v36 bitop3:0x80
    v_bitop3_b32 v5, v5, v38, v40 bitop3:0x80
    v_bitop3_b32 v5, v5, v42, v44 bitop3:0x80
    v_bitop3_b32 v5, v5, v46, v46 bitop3:0x80
    v_and_b32 v5, 1, v5
    v_cmp_ne_u32 vcc, 1, v5
    s_cbranch_vccnz L_spin_36_S
    s_branch L_38_S
L_37_S:
    v_or3_b32 v5, v32, v34, v36
    v_or3_b32 v5, v5, v38, v40
    v_or3_b32 v5, v5, v42, v44
    v_or3_b32 v5, v5, v46, v46
    v_and_b32 v5, 1, v5
    v_cmp_ne_u32 vcc, 0, v5
    s_cbranch_vccnz L_spin_36_S
L_38_S:
L_pbok_S:
    v_add_f32_dpp v124, v120, v120 row_ror:8 row_mask:0xf bank_mask:0xf
    v_add_f32_dpp v125, v121, v121 row_ror:8 row_mask:0xf bank_mask:0xf
    v_add_f32_dpp v126, v122, v122 row_ror:8 row_mask:0xf bank_mask:0xf
    v_add_f32_dpp v127, v123, v123 row_ror:8 row_mask:0xf bank_mask:0xf
    s_mov_b64 exec, 0x00ff00ff
    v_cvt_pk_bf16_f32 v128, v124, v125
    v_cvt_pk_bf16_f32 v129, v126, v127
    v_and_or_b32 v128, v128, -2, s26
    buffer_store_dwordx2 v[128:129], v26, s[4:7], s57 offen sc1
    buffer_store_dwordx2 v[128:129], v26, s[4:7], s56 offen sc1
    s_mov_b64 exec, -1
    s_sleep 10
    s_branch L_pc0_S
L_nored_S:
    s_cmp_lg_u32 s16, 3
    s_cbranch_scc1 L_39_S
    s_sleep 22
    v_and_b32 v4, 7, v0
    v_lshrrev_b32 v5, 4, v0
    v_mul_u32_u24 v6, 224, v4
    v_lshl_add_u32 v6, v5, 4, v6
    ds_read_b128 v[120:123], v6 offset:12544
    ds_read_b128 v[124:127], v6 offset:12608
    ds_read_b128 v[128:131], v6 offset:12672
    ds_read_b128 v[72:75], v27 offset:0
    ds_read_b128 v[76:79], v27 offset:512
    ds_read_b128 v[80:83], v27 offset:1024
    v_lshlrev_b32 v4, 4, v4
    v_lshl_add_u32 v4, v5, 7, v4
    s_mov_b32 exec_lo, 0x00ff00ff
    s_mov_b32 exec_hi, 0x00ff00ff
    s_waitcnt lgkmcnt(3)
    buffer_store_dwordx4 v[120:123], v4, s[4:7], s36 offen offset:0 sc1
    buffer_store_dwordx4 v[124:127], v4, s[4:7], s36 offen offset:512 sc1
    buffer_store_dwordx4 v[128:131], v4, s[4:7], s36 offen offset:1024 sc1
    s_mov_b32 exec_lo, -1
    s_mov_b32 exec_hi, 0
    s_waitcnt lgkmcnt(0)
    buffer_store_dwordx4 v[72:75], v3, s[4:7], s37 offen offset:0 sc1
    buffer_store_dwordx4 v[76:79], v3, s[4:7], s37 offen offset:512 sc1
    buffer_store_dwordx4 v[80:83], v3, s[4:7], s37 offen offset:1024 sc1
    v_mov_b32 v6, 0
    v_mov_b32 v7, s24
    s_mov_b64 exec, 1
    buffer_store_dword v7, v6, s[4:7], s28 offen sc1
    s_mov_b64 exec, -1
    s_add_u32 s36, s36, 3072
    s_add_u32 s37, s37, 3072
    s_add_u32 s40, s24, 4
    s_min_u32 s40, s40, 64
    s_cmp_ge_u32 s43, s40
    s_cbranch_scc1 L_40_S
    v_lshlrev_b32 v6, 7, v0
    s_cmp_ge_u32 s43, s40
    s_cbranch_scc1 L_42_S
    s_mov_b64 exec, 3
L_41_S:
    buffer_load_dword v7, v6, s[4:7], s42 offen sc1
    s_waitcnt vmcnt(0)
    v_cmp_gt_u32 vcc, s40, v7
    s_cbranch_vccz L_43_S
    s_sleep 4
    s_branch L_spin_44_S
L_43_S:
    v_readlane_b32 s43, v7, 0
    v_readlane_b32 s29, v7, 1
    s_nop 3
    s_min_u32 s43, s43, s29
    s_mov_b64 exec, -1
L_42_S:
L_40_S:
    s_branch L_pc0_S
L_39_S:
    s_sleep 26
L_pc0_S:
    s_add_u32 s50, s50, s46
    s_add_u32 s51, s51, s46
    s_add_u32 s52, s52, s46
    s_add_u32 s53, s53, s46
    s_add_u32 s54, s54, s46
    s_add_u32 s55, s55, s46
    s_add_u32 s56, s56, s46
    s_add_u32 s57, s57, 20480
    v_mov_b32 v132, 0
    v_mov_b32 v133, 0
    v_mov_b32 v134, 0
    v_mov_b32 v135, 0
    v_mov_b32 v136, 0
    v_mov_b32 v137, 0
    v_mov_b32 v138, 0
    v_mov_b32 v139, 0
    v_mov_b32 v140, 0
    v_mov_b32 v141, 0
    v_mov_b32 v142, 0
    v_mov_b32 v143, 0
    v_mov_b32 v144, 0
    v_mov_b32 v145, 0
    v_mov_b32 v146, 0
    v_mov_b32 v147, 0
    v_mov_b32 v148, 0
    v_mov_b32 v149, 0
    v_mov_b32 v150, 0
    v_mov_b32 v151, 0
L_pc_S:
    buffer_load_dwordx4 v[96:99], v23, s[4:7], s58 offen offset:0 sc1
    buffer_load_dwordx4 v[100:103], v23, s[4:7], s58 offen offset:256 sc1
    buffer_load_dwordx2 v[104:105], v24, s[4:7], s59 offen sc1
    s_waitcnt vmcnt(0)
L_pc1_S:
    s_cmp_eq_u32 s26, 0
    s_cbranch_scc1 L_46_S
    v_bitop3_b32 v5, v96, v98, v100 bitop3:0x80
    v_bitop3_b32 v5, v5, v102, v104 bitop3:0x80
    v_and_b32 v5, 1, v5
    v_cmp_ne_u32 vcc, 1, v5
    s_cbranch_vccnz L_spin_45_S
    s_branch L_47_S
L_46_S:
    v_or3_b32 v5, v96, v98, v100
    v_or3_b32 v5, v5, v102, v104
    v_and_b32 v5, 1, v5
    v_cmp_ne_u32 vcc, 0, v5
    s_cbranch_vccnz L_spin_45_S
L_47_S:
    buffer_load_dwordx4 v[108:111], v23, s[4:7], s60 offen offset:0 sc1
    buffer_load_dwordx4 v[112:115], v23, s[4:7], s60 offen offset:256 sc1
    buffer_load_dwordx2 v[116:117], v24, s[4:7], s61 offen sc1
    v_lshlrev_b32 v32, 16, v96
    v_and_b32 v33, 0xffff0000, v96
    v_lshlrev_b32 v34, 16, v97
    v_and_b32 v35, 0xffff0000, v97
    v_lshlrev_b32 v36, 16, v98
    v_and_b32 v37, 0xffff0000, v98
    v_lshlrev_b32 v38, 16, v99
    v_and_b32 v39, 0xffff0000, v99
    v_lshlrev_b32 v40, 16, v100
    v_and_b32 v41, 0xffff0000, v100
    v_lshlrev_b32 v42, 16, v101
    v_and_b32 v43, 0xffff0000, v101
    v_lshlrev_b32 v44, 16, v102
    v_and_b32 v45, 0xffff0000, v102
    v_lshlrev_b32 v46, 16, v103
    v_and_b32 v47, 0xffff0000, v103
    v_lshlrev_b32 v48, 16, v104
    v_and_b32 v49, 0xffff0000, v104
    v_lshlrev_b32 v50, 16, v105
    v_and_b32 v51, 0xffff0000, v105
    s_add_u32 s58, s58, s46
    s_add_u32 s59, s59, s46
    s_add_u32 s24, s24, 1
    s_add_u32 s25, s25, 1
    s_cmp_eq_u32 s25, 3
    s_cselect_b32 s25, 0, s25
    s_branch L_pr1_S
L_pr_S:
    buffer_load_dwordx4 v[108:111], v23, s[4:7], s60 offen offset:0 sc1
    buffer_load_dwordx4 v[112:115], v23, s[4:7], s60 offen offset:256 sc1
    buffer_load_dwordx2 v[116:117], v24, s[4:7], s61 offen sc1
L_pr1_S:
    s_waitcnt vmcnt(0)
    s_cmp_eq_u32 s26, 0
    s_cbranch_scc1 L_49_S
    v_bitop3_b32 v5, v108, v110, v112 bitop3:0x80
    v_bitop3_b32 v5, v5, v114, v116 bitop3:0x80
    v_and_b32 v5, 1, v5
    v_cmp_ne_u32 vcc, 1, v5
    s_cbranch_vccnz L_spin_48_S
    s_branch L_50_S
L_49_S:
    v_or3_b32 v5, v108, v110, v112
    v_or3_b32 v5, v5, v114, v116
    v_and_b32 v5, 1, v5
    v_cmp_ne_u32 vcc, 0, v5
    s_cbranch_vccnz L_spin_48_S
L_50_S:
    v_dot2_f32_bf16 v32, v108, s62, v32
    v_dot2_f32_bf16 v33, v108, s63, v33
    v_dot2_f32_bf16 v34, v109, s62, v34
    v_dot2_f32_bf16 v35, v109, s63, v35
    v_dot2_f32_bf16 v36, v110, s62, v36
    v_dot2_f32_bf16 v37, v110, s63, v37
    v_dot2_f32_bf16 v38, v111, s62, v38
    v_dot2_f32_bf16 v39, v111, s63, v39
    v_dot2_f32_bf16 v40, v112, s62, v40
    v_dot2_f32_bf16 v41, v112, s63, v41
    v_dot2_f32_bf16 v42, v113, s62, v42
    v_dot2_f32_bf16 v43, v113, s63, v43
    v_dot2_f32_bf16 v44, v114, s62, v44
    v_dot2_f32_bf16 v45, v114, s63, v45
    v_dot2_f32_bf16 v46, v115, s62, v46
    v_dot2_f32_bf16 v47, v115, s63, v47
    v_dot2_f32_bf16 v48, v116, s62, v48
    v_dot2_f32_bf16 v49, v116, s63, v49
    v_dot2_f32_bf16 v50, v117, s62, v50
    v_dot2_f32_bf16 v51, v117, s63, v51
    v_cvt_pk_bf16_f32 v96, v32, v33
    v_cvt_pk_bf16_f32 v97, v34, v35
    v_cvt_pk_bf16_f32 v98, v36, v37
    v_cvt_pk_bf16_f32 v99, v38, v39
    ds_write_b128 v30, v[96:99]
    v_cvt_pk_bf16_f32 v100, v40, v41
    v_cvt_pk_bf16_f32 v101, v42, v43
    v_cvt_pk_bf16_f32 v102, v44, v45
    v_cvt_pk_bf16_f32 v103, v46, v47
    ds_write_b128 v30, v[100:103] offset:1344
    v_cvt_pk_bf16_f32 v104, v48, v49
    v_cvt_pk_bf16_f32 v105, v50, v51
    ds_write_b32 v31, v104
    ds_write_b32 v31, v105 offset:1344
    s_mov_b32 m0, s47
    s_xor_b32 s47, s47, 8192
    buffer_load_dwordx4 v3, s[4:7], s34 offen sc1 lds
    s_mov_b32 exec_hi, 0
    buffer_load_dwordx4 v3, s[4:7], s34 offen offset:1024 sc1 lds
    s_mov_b32 exec_hi, -1
    s_add_u32 s34, s34, 12288
    s_add_u32 s60, s60, 20480
    s_add_u32 s61, s61, 20480
    s_xor_b32 s26, s26, 1
    s_waitcnt lgkmcnt(0)
    s_branch L_step_S
L_ch_done:
    s_waitcnt lgkmcnt(0)
    s_cmp_lg_u32 s16, 3
    s_cbranch_scc1 L_51
    v_and_b32 v4, 7, v0
    v_lshrrev_b32 v5, 4, v0
    v_mul_u32_u24 v6, 224, v4
    v_lshl_add_u32 v6, v5, 4, v6
    ds_read_b128 v[120:123], v6 offset:12544
    ds_read_b128 v[124:127], v6 offset:12608
    ds_read_b128 v[128:131], v6 offset:12672
    ds_read_b128 v[72:75], v27 offset:0
    ds_read_b128 v[76:79], v27 offset:512
    ds_read_b128 v[80:83], v27 offset:1024
    v_lshlrev_b32 v4, 4, v4
    v_lshl_add_u32 v4, v5, 7, v4
    s_mov_b32 exec_lo, 0x00ff00ff
    s_mov_b32 exec_hi, 0x00ff00ff
    s_waitcnt lgkmcnt(3)
    buffer_store_dwordx4 v[120:123], v4, s[4:7], s36 offen offset:0 sc1
    buffer_store_dwordx4 v[124:127], v4, s[4:7], s36 offen offset:512 sc1
    buffer_store_dwordx4 v[128:131], v4, s[4:7], s36 offen offset:1024 sc1
    s_mov_b32 exec_lo, -1
    s_mov_b32 exec_hi, 0
    s_waitcnt lgkmcnt(0)
    buffer_store_dwordx4 v[72:75], v3, s[4:7], s37 offen offset:0 sc1
    buffer_store_dwordx4 v[76:79], v3, s[4:7], s37 offen offset:512 sc1
    buffer_store_dwordx4 v[80:83], v3, s[4:7], s37 offen offset:1024 sc1
    v_mov_b32 v6, 0
    v_mov_b32 v7, s24
    s_mov_b64 exec, 1
    buffer_store_dword v7, v6, s[4:7], s28 offen sc1
    s_mov_b64 exec, -1
    s_add_u32 s36, s36, 3072
    s_add_u32 s37, s37, 3072
L_51:
    s_waitcnt vmcnt(0) lgkmcnt(0)
    s_barrier
    s_cmp_lg_u32 s16, 3
    s_cbranch_scc1 L_52
    v_mov_b32 v4, 0
    v_mov_b32 v5, 64
    s_mov_b64 exec, 1
    buffer_store_dword v5, v4, s[4:7], s28 offen sc1
    s_mov_b64 exec, -1
L_52:
    s_mov_b32 s38, 0
    s_branch L_op
L_bulk:
    s_bfe_u32 s17, s32, 0x10001
    s_and_b32 s30, s32, 1
    s_lshr_b32 s31, s19, 1
    s_mul_i32 s20, s30, 16
    s_add_u32 s20, s20, s31
    s_and_b32 s18, s19, 1
    s_mul_i32 s30, s17, 8192
    s_mul_i32 s29, s20, 256
    s_add_u32 s30, s30, s29
    s_mul_i32 s29, s18, 128
    s_add_u32 s30, s30, s29
    s_add_u32 s30, s30, 181846016
    s_cmp_lg_u32 s16, 0
    s_cbranch_scc1 L_53
    v_mov_b32 v1, 0
    v_lshlrev_b32 v3, 7, v0
    s_mov_b32 s29, 184500224
    s_cmp_lg_u32 s19, 0
    s_cbranch_scc1 L_54
    buffer_store_dword v1, v3, s[4:7], s29 offen sc1
    s_add_u32 s29, s29, 8192
    buffer_store_dword v1, v3, s[4:7], s29 offen sc1
L_54:
    v_mov_b32 v1, 0
    v_mov_b32 v2, 1
    s_mov_b64 exec, 1
    buffer_store_dword v1, v1, s[4:7], s30 offen sc1
    s_waitcnt vmcnt(0)
    buffer_atomic_add v2, v1, s[12:15], 0 offen offset:40
    s_mov_b64 exec, -1
L_53:
    s_mul_i32 s29, s17, 56
    s_add_u32 s88, s0, s29
    s_addc_u32 s89, s1, 0
    s_lshl_b32 s29, s18, 3
    s_add_u32 s90, s88, s29
    s_addc_u32 s91, s89, 0
    s_load_dwordx2 s[8:9], s[90:91], 24
    s_mov_b32 s10, 7864320
    s_mov_b32 s11, 0x20000
    v_and_b32 v8, 15, v0
    v_lshrrev_b32 v9, 4, v0
    s_mul_i32 s30, s20, 384
    s_mul_i32 s29, s16, 393216
    s_add_u32 s30, s30, s29
    v_add_u32 v5, 0, v0
    v_mul_u32_u24 v6, 171, v5
    v_lshrrev_b32 v6, 12, v6
    v_mul_u32_u24 v7, 24, v6
    v_sub_u32 v7, v5, v7
    v_mul_u32_u24 v6, 12288, v6
    v_lshl_add_u32 v6, v7, 4, v6
    v_add_u32 v1, s30, v6
    v_add_u32 v5, 64, v0
    v_mul_u32_u24 v6, 171, v5
    v_lshrrev_b32 v6, 12, v6
    v_mul_u32_u24 v7, 24, v6
    v_sub_u32 v7, v5, v7
    v_mul_u32_u24 v6, 12288, v6
    v_lshl_add_u32 v6, v7, 4, v6
    v_add_u32 v2, s30, v6
    v_add_u32 v5, 128, v0
    v_mul_u32_u24 v6, 171, v5
    v_lshrrev_b32 v6, 12, v6
    v_mul_u32_u24 v7, 24, v6
    v_sub_u32 v7, v5, v7
    v_mul_u32_u24 v6, 12288, v6
    v_lshl_add_u32 v6, v7, 4, v6
    v_add_u32 v3, s30, v6
    v_lshrrev_b32 v5, 2, v8
    v_lshl_add_u32 v5, v9, 3, v5
    v_mul_u32_u24 v5, 384, v5
    v_and_b32 v6, 3, v8
    v_lshl_add_u32 v5, v6, 3, v5
    s_mul_i32 s30, s16, 96
    v_add_u32 v4, s30, v5
    s_mul_i32 s41, s16, 12288
    s_waitcnt lgkmcnt(0)
    s_barrier
    s_mov_b32 s29, 0
    s_add_u32 m0, s41, 0
    s_nop 0
    buffer_load_dwordx4 v1, s[8:11], s29 offen nt lds
    s_mov_b32 s29, 0
    s_add_u32 m0, s41, 1024
    s_nop 0
    buffer_load_dwordx4 v2, s[8:11], s29 offen nt lds
    s_mov_b32 s29, 0
    s_add_u32 m0, s41, 2048
    s_nop 0
    buffer_load_dwordx4 v3, s[8:11], s29 offen nt lds
    s_mov_b32 s29, 98304
    s_add_u32 m0, s41, 3072
    s_nop 0
    buffer_load_dwordx4 v1, s[8:11], s29 offen nt lds
    s_mov_b32 s29, 98304
    s_add_u32 m0, s41, 4096
    s_nop 0
    buffer_load_dwordx4 v2, s[8:11], s29 offen nt lds
    s_mov_b32 s29, 98304
    s_add_u32 m0, s41, 5120
    s_nop 0
    buffer_load_dwordx4 v3, s[8:11], s29 offen nt lds
    s_mov_b32 s29, 196608
    s_add_u32 m0, s41, 6144
    s_nop 0
    buffer_load_dwordx4 v1, s[8:11], s29 offen nt lds
    s_mov_b32 s29, 196608
    s_add_u32 m0, s41, 7168
    s_nop 0
    buffer_load_dwordx4 v2, s[8:11], s29 offen nt lds
    s_mov_b32 s29, 196608
    s_add_u32 m0, s41, 8192
    s_nop 0
    buffer_load_dwordx4 v3, s[8:11], s29 offen nt lds
    s_mov_b32 s29, 294912
    s_add_u32 m0, s41, 9216
    s_nop 0
    buffer_load_dwordx4 v1, s[8:11], s29 offen nt lds
    s_mov_b32 s29, 294912
    s_add_u32 m0, s41, 10240
    s_nop 0
    buffer_load_dwordx4 v2, s[8:11], s29 offen nt lds
    s_mov_b32 s29, 294912
    s_add_u32 m0, s41, 11264
    s_nop 0
    buffer_load_dwordx4 v3, s[8:11], s29 offen nt lds
    s_mov_b32 s29, 1572864
    s_add_u32 m0, s41, 49152
    s_nop 0
    buffer_load_dwordx4 v1, s[8:11], s29 offen nt lds
    s_mov_b32 s29, 1572864
    s_add_u32 m0, s41, 50176
    s_nop 0
    buffer_load_dwordx4 v2, s[8:11], s29 offen nt lds
    s_mov_b32 s29, 1572864
    s_add_u32 m0, s41, 51200
    s_nop 0
    buffer_load_dwordx4 v3, s[8:11], s29 offen nt lds
    s_mov_b32 s29, 1671168
    s_add_u32 m0, s41, 52224
    s_nop 0
    buffer_load_dwordx4 v1, s[8:11], s29 offen nt lds
    s_mov_b32 s29, 1671168
    s_add_u32 m0, s41, 53248
    s_nop 0
    buffer_load_dwordx4 v2, s[8:11], s29 offen nt lds
    s_mov_b32 s29, 1671168
    s_add_u32 m0, s41, 54272
    s_nop 0
    buffer_load_dwordx4 v3, s[8:11], s29 offen nt lds
    s_mov_b32 s29, 1769472
    s_add_u32 m0, s41, 55296
    s_nop 0
    buffer_load_dwordx4 v1, s[8:11], s29 offen nt lds
    s_mov_b32 s29, 1769472
    s_add_u32 m0, s41, 56320
    s_nop 0
    buffer_load_dwordx4 v2, s[8:11], s29 offen nt lds
    s_mov_b32 s29, 1769472
    s_add_u32 m0, s41, 57344
    s_nop 0
    buffer_load_dwordx4 v3, s[8:11], s29 offen nt lds
    s_mov_b32 s29, 1867776
    s_add_u32 m0, s41, 58368
    s_nop 0
    buffer_load_dwordx4 v1, s[8:11], s29 offen nt lds
    s_mov_b32 s29, 1867776
    s_add_u32 m0, s41, 59392
    s_nop 0
    buffer_load_dwordx4 v2, s[8:11], s29 offen nt lds
    s_mov_b32 s29, 1867776
    s_add_u32 m0, s41, 60416
    s_nop 0
    buffer_load_dwordx4 v3, s[8:11], s29 offen nt lds
    s_waitcnt vmcnt(12)
    s_barrier
    ds_read_b64_tr_b16 a[0:1], v4 offset:0
    ds_read_b64_tr_b16 a[2:3], v4 offset:1536
    ds_read_b64_tr_b16 a[80:81], v4 offset:32
    ds_read_b64_tr_b16 a[82:83], v4 offset:1568
    ds_read_b64_tr_b16 a[160:161], v4 offset:64
    ds_read_b64_tr_b16 a[162:163], v4 offset:1600
    ds_read_b64_tr_b16 a[4:5], v4 offset:12288
    ds_read_b64_tr_b16 a[6:7], v4 offset:13824
    ds_read_b64_tr_b16 a[84:85], v4 offset:12320
    ds_read_b64_tr_b16 a[86:87], v4 offset:13856
    ds_read_b64_tr_b16 a[164:165], v4 offset:12352
    ds_read_b64_tr_b16 a[166:167], v4 offset:13888
    ds_read_b64_tr_b16 a[8:9], v4 offset:24576
    ds_read_b64_tr_b16 a[10:11], v4 offset:26112
    ds_read_b64_tr_b16 a[88:89], v4 offset:24608
    ds_read_b64_tr_b16 a[90:91], v4 offset:26144
    ds_read_b64_tr_b16 a[168:169], v4 offset:24640
    ds_read_b64_tr_b16 a[170:171], v4 offset:26176
    ds_read_b64_tr_b16 a[12:13], v4 offset:36864
    ds_read_b64_tr_b16 a[14:15], v4 offset:38400
    ds_read_b64_tr_b16 a[92:93], v4 offset:36896
    ds_read_b64_tr_b16 a[94:95], v4 offset:38432
    ds_read_b64_tr_b16 a[172:173], v4 offset:36928
    ds_read_b64_tr_b16 a[174:175], v4 offset:38464
    v_add_u32 v4, 49152, v4
    s_waitcnt lgkmcnt(0)
    s_barrier
    s_mov_b32 s29, 3145728
    s_add_u32 m0, s41, 0
    s_nop 0
    buffer_load_dwordx4 v1, s[8:11], s29 offen nt lds
    s_mov_b32 s29, 3145728
    s_add_u32 m0, s41, 1024
    s_nop 0
    buffer_load_dwordx4 v2, s[8:11], s29 offen nt lds
    s_mov_b32 s29, 3145728
    s_add_u32 m0, s41, 2048
    s_nop 0
    buffer_load_dwordx4 v3, s[8:11], s29 offen nt lds
    s_mov_b32 s29, 3244032
    s_add_u32 m0, s41, 3072
    s_nop 0
    buffer_load_dwordx4 v1, s[8:11], s29 offen nt lds
    s_mov_b32 s29, 3244032
    s_add_u32 m0, s41, 4096
    s_nop 0
    buffer_load_dwordx4 v2, s[8:11], s29 offen nt lds
    s_mov_b32 s29, 3244032
    s_add_u32 m0, s41, 5120
    s_nop 0
    buffer_load_dwordx4 v3, s[8:11], s29 offen nt lds
    s_mov_b32 s29, 3342336
    s_add_u32 m0, s41, 6144
    s_nop 0
    buffer_load_dwordx4 v1, s[8:11], s29 offen nt lds
    s_mov_b32 s29, 3342336
    s_add_u32 m0, s41, 7168
    s_nop 0
    buffer_load_dwordx4 v2, s[8:11], s29 offen nt lds
    s_mov_b32 s29, 3342336
    s_add_u32 m0, s41, 8192
    s_nop 0
    buffer_load_dwordx4 v3, s[8:11], s29 offen nt lds
    s_mov_b32 s29, 3440640
    s_add_u32 m0, s41, 9216
    s_nop 0
    buffer_load_dwordx4 v1, s[8:11], s29 offen nt lds
    s_mov_b32 s29, 3440640
    s_add_u32 m0, s41, 10240
    s_nop 0
    buffer_load_dwordx4 v2, s[8:11], s29 offen nt lds
    s_mov_b32 s29, 3440640
    s_add_u32 m0, s41, 11264
    s_nop 0
    buffer_load_dwordx4 v3, s[8:11], s29 offen nt lds
    s_waitcnt vmcnt(12)
    s_barrier
    ds_read_b64_tr_b16 a[16:17], v4 offset:0
    ds_read_b64_tr_b16 a[18:19], v4 offset:1536
    ds_read_b64_tr_b16 a[96:97], v4 offset:32
    ds_read_b64_tr_b16 a[98:99], v4 offset:1568
    ds_read_b64_tr_b16 a[176:177], v4 offset:64
    ds_read_b64_tr_b16 a[178:179], v4 offset:1600
    ds_read_b64_tr_b16 a[20:21], v4 offset:12288
    ds_read_b64_tr_b16 a[22:23], v4 offset:13824
    ds_read_b64_tr_b16 a[100:101], v4 offset:12320
    ds_read_b64_tr_b16 a[102:103], v4 offset:13856
    ds_read_b64_tr_b16 a[180:181], v4 offset:12352
    ds_read_b64_tr_b16 a[182:183], v4 offset:13888
    ds_read_b64_tr_b16 a[24:25], v4 offset:24576
    ds_read_b64_tr_b16 a[26:27], v4 offset:26112
    ds_read_b64_tr_b16 a[104:105], v4 offset:24608
    ds_read_b64_tr_b16 a[106:107], v4 offset:26144
    ds_read_b64_tr_b16 a[184:185], v4 offset:24640
    ds_read_b64_tr_b16 a[186:187], v4 offset:26176
    ds_read_b64_tr_b16 a[28:29], v4 offset:36864
    ds_read_b64_tr_b16 a[30:31], v4 offset:38400
    ds_read_b64_tr_b16 a[108:109], v4 offset:36896
    ds_read_b64_tr_b16 a[110:111], v4 offset:38432
    ds_read_b64_tr_b16 a[188:189], v4 offset:36928
    ds_read_b64_tr_b16 a[190:191], v4 offset:38464
    v_subrev_u32 v4, 49152, v4
    s_waitcnt lgkmcnt(0)
    s_barrier
    s_mov_b32 s29, 4718592
    s_add_u32 m0, s41, 49152
    s_nop 0
    buffer_load_dwordx4 v1, s[8:11], s29 offen nt lds
    s_mov_b32 s29, 4718592
    s_add_u32 m0, s41, 50176
    s_nop 0
    buffer_load_dwordx4 v2, s[8:11], s29 offen nt lds
    s_mov_b32 s29, 4718592
    s_add_u32 m0, s41, 51200
    s_nop 0
    buffer_load_dwordx4 v3, s[8:11], s29 offen nt lds
    s_mov_b32 s29, 4816896
    s_add_u32 m0, s41, 52224
    s_nop 0
    buffer_load_dwordx4 v1, s[8:11], s29 offen nt lds
    s_mov_b32 s29, 4816896
    s_add_u32 m0, s41, 53248
    s_nop 0
    buffer_load_dwordx4 v2, s[8:11], s29 offen nt lds
    s_mov_b32 s29, 4816896
    s_add_u32 m0, s41, 54272
    s_nop 0
    buffer_load_dwordx4 v3, s[8:11], s29 offen nt lds
    s_mov_b32 s29, 4915200
    s_add_u32 m0, s41, 55296
    s_nop 0
    buffer_load_dwordx4 v1, s[8:11], s29 offen nt lds
    s_mov_b32 s29, 4915200
    s_add_u32 m0, s41, 56320
    s_nop 0
    buffer_load_dwordx4 v2, s[8:11], s29 offen nt lds
    s_mov_b32 s29, 4915200
    s_add_u32 m0, s41, 57344
    s_nop 0
    buffer_load_dwordx4 v3, s[8:11], s29 offen nt lds
    s_mov_b32 s29, 5013504
    s_add_u32 m0, s41, 58368
    s_nop 0
    buffer_load_dwordx4 v1, s[8:11], s29 offen nt lds
    s_mov_b32 s29, 5013504
    s_add_u32 m0, s41, 59392
    s_nop 0
    buffer_load_dwordx4 v2, s[8:11], s29 offen nt lds
    s_mov_b32 s29, 5013504
    s_add_u32 m0, s41, 60416
    s_nop 0
    buffer_load_dwordx4 v3, s[8:11], s29 offen nt lds
    s_waitcnt vmcnt(12)
    s_barrier
    ds_read_b64_tr_b16 a[32:33], v4 offset:0
    ds_read_b64_tr_b16 a[34:35], v4 offset:1536
    ds_read_b64_tr_b16 a[112:113], v4 offset:32
    ds_read_b64_tr_b16 a[114:115], v4 offset:1568
    ds_read_b64_tr_b16 a[192:193], v4 offset:64
    ds_read_b64_tr_b16 a[194:195], v4 offset:1600
    ds_read_b64_tr_b16 a[36:37], v4 offset:12288
    ds_read_b64_tr_b16 a[38:39], v4 offset:13824
    ds_read_b64_tr_b16 a[116:117], v4 offset:12320
    ds_read_b64_tr_b16 a[118:119], v4 offset:13856
    ds_read_b64_tr_b16 a[196:197], v4 offset:12352
    ds_read_b64_tr_b16 a[198:199], v4 offset:13888
    ds_read_b64_tr_b16 a[40:41], v4 offset:24576
    ds_read_b64_tr_b16 a[42:43], v4 offset:26112
    ds_read_b64_tr_b16 a[120:121], v4 offset:24608
    ds_read_b64_tr_b16 a[122:123], v4 offset:26144
    ds_read_b64_tr_b16 a[200:201], v4 offset:24640
    ds_read_b64_tr_b16 a[202:203], v4 offset:26176
    ds_read_b64_tr_b16 a[44:45], v4 offset:36864
    ds_read_b64_tr_b16 a[46:47], v4 offset:38400
    ds_read_b64_tr_b16 a[124:125], v4 offset:36896
    ds_read_b64_tr_b16 a[126:127], v4 offset:38432
    ds_read_b64_tr_b16 a[204:205], v4 offset:36928
    ds_read_b64_tr_b16 a[206:207], v4 offset:38464
    v_add_u32 v4, 49152, v4
    s_waitcnt lgkmcnt(0)
    s_barrier
    s_mov_b32 s29, 6291456
    s_add_u32 m0, s41, 0
    s_nop 0
    buffer_load_dwordx4 v1, s[8:11], s29 offen nt lds
    s_mov_b32 s29, 6291456
    s_add_u32 m0, s41, 1024
    s_nop 0
    buffer_load_dwordx4 v2, s[8:11], s29 offen nt lds
    s_mov_b32 s29, 6291456
    s_add_u32 m0, s41, 2048
    s_nop 0
    buffer_load_dwordx4 v3, s[8:11], s29 offen nt lds
    s_mov_b32 s29, 6389760
    s_add_u32 m0, s41, 3072
    s_nop 0
    buffer_load_dwordx4 v1, s[8:11], s29 offen nt lds
    s_mov_b32 s29, 6389760
    s_add_u32 m0, s41, 4096
    s_nop 0
    buffer_load_dwordx4 v2, s[8:11], s29 offen nt lds
    s_mov_b32 s29, 6389760
    s_add_u32 m0, s41, 5120
    s_nop 0
    buffer_load_dwordx4 v3, s[8:11], s29 offen nt lds
    s_mov_b32 s29, 6488064
    s_add_u32 m0, s41, 6144
    s_nop 0
    buffer_load_dwordx4 v1, s[8:11], s29 offen nt lds
    s_mov_b32 s29, 6488064
    s_add_u32 m0, s41, 7168
    s_nop 0
    buffer_load_dwordx4 v2, s[8:11], s29 offen nt lds
    s_mov_b32 s29, 6488064
    s_add_u32 m0, s41, 8192
    s_nop 0
    buffer_load_dwordx4 v3, s[8:11], s29 offen nt lds
    s_mov_b32 s29, 6586368
    s_add_u32 m0, s41, 9216
    s_nop 0
    buffer_load_dwordx4 v1, s[8:11], s29 offen nt lds
    s_mov_b32 s29, 6586368
    s_add_u32 m0, s41, 10240
    s_nop 0
    buffer_load_dwordx4 v2, s[8:11], s29 offen nt lds
    s_mov_b32 s29, 6586368
    s_add_u32 m0, s41, 11264
    s_nop 0
    buffer_load_dwordx4 v3, s[8:11], s29 offen nt lds
    s_waitcnt vmcnt(12)
    s_barrier
    ds_read_b64_tr_b16 a[48:49], v4 offset:0
    ds_read_b64_tr_b16 a[50:51], v4 offset:1536
    ds_read_b64_tr_b16 a[128:129], v4 offset:32
    ds_read_b64_tr_b16 a[130:131], v4 offset:1568
    ds_read_b64_tr_b16 a[208:209], v4 offset:64
    ds_read_b64_tr_b16 a[210:211], v4 offset:1600
    ds_read_b64_tr_b16 a[52:53], v4 offset:12288
    ds_read_b64_tr_b16 a[54:55], v4 offset:13824
    ds_read_b64_tr_b16 a[132:133], v4 offset:12320
    ds_read_b64_tr_b16 a[134:135], v4 offset:13856
    ds_read_b64_tr_b16 a[212:213], v4 offset:12352
    ds_read_b64_tr_b16 a[214:215], v4 offset:13888
    ds_read_b64_tr_b16 a[56:57], v4 offset:24576
    ds_read_b64_tr_b16 a[58:59], v4 offset:26112
    ds_read_b64_tr_b16 a[136:137], v4 offset:24608
    ds_read_b64_tr_b16 a[138:139], v4 offset:26144
    ds_read_b64_tr_b16 a[216:217], v4 offset:24640
    ds_read_b64_tr_b16 a[218:219], v4 offset:26176
    ds_read_b64_tr_b16 a[60:61], v4 offset:36864
    ds_read_b64_tr_b16 a[62:63], v4 offset:38400
    ds_read_b64_tr_b16 a[140:141], v4 offset:36896
    ds_read_b64_tr_b16 a[142:143], v4 offset:38432
    ds_read_b64_tr_b16 a[220:221], v4 offset:36928
    ds_read_b64_tr_b16 a[222:223], v4 offset:38464
    v_subrev_u32 v4, 49152, v4
    s_waitcnt lgkmcnt(0)
    s_barrier
    s_waitcnt vmcnt(0)
    s_barrier
    ds_read_b64_tr_b16 a[64:65], v4 offset:0
    ds_read_b64_tr_b16 a[66:67], v4 offset:1536
    ds_read_b64_tr_b16 a[144:145], v4 offset:32
    ds_read_b64_tr_b16 a[146:147], v4 offset:1568
    ds_read_b64_tr_b16 a[224:225], v4 offset:64
    ds_read_b64_tr_b16 a[226:227], v4 offset:1600
    ds_read_b64_tr_b16 a[68:69], v4 offset:12288
    ds_read_b64_tr_b16 a[70:71], v4 offset:13824
    ds_read_b64_tr_b16 a[148:149], v4 offset:12320
    ds_read_b64_tr_b16 a[150:151], v4 offset:13856
    ds_read_b64_tr_b16 a[228:229], v4 offset:12352
    ds_read_b64_tr_b16 a[230:231], v4 offset:13888
    ds_read_b64_tr_b16 a[72:73], v4 offset:24576
    ds_read_b64_tr_b16 a[74:75], v4 offset:26112
    ds_read_b64_tr_b16 a[152:153], v4 offset:24608
    ds_read_b64_tr_b16 a[154:155], v4 offset:26144
    ds_read_b64_tr_b16 a[232:233], v4 offset:24640
    ds_read_b64_tr_b16 a[234:235], v4 offset:26176
    ds_read_b64_tr_b16 a[76:77], v4 offset:36864
    ds_read_b64_tr_b16 a[78:79], v4 offset:38400
    ds_read_b64_tr_b16 a[156:157], v4 offset:36896
    ds_read_b64_tr_b16 a[158:159], v4 offset:38432
    ds_read_b64_tr_b16 a[236:237], v4 offset:36928
    ds_read_b64_tr_b16 a[238:239], v4 offset:38464
    v_add_u32 v4, 49152, v4
    s_waitcnt lgkmcnt(0)
    s_barrier
    v_lshlrev_b32 v4, 4, v0
    v_mov_b32 v10, 0
    s_mov_b32 s36, 0
    s_mul_i32 s31, s17, 32
    s_add_u32 s31, s31, s20
    s_mul_i32 s39, s31, 256
    s_mul_i32 s29, s18, 128
    s_add_u32 s39, s39, s29
    s_add_u32 s39, s39, 181846016
    s_lshr_b32 s30, s16, 1
    s_and_b32 s32, s16, 1
    s_mul_i32 s37, s31, 790784
    s_mul_i32 s29, s30, 6144
    s_add_u32 s37, s37, s29
    s_mul_i32 s29, s32, 1024
    s_add_u32 s37, s37, s29
    s_add_u32 s37, s37, -12288
    s_mul_i32 s38, s31, 790784
    s_mul_i32 s29, s30, 6144
    s_add_u32 s38, s38, s29
    s_mul_i32 s29, s32, 1024
    s_add_u32 s38, s38, s29
    s_add_u32 s38, s38, -8192
    s_cmp_eq_u32 s18, 0
    s_cbranch_scc1 L_kv_st
    s_mul_i32 s37, s31, 790784
    s_mul_i32 s29, s16, 3072
    s_add_u32 s37, s37, s29
    s_add_u32 s37, s37, 50597888
L_kv_st:
    s_mov_b32 s40, s37
    s_mov_b32 s42, s38
    s_mul_i32 s37, s2, 16384
    s_add_u32 s37, s37, 188743680
    s_mov_b32 s38, s37
    s_load_dwordx2 s[8:9], s[88:89], 0
    s_mov_b32 s10, 2621440
    v_lshrrev_b32 v5, 3, v0
    v_xor_b32 v6, v5, v0
    v_and_b32 v6, 7, v6
    v_mul_u32_u24 v5, 1280, v5
    v_lshl_add_u32 v5, v6, 4, v5
    s_mul_i32 s30, s16, 10240
    v_add_u32 v1, s30, v5
    s_mul_i32 s41, s16, 5120
    v_lshrrev_b32 v5, 4, v0
    v_xor_b32 v5, v5, v0
    v_and_b32 v5, 7, v5
    v_and_b32 v6, 7, v0
    v_lshlrev_b32 v6, 7, v6
    v_lshl_add_u32 v5, v5, 4, v6
    v_bfe_u32 v6, v0, 3, 1
    v_mul_u32_u24 v6, 5120, v6
    v_add_u32 v2, v5, v6
    v_add_u32 v3, 20480, v2
    v_xor_b32 v14, 64, v2
    v_xor_b32 v15, 64, v3
    s_mov_b32 s34, 0
    s_mov_b32 s35, s41
    s_waitcnt lgkmcnt(0)
    s_add_u32 m0, s35, 0
    s_nop 0
    buffer_load_dwordx4 v1, s[8:11], s34 offen offset:0 lds
    s_add_u32 m0, s35, 896
    s_nop 0
    buffer_load_dwordx4 v1, s[8:11], s34 offen offset:128 lds
    s_add_u32 m0, s35, 1792
    s_nop 0
    buffer_load_dwordx4 v1, s[8:11], s34 offen offset:256 lds
    s_add_u32 m0, s35, 2688
    s_nop 0
    buffer_load_dwordx4 v1, s[8:11], s34 offen offset:384 lds
    s_add_u32 m0, s35, 3584
    s_nop 0
    buffer_load_dwordx4 v1, s[8:11], s34 offen offset:512 lds
    s_add_u32 s34, s34, 640
    s_add_u32 s35, s35, 20480
    s_add_u32 s29, s41, 122880
    s_cmp_ge_u32 s35, s29
    s_cselect_b32 s35, s41, s35
    s_add_u32 m0, s35, 0
    s_nop 0
    buffer_load_dwordx4 v1, s[8:11], s34 offen offset:0 lds
    s_add_u32 m0, s35, 896
    s_nop 0
    buffer_load_dwordx4 v1, s[8:11], s34 offen offset:128 lds
    s_add_u32 m0, s35, 1792
    s_nop 0
    buffer_load_dwordx4 v1, s[8:11], s34 offen offset:256 lds
    s_add_u32 m0, s35, 2688
    s_nop 0
    buffer_load_dwordx4 v1, s[8:11], s34 offen offset:384 lds
    s_add_u32 m0, s35, 3584
    s_nop 0
    buffer_load_dwordx4 v1, s[8:11], s34 offen offset:512 lds
    s_add_u32 s34, s34, 40320
    s_add_u32 s35, s35, 20480
    s_add_u32 s29, s41, 122880
    s_cmp_ge_u32 s35, s29
    s_cselect_b32 s35, s41, s35
    s_add_u32 m0, s35, 0
    s_nop 0
    buffer_load_dwordx4 v1, s[8:11], s34 offen offset:0 lds
    s_add_u32 m0, s35, 896
    s_nop 0
    buffer_load_dwordx4 v1, s[8:11], s34 offen offset:128 lds
    s_add_u32 m0, s35, 1792
    s_nop 0
    buffer_load_dwordx4 v1, s[8:11], s34 offen offset:256 lds
    s_add_u32 m0, s35, 2688
    s_nop 0
    buffer_load_dwordx4 v1, s[8:11], s34 offen offset:384 lds
    s_add_u32 m0, s35, 3584
    s_nop 0
    buffer_load_dwordx4 v1, s[8:11], s34 offen offset:512 lds
    s_add_u32 s34, s34, 640
    s_add_u32 s35, s35, 20480
    s_add_u32 s29, s41, 122880
    s_cmp_ge_u32 s35, s29
    s_cselect_b32 s35, s41, s35
    s_add_u32 m0, s35, 0
    s_nop 0
    buffer_load_dwordx4 v1, s[8:11], s34 offen offset:0 lds
    s_add_u32 m0, s35, 896
    s_nop 0
    buffer_load_dwordx4 v1, s[8:11], s34 offen offset:128 lds
    s_add_u32 m0, s35, 1792
    s_nop 0
    buffer_load_dwordx4 v1, s[8:11], s34 offen offset:256 lds
    s_add_u32 m0, s35, 2688
    s_nop 0
    buffer_load_dwordx4 v1, s[8:11], s34 offen offset:384 lds
    s_add_u32 m0, s35, 3584
    s_nop 0
    buffer_load_dwordx4 v1, s[8:11], s34 offen offset:512 lds
    s_add_u32 s34, s34, 40320
    s_add_u32 s35, s35, 20480
    s_add_u32 s29, s41, 122880
    s_cmp_ge_u32 s35, s29
    s_cselect_b32 s35, s41, s35
    s_waitcnt vmcnt(0)
    s_barrier
    ds_read_b128 v[16:19], v2 offset:0
    ds_read_b128 v[20:23], v2 offset:10240
    ds_read_b128 v[24:27], v14 offset:0
    ds_read_b128 v[28:31], v14 offset:10240
    s_cmp_eq_u32 s18, 1
    s_cbranch_scc1 L_kv1_loop
.p2align 6
L_kv0_loop:
    s_waitcnt lgkmcnt(2)
    v_mfma_f32_16x16x32_bf16 v[48:51], a[0:3], v[16:19], 0
    ds_read_b128 v[32:35], v2 offset:1024
    v_mfma_f32_16x16x32_bf16 v[52:55], a[0:3], v[20:23], 0
    v_mfma_f32_16x16x32_bf16 v[56:59], a[80:83], v[16:19], 0
    ds_read_b128 v[36:39], v2 offset:11264
    v_mfma_f32_16x16x32_bf16 v[60:63], a[80:83], v[20:23], 0
    v_mfma_f32_16x16x32_bf16 v[64:67], a[160:163], v[16:19], 0
    s_add_u32 m0, s35, 0
    s_nop 0
    buffer_load_dwordx4 v1, s[8:11], s34 offen offset:0 lds
    v_mfma_f32_16x16x32_bf16 v[68:71], a[160:163], v[20:23], 0
    s_waitcnt lgkmcnt(2)
    v_mfma_f32_16x16x32_bf16 v[48:51], a[4:7], v[24:27], v[48:51]
    ds_read_b128 v[40:43], v14 offset:1024
    v_mfma_f32_16x16x32_bf16 v[52:55], a[4:7], v[28:31], v[52:55]
    v_mfma_f32_16x16x32_bf16 v[56:59], a[84:87], v[24:27], v[56:59]
    ds_read_b128 v[44:47], v14 offset:11264
    v_mfma_f32_16x16x32_bf16 v[60:63], a[84:87], v[28:31], v[60:63]
    v_mfma_f32_16x16x32_bf16 v[64:67], a[164:167], v[24:27], v[64:67]
    s_add_u32 m0, s35, 896
    s_nop 0
    buffer_load_dwordx4 v1, s[8:11], s34 offen offset:128 lds
    v_mfma_f32_16x16x32_bf16 v[68:71], a[164:167], v[28:31], v[68:71]
    s_waitcnt lgkmcnt(2)
    v_mfma_f32_16x16x32_bf16 v[48:51], a[8:11], v[32:35], v[48:51]
    ds_read_b128 v[16:19], v2 offset:2048
    v_mfma_f32_16x16x32_bf16 v[52:55], a[8:11], v[36:39], v[52:55]
    v_mfma_f32_16x16x32_bf16 v[56:59], a[88:91], v[32:35], v[56:59]
    ds_read_b128 v[20:23], v2 offset:12288
    v_mfma_f32_16x16x32_bf16 v[60:63], a[88:91], v[36:39], v[60:63]
    v_mfma_f32_16x16x32_bf16 v[64:67], a[168:171], v[32:35], v[64:67]
    s_add_u32 m0, s35, 1792
    s_nop 0
    buffer_load_dwordx4 v1, s[8:11], s34 offen offset:256 lds
    v_mfma_f32_16x16x32_bf16 v[68:71], a[168:171], v[36:39], v[68:71]
    s_waitcnt lgkmcnt(2)
    v_mfma_f32_16x16x32_bf16 v[48:51], a[12:15], v[40:43], v[48:51]
    ds_read_b128 v[24:27], v14 offset:2048
    v_mfma_f32_16x16x32_bf16 v[52:55], a[12:15], v[44:47], v[52:55]
    v_mfma_f32_16x16x32_bf16 v[56:59], a[92:95], v[40:43], v[56:59]
    ds_read_b128 v[28:31], v14 offset:12288
    v_mfma_f32_16x16x32_bf16 v[60:63], a[92:95], v[44:47], v[60:63]
    v_mfma_f32_16x16x32_bf16 v[64:67], a[172:175], v[40:43], v[64:67]
    s_add_u32 m0, s35, 2688
    s_nop 0
    buffer_load_dwordx4 v1, s[8:11], s34 offen offset:384 lds
    v_mfma_f32_16x16x32_bf16 v[68:71], a[172:175], v[44:47], v[68:71]
    s_waitcnt lgkmcnt(2)
    v_mfma_f32_16x16x32_bf16 v[48:51], a[16:19], v[16:19], v[48:51]
    ds_read_b128 v[32:35], v2 offset:3072
    v_mfma_f32_16x16x32_bf16 v[52:55], a[16:19], v[20:23], v[52:55]
    v_mfma_f32_16x16x32_bf16 v[56:59], a[96:99], v[16:19], v[56:59]
    ds_read_b128 v[36:39], v2 offset:13312
    v_mfma_f32_16x16x32_bf16 v[60:63], a[96:99], v[20:23], v[60:63]
    v_mfma_f32_16x16x32_bf16 v[64:67], a[176:179], v[16:19], v[64:67]
    s_add_u32 m0, s35, 3584
    s_nop 0
    buffer_load_dwordx4 v1, s[8:11], s34 offen offset:512 lds
    s_add_u32 s34, s34, 640
    s_add_u32 s35, s35, 20480
    s_add_u32 s29, s41, 122880
    s_cmp_ge_u32 s35, s29
    s_cselect_b32 s35, s41, s35
    v_mfma_f32_16x16x32_bf16 v[68:71], a[176:179], v[20:23], v[68:71]
    s_waitcnt lgkmcnt(2)
    v_mfma_f32_16x16x32_bf16 v[48:51], a[20:23], v[24:27], v[48:51]
    ds_read_b128 v[40:43], v14 offset:3072
    v_mfma_f32_16x16x32_bf16 v[52:55], a[20:23], v[28:31], v[52:55]
    v_mfma_f32_16x16x32_bf16 v[56:59], a[100:103], v[24:27], v[56:59]
    ds_read_b128 v[44:47], v14 offset:13312
    v_mfma_f32_16x16x32_bf16 v[60:63], a[100:103], v[28:31], v[60:63]
    v_mfma_f32_16x16x32_bf16 v[64:67], a[180:183], v[24:27], v[64:67]
    v_mfma_f32_16x16x32_bf16 v[68:71], a[180:183], v[28:31], v[68:71]
    buffer_store_dwordx4 v[72:75], v4, s[4:7], s37 offen offset:0 sc1
    buffer_store_dwordx4 v[76:79], v4, s[4:7], s37 offen offset:2048 sc1
    s_waitcnt lgkmcnt(2)
    v_mfma_f32_16x16x32_bf16 v[48:51], a[24:27], v[32:35], v[48:51]
    ds_read_b128 v[16:19], v2 offset:4096
    v_mfma_f32_16x16x32_bf16 v[52:55], a[24:27], v[36:39], v[52:55]
    v_mfma_f32_16x16x32_bf16 v[56:59], a[104:107], v[32:35], v[56:59]
    ds_read_b128 v[20:23], v2 offset:14336
    v_mfma_f32_16x16x32_bf16 v[60:63], a[104:107], v[36:39], v[60:63]
    v_mfma_f32_16x16x32_bf16 v[64:67], a[184:187], v[32:35], v[64:67]
    v_mfma_f32_16x16x32_bf16 v[68:71], a[184:187], v[36:39], v[68:71]
    buffer_store_dwordx4 v[80:83], v4, s[4:7], s38 offen offset:0 sc1
    s_waitcnt lgkmcnt(2)
    v_mfma_f32_16x16x32_bf16 v[48:51], a[28:31], v[40:43], v[48:51]
    ds_read_b128 v[24:27], v14 offset:4096
    v_mfma_f32_16x16x32_bf16 v[52:55], a[28:31], v[44:47], v[52:55]
    v_mfma_f32_16x16x32_bf16 v[56:59], a[108:111], v[40:43], v[56:59]
    ds_read_b128 v[28:31], v14 offset:14336
    v_mfma_f32_16x16x32_bf16 v[60:63], a[108:111], v[44:47], v[60:63]
    v_mfma_f32_16x16x32_bf16 v[64:67], a[188:191], v[40:43], v[64:67]
    v_mfma_f32_16x16x32_bf16 v[68:71], a[188:191], v[44:47], v[68:71]
    s_waitcnt vmcnt(21)
    s_barrier
    v_add_u32 v2, 40960, v2
    v_subrev_u32 v12, 122880, v2
    v_min_u32 v2, v2, v12
    v_xor_b32 v14, 64, v2
    s_waitcnt lgkmcnt(2)
    v_mfma_f32_16x16x32_bf16 v[48:51], a[32:35], v[16:19], v[48:51]
    ds_read_b128 v[32:35], v3 offset:0
    v_mfma_f32_16x16x32_bf16 v[52:55], a[32:35], v[20:23], v[52:55]
    v_mfma_f32_16x16x32_bf16 v[56:59], a[112:115], v[16:19], v[56:59]
    ds_read_b128 v[36:39], v3 offset:10240
    v_mfma_f32_16x16x32_bf16 v[60:63], a[112:115], v[20:23], v[60:63]
    v_mfma_f32_16x16x32_bf16 v[64:67], a[192:195], v[16:19], v[64:67]
    v_mfma_f32_16x16x32_bf16 v[68:71], a[192:195], v[20:23], v[68:71]
    s_waitcnt lgkmcnt(2)
    v_mfma_f32_16x16x32_bf16 v[48:51], a[36:39], v[24:27], v[48:51]
    ds_read_b128 v[40:43], v15 offset:0
    v_mfma_f32_16x16x32_bf16 v[52:55], a[36:39], v[28:31], v[52:55]
    v_mfma_f32_16x16x32_bf16 v[56:59], a[116:119], v[24:27], v[56:59]
    ds_read_b128 v[44:47], v15 offset:10240
    v_mfma_f32_16x16x32_bf16 v[60:63], a[116:119], v[28:31], v[60:63]
    v_mfma_f32_16x16x32_bf16 v[64:67], a[196:199], v[24:27], v[64:67]
    v_mfma_f32_16x16x32_bf16 v[68:71], a[196:199], v[28:31], v[68:71]
    s_waitcnt lgkmcnt(2)
    v_mfma_f32_16x16x32_bf16 v[48:51], a[40:43], v[32:35], v[48:51]
    ds_read_b128 v[16:19], v3 offset:1024
    v_mfma_f32_16x16x32_bf16 v[52:55], a[40:43], v[36:39], v[52:55]
    v_mfma_f32_16x16x32_bf16 v[56:59], a[120:123], v[32:35], v[56:59]
    ds_read_b128 v[20:23], v3 offset:11264
    v_mfma_f32_16x16x32_bf16 v[60:63], a[120:123], v[36:39], v[60:63]
    v_mfma_f32_16x16x32_bf16 v[64:67], a[200:203], v[32:35], v[64:67]
    s_add_u32 m0, s35, 0
    s_nop 0
    buffer_load_dwordx4 v1, s[8:11], s34 offen offset:0 lds
    v_mfma_f32_16x16x32_bf16 v[68:71], a[200:203], v[36:39], v[68:71]
    s_waitcnt lgkmcnt(2)
    v_mfma_f32_16x16x32_bf16 v[48:51], a[44:47], v[40:43], v[48:51]
    ds_read_b128 v[24:27], v15 offset:1024
    v_mfma_f32_16x16x32_bf16 v[52:55], a[44:47], v[44:47], v[52:55]
    v_mfma_f32_16x16x32_bf16 v[56:59], a[124:127], v[40:43], v[56:59]
    ds_read_b128 v[28:31], v15 offset:11264
    v_mfma_f32_16x16x32_bf16 v[60:63], a[124:127], v[44:47], v[60:63]
    v_mfma_f32_16x16x32_bf16 v[64:67], a[204:207], v[40:43], v[64:67]
    s_add_u32 m0, s35, 896
    s_nop 0
    buffer_load_dwordx4 v1, s[8:11], s34 offen offset:128 lds
    v_mfma_f32_16x16x32_bf16 v[68:71], a[204:207], v[44:47], v[68:71]
    s_waitcnt lgkmcnt(2)
    v_mfma_f32_16x16x32_bf16 v[48:51], a[48:51], v[16:19], v[48:51]
    ds_read_b128 v[32:35], v3 offset:2048
    v_mfma_f32_16x16x32_bf16 v[52:55], a[48:51], v[20:23], v[52:55]
    v_mfma_f32_16x16x32_bf16 v[56:59], a[128:131], v[16:19], v[56:59]
    ds_read_b128 v[36:39], v3 offset:12288
    v_mfma_f32_16x16x32_bf16 v[60:63], a[128:131], v[20:23], v[60:63]
    v_mfma_f32_16x16x32_bf16 v[64:67], a[208:211], v[16:19], v[64:67]
    s_add_u32 m0, s35, 1792
    s_nop 0
    buffer_load_dwordx4 v1, s[8:11], s34 offen offset:256 lds
    v_mfma_f32_16x16x32_bf16 v[68:71], a[208:211], v[20:23], v[68:71]
    s_waitcnt lgkmcnt(2)
    v_mfma_f32_16x16x32_bf16 v[48:51], a[52:55], v[24:27], v[48:51]
    ds_read_b128 v[40:43], v15 offset:2048
    v_mfma_f32_16x16x32_bf16 v[52:55], a[52:55], v[28:31], v[52:55]
    v_mfma_f32_16x16x32_bf16 v[56:59], a[132:135], v[24:27], v[56:59]
    ds_read_b128 v[44:47], v15 offset:12288
    v_mfma_f32_16x16x32_bf16 v[60:63], a[132:135], v[28:31], v[60:63]
    v_mfma_f32_16x16x32_bf16 v[64:67], a[212:215], v[24:27], v[64:67]
    s_add_u32 m0, s35, 2688
    s_nop 0
    buffer_load_dwordx4 v1, s[8:11], s34 offen offset:384 lds
    v_mfma_f32_16x16x32_bf16 v[68:71], a[212:215], v[28:31], v[68:71]
    s_waitcnt lgkmcnt(2)
    v_mfma_f32_16x16x32_bf16 v[48:51], a[56:59], v[32:35], v[48:51]
    ds_read_b128 v[16:19], v3 offset:3072
    v_mfma_f32_16x16x32_bf16 v[52:55], a[56:59], v[36:39], v[52:55]
    v_mfma_f32_16x16x32_bf16 v[56:59], a[136:139], v[32:35], v[56:59]
    ds_read_b128 v[20:23], v3 offset:13312
    v_mfma_f32_16x16x32_bf16 v[60:63], a[136:139], v[36:39], v[60:63]
    v_mfma_f32_16x16x32_bf16 v[64:67], a[216:219], v[32:35], v[64:67]
    s_add_u32 m0, s35, 3584
    s_nop 0
    buffer_load_dwordx4 v1, s[8:11], s34 offen offset:512 lds
    s_add_u32 s34, s34, 40320
    s_add_u32 s35, s35, 20480
    s_add_u32 s29, s41, 122880
    s_cmp_ge_u32 s35, s29
    s_cselect_b32 s35, s41, s35
    v_mfma_f32_16x16x32_bf16 v[68:71], a[216:219], v[36:39], v[68:71]
    s_waitcnt lgkmcnt(2)
    v_mfma_f32_16x16x32_bf16 v[48:51], a[60:63], v[40:43], v[48:51]
    ds_read_b128 v[24:27], v15 offset:3072
    v_mfma_f32_16x16x32_bf16 v[52:55], a[60:63], v[44:47], v[52:55]
    v_mfma_f32_16x16x32_bf16 v[56:59], a[140:143], v[40:43], v[56:59]
    ds_read_b128 v[28:31], v15 offset:13312
    v_mfma_f32_16x16x32_bf16 v[60:63], a[140:143], v[44:47], v[60:63]
    v_mfma_f32_16x16x32_bf16 v[64:67], a[220:223], v[40:43], v[64:67]
    v_mfma_f32_16x16x32_bf16 v[68:71], a[220:223], v[44:47], v[68:71]
    s_waitcnt lgkmcnt(2)
    v_mfma_f32_16x16x32_bf16 v[48:51], a[64:67], v[16:19], v[48:51]
    ds_read_b128 v[32:35], v3 offset:4096
    v_mfma_f32_16x16x32_bf16 v[52:55], a[64:67], v[20:23], v[52:55]
    v_mfma_f32_16x16x32_bf16 v[56:59], a[144:147], v[16:19], v[56:59]
    ds_read_b128 v[36:39], v3 offset:14336
    v_mfma_f32_16x16x32_bf16 v[60:63], a[144:147], v[20:23], v[60:63]
    v_mfma_f32_16x16x32_bf16 v[64:67], a[224:227], v[16:19], v[64:67]
    v_mfma_f32_16x16x32_bf16 v[68:71], a[224:227], v[20:23], v[68:71]
    s_waitcnt lgkmcnt(2)
    v_mfma_f32_16x16x32_bf16 v[48:51], a[68:71], v[24:27], v[48:51]
    ds_read_b128 v[40:43], v15 offset:4096
    v_mfma_f32_16x16x32_bf16 v[52:55], a[68:71], v[28:31], v[52:55]
    v_mfma_f32_16x16x32_bf16 v[56:59], a[148:151], v[24:27], v[56:59]
    ds_read_b128 v[44:47], v15 offset:14336
    v_mfma_f32_16x16x32_bf16 v[60:63], a[148:151], v[28:31], v[60:63]
    v_mfma_f32_16x16x32_bf16 v[64:67], a[228:231], v[24:27], v[64:67]
    v_mfma_f32_16x16x32_bf16 v[68:71], a[228:231], v[28:31], v[68:71]
    s_cmp_ge_u32 s36, 6
    s_cbranch_scc1 L_56
    s_waitcnt vmcnt(5)
    L_56:
    s_waitcnt vmcnt(18)
    s_barrier
    v_add_u32 v3, 40960, v3
    v_subrev_u32 v12, 122880, v3
    v_min_u32 v3, v3, v12
    v_xor_b32 v15, 64, v3
    s_waitcnt lgkmcnt(2)
    v_mfma_f32_16x16x32_bf16 v[48:51], a[72:75], v[32:35], v[48:51]
    ds_read_b128 v[16:19], v2 offset:0
    v_mfma_f32_16x16x32_bf16 v[52:55], a[72:75], v[36:39], v[52:55]
    v_mfma_f32_16x16x32_bf16 v[56:59], a[152:155], v[32:35], v[56:59]
    ds_read_b128 v[20:23], v2 offset:10240
    v_mfma_f32_16x16x32_bf16 v[60:63], a[152:155], v[36:39], v[60:63]
    v_mfma_f32_16x16x32_bf16 v[64:67], a[232:235], v[32:35], v[64:67]
    v_mfma_f32_16x16x32_bf16 v[68:71], a[232:235], v[36:39], v[68:71]
    s_cmp_lg_u32 s16, 0
    s_cbranch_scc1 L_55
    s_cmp_lt_u32 s36, 1
    s_cbranch_scc1 L_55
    s_cmp_lt_u32 s36, 6
    s_cselect_b32 s29, 0, 1
    s_sub_u32 s29, s36, s29
    v_mov_b32 v11, s29
    s_mov_b64 exec, 1
    buffer_store_dword v11, v10, s[4:7], s39 offen sc1
    s_mov_b64 exec, -1
    L_55:
    s_waitcnt lgkmcnt(2)
    v_mfma_f32_16x16x32_bf16 v[48:51], a[76:79], v[40:43], v[48:51]
    ds_read_b128 v[24:27], v14 offset:0
    v_mfma_f32_16x16x32_bf16 v[52:55], a[76:79], v[44:47], v[52:55]
    v_mfma_f32_16x16x32_bf16 v[56:59], a[156:159], v[40:43], v[56:59]
    ds_read_b128 v[28:31], v14 offset:10240
    v_mfma_f32_16x16x32_bf16 v[60:63], a[156:159], v[44:47], v[60:63]
    v_mfma_f32_16x16x32_bf16 v[64:67], a[236:239], v[40:43], v[64:67]
    v_mfma_f32_16x16x32_bf16 v[68:71], a[236:239], v[44:47], v[68:71]
    s_cmp_eq_u32 s36, 0
    s_cselect_b32 s37, s40, s37
    s_cselect_b32 s38, s42, s38
    s_add_u32 s37, s37, 12288
    s_add_u32 s38, s38, 12288
    s_add_u32 s36, s36, 1
    s_nop 1
    v_cvt_pk_bf16_f32 v72, v48, v49
    v_cvt_pk_bf16_f32 v73, v50, v51
    v_cvt_pk_bf16_f32 v76, v52, v53
    v_cvt_pk_bf16_f32 v77, v54, v55
    v_cvt_pk_bf16_f32 v74, v56, v57
    v_cvt_pk_bf16_f32 v75, v58, v59
    v_cvt_pk_bf16_f32 v78, v60, v61
    v_cvt_pk_bf16_f32 v79, v62, v63
    v_cvt_pk_bf16_f32 v80, v64, v65
    v_cvt_pk_bf16_f32 v81, v66, v67
    v_cvt_pk_bf16_f32 v82, v68, v69
    v_cvt_pk_bf16_f32 v83, v70, v71
    s_cmp_lt_u32 s36, 64
    s_cbranch_scc1 L_kv0_loop
    buffer_store_dwordx4 v[72:75], v4, s[4:7], s37 offen offset:0 sc1
    buffer_store_dwordx4 v[76:79], v4, s[4:7], s37 offen offset:2048 sc1
    buffer_store_dwordx4 v[80:83], v4, s[4:7], s38 offen offset:0 sc1
    s_branch L_kv_fin
.p2align 6
L_kv1_loop:
    s_waitcnt lgkmcnt(2)
    v_mfma_f32_16x16x32_bf16 v[48:51], v[16:19], a[0:3], 0
    ds_read_b128 v[32:35], v2 offset:1024
    v_mfma_f32_16x16x32_bf16 v[52:55], v[20:23], a[0:3], 0
    v_mfma_f32_16x16x32_bf16 v[56:59], v[16:19], a[80:83], 0
    ds_read_b128 v[36:39], v2 offset:11264
    v_mfma_f32_16x16x32_bf16 v[60:63], v[20:23], a[80:83], 0
    v_mfma_f32_16x16x32_bf16 v[64:67], v[16:19], a[160:163], 0
    s_add_u32 m0, s35, 0
    s_nop 0
    buffer_load_dwordx4 v1, s[8:11], s34 offen offset:0 lds
    v_mfma_f32_16x16x32_bf16 v[68:71], v[20:23], a[160:163], 0
    s_waitcnt lgkmcnt(2)
    v_mfma_f32_16x16x32_bf16 v[48:51], v[24:27], a[4:7], v[48:51]
    ds_read_b128 v[40:43], v14 offset:1024
    v_mfma_f32_16x16x32_bf16 v[52:55], v[28:31], a[4:7], v[52:55]
    v_mfma_f32_16x16x32_bf16 v[56:59], v[24:27], a[84:87], v[56:59]
    ds_read_b128 v[44:47], v14 offset:11264
    v_mfma_f32_16x16x32_bf16 v[60:63], v[28:31], a[84:87], v[60:63]
    v_mfma_f32_16x16x32_bf16 v[64:67], v[24:27], a[164:167], v[64:67]
    s_add_u32 m0, s35, 896
    s_nop 0
    buffer_load_dwordx4 v1, s[8:11], s34 offen offset:128 lds
    v_mfma_f32_16x16x32_bf16 v[68:71], v[28:31], a[164:167], v[68:71]
    s_waitcnt lgkmcnt(2)
    v_mfma_f32_16x16x32_bf16 v[48:51], v[32:35], a[8:11], v[48:51]
    ds_read_b128 v[16:19], v2 offset:2048
    v_mfma_f32_16x16x32_bf16 v[52:55], v[36:39], a[8:11], v[52:55]
    v_mfma_f32_16x16x32_bf16 v[56:59], v[32:35], a[88:91], v[56:59]
    ds_read_b128 v[20:23], v2 offset:12288
    v_mfma_f32_16x16x32_bf16 v[60:63], v[36:39], a[88:91], v[60:63]
    v_mfma_f32_16x16x32_bf16 v[64:67], v[32:35], a[168:171], v[64:67]
    s_add_u32 m0, s35, 1792
    s_nop 0
    buffer_load_dwordx4 v1, s[8:11], s34 offen offset:256 lds
    v_mfma_f32_16x16x32_bf16 v[68:71], v[36:39], a[168:171], v[68:71]
    s_waitcnt lgkmcnt(2)
    v_mfma_f32_16x16x32_bf16 v[48:51], v[40:43], a[12:15], v[48:51]
    ds_read_b128 v[24:27], v14 offset:2048
    v_mfma_f32_16x16x32_bf16 v[52:55], v[44:47], a[12:15], v[52:55]
    v_mfma_f32_16x16x32_bf16 v[56:59], v[40:43], a[92:95], v[56:59]
    ds_read_b128 v[28:31], v14 offset:12288
    v_mfma_f32_16x16x32_bf16 v[60:63], v[44:47], a[92:95], v[60:63]
    v_mfma_f32_16x16x32_bf16 v[64:67], v[40:43], a[172:175], v[64:67]
    s_add_u32 m0, s35, 2688
    s_nop 0
    buffer_load_dwordx4 v1, s[8:11], s34 offen offset:384 lds
    v_mfma_f32_16x16x32_bf16 v[68:71], v[44:47], a[172:175], v[68:71]
    s_waitcnt lgkmcnt(2)
    v_mfma_f32_16x16x32_bf16 v[48:51], v[16:19], a[16:19], v[48:51]
    ds_read_b128 v[32:35], v2 offset:3072
    v_mfma_f32_16x16x32_bf16 v[52:55], v[20:23], a[16:19], v[52:55]
    v_mfma_f32_16x16x32_bf16 v[56:59], v[16:19], a[96:99], v[56:59]
    ds_read_b128 v[36:39], v2 offset:13312
    v_mfma_f32_16x16x32_bf16 v[60:63], v[20:23], a[96:99], v[60:63]
    v_mfma_f32_16x16x32_bf16 v[64:67], v[16:19], a[176:179], v[64:67]
    s_add_u32 m0, s35, 3584
    s_nop 0
    buffer_load_dwordx4 v1, s[8:11], s34 offen offset:512 lds
    s_add_u32 s34, s34, 640
    s_add_u32 s35, s35, 20480
    s_add_u32 s29, s41, 122880
    s_cmp_ge_u32 s35, s29
    s_cselect_b32 s35, s41, s35
    v_mfma_f32_16x16x32_bf16 v[68:71], v[20:23], a[176:179], v[68:71]
    s_waitcnt lgkmcnt(2)
    v_mfma_f32_16x16x32_bf16 v[48:51], v[24:27], a[20:23], v[48:51]
    ds_read_b128 v[40:43], v14 offset:3072
    v_mfma_f32_16x16x32_bf16 v[52:55], v[28:31], a[20:23], v[52:55]
    v_mfma_f32_16x16x32_bf16 v[56:59], v[24:27], a[100:103], v[56:59]
    ds_read_b128 v[44:47], v14 offset:13312
    v_mfma_f32_16x16x32_bf16 v[60:63], v[28:31], a[100:103], v[60:63]
    v_mfma_f32_16x16x32_bf16 v[64:67], v[24:27], a[180:183], v[64:67]
    v_mfma_f32_16x16x32_bf16 v[68:71], v[28:31], a[180:183], v[68:71]
    buffer_store_dwordx4 v[72:75], v4, s[4:7], s37 offen offset:0 sc1
    buffer_store_dwordx4 v[76:79], v4, s[4:7], s37 offen offset:1024 sc1
    s_waitcnt lgkmcnt(2)
    v_mfma_f32_16x16x32_bf16 v[48:51], v[32:35], a[24:27], v[48:51]
    ds_read_b128 v[16:19], v2 offset:4096
    v_mfma_f32_16x16x32_bf16 v[52:55], v[36:39], a[24:27], v[52:55]
    v_mfma_f32_16x16x32_bf16 v[56:59], v[32:35], a[104:107], v[56:59]
    ds_read_b128 v[20:23], v2 offset:14336
    v_mfma_f32_16x16x32_bf16 v[60:63], v[36:39], a[104:107], v[60:63]
    v_mfma_f32_16x16x32_bf16 v[64:67], v[32:35], a[184:187], v[64:67]
    v_mfma_f32_16x16x32_bf16 v[68:71], v[36:39], a[184:187], v[68:71]
    buffer_store_dwordx4 v[80:83], v4, s[4:7], s37 offen offset:2048 sc1
    s_waitcnt lgkmcnt(2)
    v_mfma_f32_16x16x32_bf16 v[48:51], v[40:43], a[28:31], v[48:51]
    ds_read_b128 v[24:27], v14 offset:4096
    v_mfma_f32_16x16x32_bf16 v[52:55], v[44:47], a[28:31], v[52:55]
    v_mfma_f32_16x16x32_bf16 v[56:59], v[40:43], a[108:111], v[56:59]
    ds_read_b128 v[28:31], v14 offset:14336
    v_mfma_f32_16x16x32_bf16 v[60:63], v[44:47], a[108:111], v[60:63]
    v_mfma_f32_16x16x32_bf16 v[64:67], v[40:43], a[188:191], v[64:67]
    v_mfma_f32_16x16x32_bf16 v[68:71], v[44:47], a[188:191], v[68:71]
    s_waitcnt vmcnt(21)
    s_barrier
    v_add_u32 v2, 40960, v2
    v_subrev_u32 v12, 122880, v2
    v_min_u32 v2, v2, v12
    v_xor_b32 v14, 64, v2
    s_waitcnt lgkmcnt(2)
    v_mfma_f32_16x16x32_bf16 v[48:51], v[16:19], a[32:35], v[48:51]
    ds_read_b128 v[32:35], v3 offset:0
    v_mfma_f32_16x16x32_bf16 v[52:55], v[20:23], a[32:35], v[52:55]
    v_mfma_f32_16x16x32_bf16 v[56:59], v[16:19], a[112:115], v[56:59]
    ds_read_b128 v[36:39], v3 offset:10240
    v_mfma_f32_16x16x32_bf16 v[60:63], v[20:23], a[112:115], v[60:63]
    v_mfma_f32_16x16x32_bf16 v[64:67], v[16:19], a[192:195], v[64:67]
    v_mfma_f32_16x16x32_bf16 v[68:71], v[20:23], a[192:195], v[68:71]
    s_waitcnt lgkmcnt(2)
    v_mfma_f32_16x16x32_bf16 v[48:51], v[24:27], a[36:39], v[48:51]
    ds_read_b128 v[40:43], v15 offset:0
    v_mfma_f32_16x16x32_bf16 v[52:55], v[28:31], a[36:39], v[52:55]
    v_mfma_f32_16x16x32_bf16 v[56:59], v[24:27], a[116:119], v[56:59]
    ds_read_b128 v[44:47], v15 offset:10240
    v_mfma_f32_16x16x32_bf16 v[60:63], v[28:31], a[116:119], v[60:63]
    v_mfma_f32_16x16x32_bf16 v[64:67], v[24:27], a[196:199], v[64:67]
    v_mfma_f32_16x16x32_bf16 v[68:71], v[28:31], a[196:199], v[68:71]
    s_waitcnt lgkmcnt(2)
    v_mfma_f32_16x16x32_bf16 v[48:51], v[32:35], a[40:43], v[48:51]
    ds_read_b128 v[16:19], v3 offset:1024
    v_mfma_f32_16x16x32_bf16 v[52:55], v[36:39], a[40:43], v[52:55]
    v_mfma_f32_16x16x32_bf16 v[56:59], v[32:35], a[120:123], v[56:59]
    ds_read_b128 v[20:23], v3 offset:11264
    v_mfma_f32_16x16x32_bf16 v[60:63], v[36:39], a[120:123], v[60:63]
    v_mfma_f32_16x16x32_bf16 v[64:67], v[32:35], a[200:203], v[64:67]
    s_add_u32 m0, s35, 0
    s_nop 0
    buffer_load_dwordx4 v1, s[8:11], s34 offen offset:0 lds
    v_mfma_f32_16x16x32_bf16 v[68:71], v[36:39], a[200:203], v[68:71]
    s_waitcnt lgkmcnt(2)
    v_mfma_f32_16x16x32_bf16 v[48:51], v[40:43], a[44:47], v[48:51]
    ds_read_b128 v[24:27], v15 offset:1024
    v_mfma_f32_16x16x32_bf16 v[52:55], v[44:47], a[44:47], v[52:55]
    v_mfma_f32_16x16x32_bf16 v[56:59], v[40:43], a[124:127], v[56:59]
    ds_read_b128 v[28:31], v15 offset:11264
    v_mfma_f32_16x16x32_bf16 v[60:63], v[44:47], a[124:127], v[60:63]
    v_mfma_f32_16x16x32_bf16 v[64:67], v[40:43], a[204:207], v[64:67]
    s_add_u32 m0, s35, 896
    s_nop 0
    buffer_load_dwordx4 v1, s[8:11], s34 offen offset:128 lds
    v_mfma_f32_16x16x32_bf16 v[68:71], v[44:47], a[204:207], v[68:71]
    s_waitcnt lgkmcnt(2)
    v_mfma_f32_16x16x32_bf16 v[48:51], v[16:19], a[48:51], v[48:51]
    ds_read_b128 v[32:35], v3 offset:2048
    v_mfma_f32_16x16x32_bf16 v[52:55], v[20:23], a[48:51], v[52:55]
    v_mfma_f32_16x16x32_bf16 v[56:59], v[16:19], a[128:131], v[56:59]
    ds_read_b128 v[36:39], v3 offset:12288
    v_mfma_f32_16x16x32_bf16 v[60:63], v[20:23], a[128:131], v[60:63]
    v_mfma_f32_16x16x32_bf16 v[64:67], v[16:19], a[208:211], v[64:67]
    s_add_u32 m0, s35, 1792
    s_nop 0
    buffer_load_dwordx4 v1, s[8:11], s34 offen offset:256 lds
    v_mfma_f32_16x16x32_bf16 v[68:71], v[20:23], a[208:211], v[68:71]
    s_waitcnt lgkmcnt(2)
    v_mfma_f32_16x16x32_bf16 v[48:51], v[24:27], a[52:55], v[48:51]
    ds_read_b128 v[40:43], v15 offset:2048
    v_mfma_f32_16x16x32_bf16 v[52:55], v[28:31], a[52:55], v[52:55]
    v_mfma_f32_16x16x32_bf16 v[56:59], v[24:27], a[132:135], v[56:59]
    ds_read_b128 v[44:47], v15 offset:12288
    v_mfma_f32_16x16x32_bf16 v[60:63], v[28:31], a[132:135], v[60:63]
    v_mfma_f32_16x16x32_bf16 v[64:67], v[24:27], a[212:215], v[64:67]
    s_add_u32 m0, s35, 2688
    s_nop 0
    buffer_load_dwordx4 v1, s[8:11], s34 offen offset:384 lds
    v_mfma_f32_16x16x32_bf16 v[68:71], v[28:31], a[212:215], v[68:71]
    s_waitcnt lgkmcnt(2)
    v_mfma_f32_16x16x32_bf16 v[48:51], v[32:35], a[56:59], v[48:51]
    ds_read_b128 v[16:19], v3 offset:3072
    v_mfma_f32_16x16x32_bf16 v[52:55], v[36:39], a[56:59], v[52:55]
    v_mfma_f32_16x16x32_bf16 v[56:59], v[32:35], a[136:139], v[56:59]
    ds_read_b128 v[20:23], v3 offset:13312
    v_mfma_f32_16x16x32_bf16 v[60:63], v[36:39], a[136:139], v[60:63]
    v_mfma_f32_16x16x32_bf16 v[64:67], v[32:35], a[216:219], v[64:67]
    s_add_u32 m0, s35, 3584
    s_nop 0
    buffer_load_dwordx4 v1, s[8:11], s34 offen offset:512 lds
    s_add_u32 s34, s34, 40320
    s_add_u32 s35, s35, 20480
    s_add_u32 s29, s41, 122880
    s_cmp_ge_u32 s35, s29
    s_cselect_b32 s35, s41, s35
    v_mfma_f32_16x16x32_bf16 v[68:71], v[36:39], a[216:219], v[68:71]
    s_waitcnt lgkmcnt(2)
    v_mfma_f32_16x16x32_bf16 v[48:51], v[40:43], a[60:63], v[48:51]
    ds_read_b128 v[24:27], v15 offset:3072
    v_mfma_f32_16x16x32_bf16 v[52:55], v[44:47], a[60:63], v[52:55]
    v_mfma_f32_16x16x32_bf16 v[56:59], v[40:43], a[140:143], v[56:59]
    ds_read_b128 v[28:31], v15 offset:13312
    v_mfma_f32_16x16x32_bf16 v[60:63], v[44:47], a[140:143], v[60:63]
    v_mfma_f32_16x16x32_bf16 v[64:67], v[40:43], a[220:223], v[64:67]
    v_mfma_f32_16x16x32_bf16 v[68:71], v[44:47], a[220:223], v[68:71]
    s_waitcnt lgkmcnt(2)
    v_mfma_f32_16x16x32_bf16 v[48:51], v[16:19], a[64:67], v[48:51]
    ds_read_b128 v[32:35], v3 offset:4096
    v_mfma_f32_16x16x32_bf16 v[52:55], v[20:23], a[64:67], v[52:55]
    v_mfma_f32_16x16x32_bf16 v[56:59], v[16:19], a[144:147], v[56:59]
    ds_read_b128 v[36:39], v3 offset:14336
    v_mfma_f32_16x16x32_bf16 v[60:63], v[20:23], a[144:147], v[60:63]
    v_mfma_f32_16x16x32_bf16 v[64:67], v[16:19], a[224:227], v[64:67]
    v_mfma_f32_16x16x32_bf16 v[68:71], v[20:23], a[224:227], v[68:71]
    s_waitcnt lgkmcnt(2)
    v_mfma_f32_16x16x32_bf16 v[48:51], v[24:27], a[68:71], v[48:51]
    ds_read_b128 v[40:43], v15 offset:4096
    v_mfma_f32_16x16x32_bf16 v[52:55], v[28:31], a[68:71], v[52:55]
    v_mfma_f32_16x16x32_bf16 v[56:59], v[24:27], a[148:151], v[56:59]
    ds_read_b128 v[44:47], v15 offset:14336
    v_mfma_f32_16x16x32_bf16 v[60:63], v[28:31], a[148:151], v[60:63]
    v_mfma_f32_16x16x32_bf16 v[64:67], v[24:27], a[228:231], v[64:67]
    v_mfma_f32_16x16x32_bf16 v[68:71], v[28:31], a[228:231], v[68:71]
    s_cmp_ge_u32 s36, 6
    s_cbranch_scc1 L_58
    s_waitcnt vmcnt(5)
    L_58:
    s_waitcnt vmcnt(18)
    s_barrier
    v_add_u32 v3, 40960, v3
    v_subrev_u32 v12, 122880, v3
    v_min_u32 v3, v3, v12
    v_xor_b32 v15, 64, v3
    s_waitcnt lgkmcnt(2)
    v_mfma_f32_16x16x32_bf16 v[48:51], v[32:35], a[72:75], v[48:51]
    ds_read_b128 v[16:19], v2 offset:0
    v_mfma_f32_16x16x32_bf16 v[52:55], v[36:39], a[72:75], v[52:55]
    v_mfma_f32_16x16x32_bf16 v[56:59], v[32:35], a[152:155], v[56:59]
    ds_read_b128 v[20:23], v2 offset:10240
    v_mfma_f32_16x16x32_bf16 v[60:63], v[36:39], a[152:155], v[60:63]
    v_mfma_f32_16x16x32_bf16 v[64:67], v[32:35], a[232:235], v[64:67]
    v_mfma_f32_16x16x32_bf16 v[68:71], v[36:39], a[232:235], v[68:71]
    s_cmp_lg_u32 s16, 0
    s_cbranch_scc1 L_57
    s_cmp_lt_u32 s36, 1
    s_cbranch_scc1 L_57
    s_cmp_lt_u32 s36, 6
    s_cselect_b32 s29, 0, 1
    s_sub_u32 s29, s36, s29
    v_mov_b32 v11, s29
    s_mov_b64 exec, 1
    buffer_store_dword v11, v10, s[4:7], s39 offen sc1
    s_mov_b64 exec, -1
    L_57:
    s_waitcnt lgkmcnt(2)
    v_mfma_f32_16x16x32_bf16 v[48:51], v[40:43], a[76:79], v[48:51]
    ds_read_b128 v[24:27], v14 offset:0
    v_mfma_f32_16x16x32_bf16 v[52:55], v[44:47], a[76:79], v[52:55]
    v_mfma_f32_16x16x32_bf16 v[56:59], v[40:43], a[156:159], v[56:59]
    ds_read_b128 v[28:31], v14 offset:10240
    v_mfma_f32_16x16x32_bf16 v[60:63], v[44:47], a[156:159], v[60:63]
    v_mfma_f32_16x16x32_bf16 v[64:67], v[40:43], a[236:239], v[64:67]
    v_mfma_f32_16x16x32_bf16 v[68:71], v[44:47], a[236:239], v[68:71]
    s_cmp_eq_u32 s36, 0
    s_cselect_b32 s37, s40, s37
    s_cselect_b32 s38, s42, s38
    s_add_u32 s37, s37, 12288
    s_add_u32 s38, s38, 12288
    s_add_u32 s36, s36, 1
    s_nop 1
    v_cvt_pk_bf16_f32 v72, v48, v49
    v_cvt_pk_bf16_f32 v73, v50, v51
    v_cvt_pk_bf16_f32 v74, v52, v53
    v_cvt_pk_bf16_f32 v75, v54, v55
    v_cvt_pk_bf16_f32 v76, v56, v57
    v_cvt_pk_bf16_f32 v77, v58, v59
    v_cvt_pk_bf16_f32 v78, v60, v61
    v_cvt_pk_bf16_f32 v79, v62, v63
    v_cvt_pk_bf16_f32 v80, v64, v65
    v_cvt_pk_bf16_f32 v81, v66, v67
    v_cvt_pk_bf16_f32 v82, v68, v69
    v_cvt_pk_bf16_f32 v83, v70, v71
    s_cmp_lt_u32 s36, 64
    s_cbranch_scc1 L_kv1_loop
    buffer_store_dwordx4 v[72:75], v4, s[4:7], s37 offen offset:0 sc1
    buffer_store_dwordx4 v[76:79], v4, s[4:7], s37 offen offset:1024 sc1
    buffer_store_dwordx4 v[80:83], v4, s[4:7], s37 offen offset:2048 sc1
L_kv_fin:
    s_waitcnt vmcnt(0) lgkmcnt(0)
    s_barrier
    s_cmp_lg_u32 s16, 0
    s_cbranch_scc1 L_59
    v_mov_b32 v11, 64
    s_mov_b64 exec, 1
    buffer_store_dword v11, v10, s[4:7], s39 offen sc1
    s_mov_b64 exec, -1
L_59:
    s_cmp_eq_u32 s18, 0
    s_cbranch_scc1 L_qa
    s_load_dwordx2 s[8:9], s[88:89], 40
    s_mov_b32 s10, 7864320
    s_mov_b32 s11, 0x20000
    v_lshlrev_b32 v3, 4, v0
    v_mov_b32 v4, 0
    v_lshrrev_b32 v5, 2, v0
    v_mul_u32_u24 v5, 1280, v5
    v_and_b32 v6, 3, v0
    v_lshl_add_u32 v5, v6, 3, v5
    s_mul_i32 s29, s16, 320
    v_add_u32 v2, s29, v5
    s_mul_i32 s40, s20, 245760
    s_mul_i32 s29, s16, 10240
    s_add_u32 s40, s40, s29
    s_mul_i32 s41, s16, 10240
    s_mul_i32 s37, s17, 7864320
    s_mul_i32 s29, s20, 245760
    s_add_u32 s37, s37, s29
    s_mul_i32 s29, s16, 10240
    s_add_u32 s37, s37, s29
    s_add_u32 s37, s37, 192937984
    s_waitcnt vmcnt(0) lgkmcnt(0)
    s_barrier
    s_add_u32 m0, s41, 0
    s_add_u32 s29, s40, 0
    buffer_load_dwordx4 v3, s[8:11], s29 offen offset:0 lds
    buffer_load_dwordx4 v3, s[8:11], s29 offen offset:1024 lds
    buffer_load_dwordx4 v3, s[8:11], s29 offen offset:2048 lds
    buffer_load_dwordx4 v3, s[8:11], s29 offen offset:3072 lds
    s_add_u32 m0, s41, 4096
    s_add_u32 s29, s40, 4096
    buffer_load_dwordx4 v3, s[8:11], s29 offen offset:0 lds
    buffer_load_dwordx4 v3, s[8:11], s29 offen offset:1024 lds
    buffer_load_dwordx4 v3, s[8:11], s29 offen offset:2048 lds
    buffer_load_dwordx4 v3, s[8:11], s29 offen offset:3072 lds
    s_add_u32 m0, s41, 8192
    s_add_u32 s29, s40, 8192
    buffer_load_dwordx4 v3, s[8:11], s29 offen offset:0 lds
    buffer_load_dwordx4 v3, s[8:11], s29 offen offset:1024 lds
    s_add_u32 m0, s41, 40960
    s_add_u32 s29, s40, 40960
    buffer_load_dwordx4 v3, s[8:11], s29 offen offset:0 lds
    buffer_load_dwordx4 v3, s[8:11], s29 offen offset:1024 lds
    buffer_load_dwordx4 v3, s[8:11], s29 offen offset:2048 lds
    buffer_load_dwordx4 v3, s[8:11], s29 offen offset:3072 lds
    s_add_u32 m0, s41, 45056
    s_add_u32 s29, s40, 45056
    buffer_load_dwordx4 v3, s[8:11], s29 offen offset:0 lds
    buffer_load_dwordx4 v3, s[8:11], s29 offen offset:1024 lds
    buffer_load_dwordx4 v3, s[8:11], s29 offen offset:2048 lds
    buffer_load_dwordx4 v3, s[8:11], s29 offen offset:3072 lds
    s_add_u32 m0, s41, 49152
    s_add_u32 s29, s40, 49152
    buffer_load_dwordx4 v3, s[8:11], s29 offen offset:0 lds
    buffer_load_dwordx4 v3, s[8:11], s29 offen offset:1024 lds
    s_waitcnt vmcnt(10)
    s_barrier
    s_add_u32 m0, s41, 81920
    s_add_u32 s29, s40, 81920
    buffer_load_dwordx4 v3, s[8:11], s29 offen offset:0 lds
    buffer_load_dwordx4 v3, s[8:11], s29 offen offset:1024 lds
    buffer_load_dwordx4 v3, s[8:11], s29 offen offset:2048 lds
    buffer_load_dwordx4 v3, s[8:11], s29 offen offset:3072 lds
    s_add_u32 m0, s41, 86016
    s_add_u32 s29, s40, 86016
    buffer_load_dwordx4 v3, s[8:11], s29 offen offset:0 lds
    buffer_load_dwordx4 v3, s[8:11], s29 offen offset:1024 lds
    buffer_load_dwordx4 v3, s[8:11], s29 offen offset:2048 lds
    buffer_load_dwordx4 v3, s[8:11], s29 offen offset:3072 lds
    s_add_u32 m0, s41, 90112
    s_add_u32 s29, s40, 90112
    buffer_load_dwordx4 v3, s[8:11], s29 offen offset:0 lds
    buffer_load_dwordx4 v3, s[8:11], s29 offen offset:1024 lds
    ds_read_b64_tr_b16 v[16:17], v2 offset:0
    ds_read_b64_tr_b16 v[18:19], v2 offset:20480
    ds_read_b64_tr_b16 v[20:21], v2 offset:32
    ds_read_b64_tr_b16 v[22:23], v2 offset:20512
    ds_read_b64_tr_b16 v[24:25], v2 offset:64
    ds_read_b64_tr_b16 v[26:27], v2 offset:20544
    ds_read_b64_tr_b16 v[28:29], v2 offset:96
    ds_read_b64_tr_b16 v[30:31], v2 offset:20576
    ds_read_b64_tr_b16 v[32:33], v2 offset:128
    ds_read_b64_tr_b16 v[34:35], v2 offset:20608
    ds_read_b64_tr_b16 v[36:37], v2 offset:160
    ds_read_b64_tr_b16 v[38:39], v2 offset:20640
    ds_read_b64_tr_b16 v[40:41], v2 offset:192
    ds_read_b64_tr_b16 v[42:43], v2 offset:20672
    ds_read_b64_tr_b16 v[44:45], v2 offset:224
    ds_read_b64_tr_b16 v[46:47], v2 offset:20704
    ds_read_b64_tr_b16 v[48:49], v2 offset:256
    ds_read_b64_tr_b16 v[50:51], v2 offset:20736
    ds_read_b64_tr_b16 v[52:53], v2 offset:288
    ds_read_b64_tr_b16 v[54:55], v2 offset:20768
    v_add_u32 v2, 40960, v2
    s_add_u32 s29, s37, 0
    s_waitcnt lgkmcnt(15)
    buffer_store_dwordx4 v[16:19], v3, s[4:7], s29 offen offset:0 sc1
    s_waitcnt lgkmcnt(15)
    buffer_store_dwordx4 v[20:23], v3, s[4:7], s29 offen offset:1024 sc1
    s_waitcnt lgkmcnt(14)
    buffer_store_dwordx4 v[24:27], v3, s[4:7], s29 offen offset:2048 sc1
    s_waitcnt lgkmcnt(12)
    buffer_store_dwordx4 v[28:31], v3, s[4:7], s29 offen offset:3072 sc1
    s_add_u32 s29, s37, 4096
    s_waitcnt lgkmcnt(10)
    buffer_store_dwordx4 v[32:35], v3, s[4:7], s29 offen offset:0 sc1
    s_waitcnt lgkmcnt(8)
    buffer_store_dwordx4 v[36:39], v3, s[4:7], s29 offen offset:1024 sc1
    s_waitcnt lgkmcnt(6)
    buffer_store_dwordx4 v[40:43], v3, s[4:7], s29 offen offset:2048 sc1
    s_waitcnt lgkmcnt(4)
    buffer_store_dwordx4 v[44:47], v3, s[4:7], s29 offen offset:3072 sc1
    s_add_u32 s29, s37, 8192
    s_waitcnt lgkmcnt(2)
    buffer_store_dwordx4 v[48:51], v3, s[4:7], s29 offen offset:0 sc1
    s_waitcnt lgkmcnt(0)
    buffer_store_dwordx4 v[52:55], v3, s[4:7], s29 offen offset:1024 sc1
    s_nop 1
    s_waitcnt vmcnt(20)
    s_barrier
    s_add_u32 m0, s41, 0
    s_add_u32 s29, s40, 122880
    buffer_load_dwordx4 v3, s[8:11], s29 offen offset:0 lds
    buffer_load_dwordx4 v3, s[8:11], s29 offen offset:1024 lds
    buffer_load_dwordx4 v3, s[8:11], s29 offen offset:2048 lds
    buffer_load_dwordx4 v3, s[8:11], s29 offen offset:3072 lds
    s_add_u32 m0, s41, 4096
    s_add_u32 s29, s40, 126976
    buffer_load_dwordx4 v3, s[8:11], s29 offen offset:0 lds
    buffer_load_dwordx4 v3, s[8:11], s29 offen offset:1024 lds
    buffer_load_dwordx4 v3, s[8:11], s29 offen offset:2048 lds
    buffer_load_dwordx4 v3, s[8:11], s29 offen offset:3072 lds
    s_add_u32 m0, s41, 8192
    s_add_u32 s29, s40, 131072
    buffer_load_dwordx4 v3, s[8:11], s29 offen offset:0 lds
    buffer_load_dwordx4 v3, s[8:11], s29 offen offset:1024 lds
    ds_read_b64_tr_b16 v[16:17], v2 offset:0
    ds_read_b64_tr_b16 v[18:19], v2 offset:20480
    ds_read_b64_tr_b16 v[20:21], v2 offset:32
    ds_read_b64_tr_b16 v[22:23], v2 offset:20512
    ds_read_b64_tr_b16 v[24:25], v2 offset:64
    ds_read_b64_tr_b16 v[26:27], v2 offset:20544
    ds_read_b64_tr_b16 v[28:29], v2 offset:96
    ds_read_b64_tr_b16 v[30:31], v2 offset:20576
    ds_read_b64_tr_b16 v[32:33], v2 offset:128
    ds_read_b64_tr_b16 v[34:35], v2 offset:20608
    ds_read_b64_tr_b16 v[36:37], v2 offset:160
    ds_read_b64_tr_b16 v[38:39], v2 offset:20640
    ds_read_b64_tr_b16 v[40:41], v2 offset:192
    ds_read_b64_tr_b16 v[42:43], v2 offset:20672
    ds_read_b64_tr_b16 v[44:45], v2 offset:224
    ds_read_b64_tr_b16 v[46:47], v2 offset:20704
    ds_read_b64_tr_b16 v[48:49], v2 offset:256
    ds_read_b64_tr_b16 v[50:51], v2 offset:20736
    ds_read_b64_tr_b16 v[52:53], v2 offset:288
    ds_read_b64_tr_b16 v[54:55], v2 offset:20768
    v_add_u32 v2, 40960, v2
    s_add_u32 s29, s37, 40960
    s_waitcnt lgkmcnt(15)
    buffer_store_dwordx4 v[16:19], v3, s[4:7], s29 offen offset:0 sc1
    s_waitcnt lgkmcnt(15)
    buffer_store_dwordx4 v[20:23], v3, s[4:7], s29 offen offset:1024 sc1
    s_waitcnt lgkmcnt(14)
    buffer_store_dwordx4 v[24:27], v3, s[4:7], s29 offen offset:2048 sc1
    s_waitcnt lgkmcnt(12)
    buffer_store_dwordx4 v[28:31], v3, s[4:7], s29 offen offset:3072 sc1
    s_add_u32 s29, s37, 45056
    s_waitcnt lgkmcnt(10)
    buffer_store_dwordx4 v[32:35], v3, s[4:7], s29 offen offset:0 sc1
    s_waitcnt lgkmcnt(8)
    buffer_store_dwordx4 v[36:39], v3, s[4:7], s29 offen offset:1024 sc1
    s_waitcnt lgkmcnt(6)
    buffer_store_dwordx4 v[40:43], v3, s[4:7], s29 offen offset:2048 sc1
    s_waitcnt lgkmcnt(4)
    buffer_store_dwordx4 v[44:47], v3, s[4:7], s29 offen offset:3072 sc1
    s_add_u32 s29, s37, 49152
    s_waitcnt lgkmcnt(2)
    buffer_store_dwordx4 v[48:51], v3, s[4:7], s29 offen offset:0 sc1
    s_waitcnt lgkmcnt(0)
    buffer_store_dwordx4 v[52:55], v3, s[4:7], s29 offen offset:1024 sc1
    s_nop 1
    s_waitcnt vmcnt(20)
    s_barrier
    s_add_u32 m0, s41, 40960
    s_add_u32 s29, s40, 163840
    buffer_load_dwordx4 v3, s[8:11], s29 offen offset:0 lds
    buffer_load_dwordx4 v3, s[8:11], s29 offen offset:1024 lds
    buffer_load_dwordx4 v3, s[8:11], s29 offen offset:2048 lds
    buffer_load_dwordx4 v3, s[8:11], s29 offen offset:3072 lds
    s_add_u32 m0, s41, 45056
    s_add_u32 s29, s40, 167936
    buffer_load_dwordx4 v3, s[8:11], s29 offen offset:0 lds
    buffer_load_dwordx4 v3, s[8:11], s29 offen offset:1024 lds
    buffer_load_dwordx4 v3, s[8:11], s29 offen offset:2048 lds
    buffer_load_dwordx4 v3, s[8:11], s29 offen offset:3072 lds
    s_add_u32 m0, s41, 49152
    s_add_u32 s29, s40, 172032
    buffer_load_dwordx4 v3, s[8:11], s29 offen offset:0 lds
    buffer_load_dwordx4 v3, s[8:11], s29 offen offset:1024 lds
    ds_read_b64_tr_b16 v[16:17], v2 offset:0
    ds_read_b64_tr_b16 v[18:19], v2 offset:20480
    ds_read_b64_tr_b16 v[20:21], v2 offset:32
    ds_read_b64_tr_b16 v[22:23], v2 offset:20512
    ds_read_b64_tr_b16 v[24:25], v2 offset:64
    ds_read_b64_tr_b16 v[26:27], v2 offset:20544
    ds_read_b64_tr_b16 v[28:29], v2 offset:96
    ds_read_b64_tr_b16 v[30:31], v2 offset:20576
    ds_read_b64_tr_b16 v[32:33], v2 offset:128
    ds_read_b64_tr_b16 v[34:35], v2 offset:20608
    ds_read_b64_tr_b16 v[36:37], v2 offset:160
    ds_read_b64_tr_b16 v[38:39], v2 offset:20640
    ds_read_b64_tr_b16 v[40:41], v2 offset:192
    ds_read_b64_tr_b16 v[42:43], v2 offset:20672
    ds_read_b64_tr_b16 v[44:45], v2 offset:224
    ds_read_b64_tr_b16 v[46:47], v2 offset:20704
    ds_read_b64_tr_b16 v[48:49], v2 offset:256
    ds_read_b64_tr_b16 v[50:51], v2 offset:20736
    ds_read_b64_tr_b16 v[52:53], v2 offset:288
    ds_read_b64_tr_b16 v[54:55], v2 offset:20768
    v_add_u32 v2, 4294885376, v2
    s_add_u32 s29, s37, 81920
    s_waitcnt lgkmcnt(15)
    buffer_store_dwordx4 v[16:19], v3, s[4:7], s29 offen offset:0 sc1
    s_waitcnt lgkmcnt(15)
    buffer_store_dwordx4 v[20:23], v3, s[4:7], s29 offen offset:1024 sc1
    s_waitcnt lgkmcnt(14)
    buffer_store_dwordx4 v[24:27], v3, s[4:7], s29 offen offset:2048 sc1
    s_waitcnt lgkmcnt(12)
    buffer_store_dwordx4 v[28:31], v3, s[4:7], s29 offen offset:3072 sc1
    s_add_u32 s29, s37, 86016
    s_waitcnt lgkmcnt(10)
    buffer_store_dwordx4 v[32:35], v3, s[4:7], s29 offen offset:0 sc1
    s_waitcnt lgkmcnt(8)
    buffer_store_dwordx4 v[36:39], v3, s[4:7], s29 offen offset:1024 sc1
    s_waitcnt lgkmcnt(6)
    buffer_store_dwordx4 v[40:43], v3, s[4:7], s29 offen offset:2048 sc1
    s_waitcnt lgkmcnt(4)
    buffer_store_dwordx4 v[44:47], v3, s[4:7], s29 offen offset:3072 sc1
    s_add_u32 s29, s37, 90112
    s_waitcnt lgkmcnt(2)
    buffer_store_dwordx4 v[48:51], v3, s[4:7], s29 offen offset:0 sc1
    s_waitcnt lgkmcnt(0)
    buffer_store_dwordx4 v[52:55], v3, s[4:7], s29 offen offset:1024 sc1
    s_nop 1
    s_waitcnt vmcnt(20)
    s_barrier
    s_add_u32 m0, s41, 81920
    s_add_u32 s29, s40, 204800
    buffer_load_dwordx4 v3, s[8:11], s29 offen offset:0 lds
    buffer_load_dwordx4 v3, s[8:11], s29 offen offset:1024 lds
    buffer_load_dwordx4 v3, s[8:11], s29 offen offset:2048 lds
    buffer_load_dwordx4 v3, s[8:11], s29 offen offset:3072 lds
    s_add_u32 m0, s41, 86016
    s_add_u32 s29, s40, 208896
    buffer_load_dwordx4 v3, s[8:11], s29 offen offset:0 lds
    buffer_load_dwordx4 v3, s[8:11], s29 offen offset:1024 lds
    buffer_load_dwordx4 v3, s[8:11], s29 offen offset:2048 lds
    buffer_load_dwordx4 v3, s[8:11], s29 offen offset:3072 lds
    s_add_u32 m0, s41, 90112
    s_add_u32 s29, s40, 212992
    buffer_load_dwordx4 v3, s[8:11], s29 offen offset:0 lds
    buffer_load_dwordx4 v3, s[8:11], s29 offen offset:1024 lds
    ds_read_b64_tr_b16 v[16:17], v2 offset:0
    ds_read_b64_tr_b16 v[18:19], v2 offset:20480
    ds_read_b64_tr_b16 v[20:21], v2 offset:32
    ds_read_b64_tr_b16 v[22:23], v2 offset:20512
    ds_read_b64_tr_b16 v[24:25], v2 offset:64
    ds_read_b64_tr_b16 v[26:27], v2 offset:20544
    ds_read_b64_tr_b16 v[28:29], v2 offset:96
    ds_read_b64_tr_b16 v[30:31], v2 offset:20576
    ds_read_b64_tr_b16 v[32:33], v2 offset:128
    ds_read_b64_tr_b16 v[34:35], v2 offset:20608
    ds_read_b64_tr_b16 v[36:37], v2 offset:160
    ds_read_b64_tr_b16 v[38:39], v2 offset:20640
    ds_read_b64_tr_b16 v[40:41], v2 offset:192
    ds_read_b64_tr_b16 v[42:43], v2 offset:20672
    ds_read_b64_tr_b16 v[44:45], v2 offset:224
    ds_read_b64_tr_b16 v[46:47], v2 offset:20704
    ds_read_b64_tr_b16 v[48:49], v2 offset:256
    ds_read_b64_tr_b16 v[50:51], v2 offset:20736
    ds_read_b64_tr_b16 v[52:53], v2 offset:288
    ds_read_b64_tr_b16 v[54:55], v2 offset:20768
    v_add_u32 v2, 40960, v2
    s_add_u32 s29, s37, 122880
    s_waitcnt lgkmcnt(15)
    buffer_store_dwordx4 v[16:19], v3, s[4:7], s29 offen offset:0 sc1
    s_waitcnt lgkmcnt(15)
    buffer_store_dwordx4 v[20:23], v3, s[4:7], s29 offen offset:1024 sc1
    s_waitcnt lgkmcnt(14)
    buffer_store_dwordx4 v[24:27], v3, s[4:7], s29 offen offset:2048 sc1
    s_waitcnt lgkmcnt(12)
    buffer_store_dwordx4 v[28:31], v3, s[4:7], s29 offen offset:3072 sc1
    s_add_u32 s29, s37, 126976
    s_waitcnt lgkmcnt(10)
    buffer_store_dwordx4 v[32:35], v3, s[4:7], s29 offen offset:0 sc1
    s_waitcnt lgkmcnt(8)
    buffer_store_dwordx4 v[36:39], v3, s[4:7], s29 offen offset:1024 sc1
    s_waitcnt lgkmcnt(6)
    buffer_store_dwordx4 v[40:43], v3, s[4:7], s29 offen offset:2048 sc1
    s_waitcnt lgkmcnt(4)
    buffer_store_dwordx4 v[44:47], v3, s[4:7], s29 offen offset:3072 sc1
    s_add_u32 s29, s37, 131072
    s_waitcnt lgkmcnt(2)
    buffer_store_dwordx4 v[48:51], v3, s[4:7], s29 offen offset:0 sc1
    s_waitcnt lgkmcnt(0)
    buffer_store_dwordx4 v[52:55], v3, s[4:7], s29 offen offset:1024 sc1
    s_nop 1
    s_waitcnt vmcnt(20)
    s_barrier
    ds_read_b64_tr_b16 v[16:17], v2 offset:0
    ds_read_b64_tr_b16 v[18:19], v2 offset:20480
    ds_read_b64_tr_b16 v[20:21], v2 offset:32
    ds_read_b64_tr_b16 v[22:23], v2 offset:20512
    ds_read_b64_tr_b16 v[24:25], v2 offset:64
    ds_read_b64_tr_b16 v[26:27], v2 offset:20544
    ds_read_b64_tr_b16 v[28:29], v2 offset:96
    ds_read_b64_tr_b16 v[30:31], v2 offset:20576
    ds_read_b64_tr_b16 v[32:33], v2 offset:128
    ds_read_b64_tr_b16 v[34:35], v2 offset:20608
    ds_read_b64_tr_b16 v[36:37], v2 offset:160
    ds_read_b64_tr_b16 v[38:39], v2 offset:20640
    ds_read_b64_tr_b16 v[40:41], v2 offset:192
    ds_read_b64_tr_b16 v[42:43], v2 offset:20672
    ds_read_b64_tr_b16 v[44:45], v2 offset:224
    ds_read_b64_tr_b16 v[46:47], v2 offset:20704
    ds_read_b64_tr_b16 v[48:49], v2 offset:256
    ds_read_b64_tr_b16 v[50:51], v2 offset:20736
    ds_read_b64_tr_b16 v[52:53], v2 offset:288
    ds_read_b64_tr_b16 v[54:55], v2 offset:20768
    v_add_u32 v2, 40960, v2
    s_add_u32 s29, s37, 163840
    s_waitcnt lgkmcnt(15)
    buffer_store_dwordx4 v[16:19], v3, s[4:7], s29 offen offset:0 sc1
    s_waitcnt lgkmcnt(15)
    buffer_store_dwordx4 v[20:23], v3, s[4:7], s29 offen offset:1024 sc1
    s_waitcnt lgkmcnt(14)
    buffer_store_dwordx4 v[24:27], v3, s[4:7], s29 offen offset:2048 sc1
    s_waitcnt lgkmcnt(12)
    buffer_store_dwordx4 v[28:31], v3, s[4:7], s29 offen offset:3072 sc1
    s_add_u32 s29, s37, 167936
    s_waitcnt lgkmcnt(10)
    buffer_store_dwordx4 v[32:35], v3, s[4:7], s29 offen offset:0 sc1
    s_waitcnt lgkmcnt(8)
    buffer_store_dwordx4 v[36:39], v3, s[4:7], s29 offen offset:1024 sc1
    s_waitcnt lgkmcnt(6)
    buffer_store_dwordx4 v[40:43], v3, s[4:7], s29 offen offset:2048 sc1
    s_waitcnt lgkmcnt(4)
    buffer_store_dwordx4 v[44:47], v3, s[4:7], s29 offen offset:3072 sc1
    s_add_u32 s29, s37, 172032
    s_waitcnt lgkmcnt(2)
    buffer_store_dwordx4 v[48:51], v3, s[4:7], s29 offen offset:0 sc1
    s_waitcnt lgkmcnt(0)
    buffer_store_dwordx4 v[52:55], v3, s[4:7], s29 offen offset:1024 sc1
    s_nop 1
    s_waitcnt vmcnt(10)
    s_barrier
    ds_read_b64_tr_b16 v[16:17], v2 offset:0
    ds_read_b64_tr_b16 v[18:19], v2 offset:20480
    ds_read_b64_tr_b16 v[20:21], v2 offset:32
    ds_read_b64_tr_b16 v[22:23], v2 offset:20512
    ds_read_b64_tr_b16 v[24:25], v2 offset:64
    ds_read_b64_tr_b16 v[26:27], v2 offset:20544
    ds_read_b64_tr_b16 v[28:29], v2 offset:96
    ds_read_b64_tr_b16 v[30:31], v2 offset:20576
    ds_read_b64_tr_b16 v[32:33], v2 offset:128
    ds_read_b64_tr_b16 v[34:35], v2 offset:20608
    ds_read_b64_tr_b16 v[36:37], v2 offset:160
    ds_read_b64_tr_b16 v[38:39], v2 offset:20640
    ds_read_b64_tr_b16 v[40:41], v2 offset:192
    ds_read_b64_tr_b16 v[42:43], v2 offset:20672
    ds_read_b64_tr_b16 v[44:45], v2 offset:224
    ds_read_b64_tr_b16 v[46:47], v2 offset:20704
    ds_read_b64_tr_b16 v[48:49], v2 offset:256
    ds_read_b64_tr_b16 v[50:51], v2 offset:20736
    ds_read_b64_tr_b16 v[52:53], v2 offset:288
    ds_read_b64_tr_b16 v[54:55], v2 offset:20768
    v_add_u32 v2, 4294885376, v2
    s_add_u32 s29, s37, 204800
    s_waitcnt lgkmcnt(15)
    buffer_store_dwordx4 v[16:19], v3, s[4:7], s29 offen offset:0 sc1
    s_waitcnt lgkmcnt(15)
    buffer_store_dwordx4 v[20:23], v3, s[4:7], s29 offen offset:1024 sc1
    s_waitcnt lgkmcnt(14)
    buffer_store_dwordx4 v[24:27], v3, s[4:7], s29 offen offset:2048 sc1
    s_waitcnt lgkmcnt(12)
    buffer_store_dwordx4 v[28:31], v3, s[4:7], s29 offen offset:3072 sc1
    s_add_u32 s29, s37, 208896
    s_waitcnt lgkmcnt(10)
    buffer_store_dwordx4 v[32:35], v3, s[4:7], s29 offen offset:0 sc1
    s_waitcnt lgkmcnt(8)
    buffer_store_dwordx4 v[36:39], v3, s[4:7], s29 offen offset:1024 sc1
    s_waitcnt lgkmcnt(6)
    buffer_store_dwordx4 v[40:43], v3, s[4:7], s29 offen offset:2048 sc1
    s_waitcnt lgkmcnt(4)
    buffer_store_dwordx4 v[44:47], v3, s[4:7], s29 offen offset:3072 sc1
    s_add_u32 s29, s37, 212992
    s_waitcnt lgkmcnt(2)
    buffer_store_dwordx4 v[48:51], v3, s[4:7], s29 offen offset:0 sc1
    s_waitcnt lgkmcnt(0)
    buffer_store_dwordx4 v[52:55], v3, s[4:7], s29 offen offset:1024 sc1
    s_nop 1
    s_waitcnt vmcnt(0)
    s_barrier
    s_cmp_lg_u32 s16, 0
    s_cbranch_scc1 L_60
    v_mov_b32 v5, 1
    s_mov_b64 exec, 1
    buffer_atomic_add v5, v4, s[12:15], 0 offen offset:48
    s_mov_b64 exec, -1
L_60:
L_qa:
    v_mov_b32 v1, 0
    s_cmp_lg_u32 s16, 0
    s_cbranch_scc1 L_62
L_61:
    buffer_load_dword v2, v1, s[12:15], 0 offen offset:40 sc1
    s_waitcnt vmcnt(0)
    v_cmp_gt_u32 vcc, 256, v2
    s_cbranch_vccz L_62
    s_sleep 8
    s_branch L_spin_63
L_62:
    s_barrier
    s_mul_i32 s29, s17, 56
    s_add_u32 s88, s0, s29
    s_addc_u32 s89, s1, 0
    s_load_dwordx2 s[8:9], s[88:89], 16
    s_mov_b32 s10, 7864320
    s_mov_b32 s11, 0x20000
    v_and_b32 v8, 15, v0
    v_lshrrev_b32 v9, 4, v0
    s_mul_i32 s30, s20, 384
    s_mul_i32 s29, s16, 393216
    s_add_u32 s30, s30, s29
    v_add_u32 v5, 0, v0
    v_mul_u32_u24 v6, 171, v5
    v_lshrrev_b32 v6, 12, v6
    v_mul_u32_u24 v7, 24, v6
    v_sub_u32 v7, v5, v7
    v_mul_u32_u24 v6, 12288, v6
    v_lshl_add_u32 v6, v7, 4, v6
    v_add_u32 v1, s30, v6
    v_add_u32 v5, 64, v0
    v_mul_u32_u24 v6, 171, v5
    v_lshrrev_b32 v6, 12, v6
    v_mul_u32_u24 v7, 24, v6
    v_sub_u32 v7, v5, v7
    v_mul_u32_u24 v6, 12288, v6
    v_lshl_add_u32 v6, v7, 4, v6
    v_add_u32 v2, s30, v6
    v_add_u32 v5, 128, v0
    v_mul_u32_u24 v6, 171, v5
    v_lshrrev_b32 v6, 12, v6
    v_mul_u32_u24 v7, 24, v6
    v_sub_u32 v7, v5, v7
    v_mul_u32_u24 v6, 12288, v6
    v_lshl_add_u32 v6, v7, 4, v6
    v_add_u32 v3, s30, v6
    v_lshrrev_b32 v5, 2, v8
    v_lshl_add_u32 v5, v9, 3, v5
    v_mul_u32_u24 v5, 384, v5
    v_and_b32 v6, 3, v8
    v_lshl_add_u32 v5, v6, 3, v5
    s_mul_i32 s30, s16, 96
    v_add_u32 v4, s30, v5
    s_mul_i32 s41, s16, 12288
    s_waitcnt lgkmcnt(0)
    s_barrier
    s_mov_b32 s29, 0
    s_add_u32 m0, s41, 0
    s_nop 0
    buffer_load_dwordx4 v1, s[8:11], s29 offen nt lds
    s_mov_b32 s29, 0
    s_add_u32 m0, s41, 1024
    s_nop 0
    buffer_load_dwordx4 v2, s[8:11], s29 offen nt lds
    s_mov_b32 s29, 0
    s_add_u32 m0, s41, 2048
    s_nop 0
    buffer_load_dwordx4 v3, s[8:11], s29 offen nt lds
    s_mov_b32 s29, 98304
    s_add_u32 m0, s41, 3072
    s_nop 0
    buffer_load_dwordx4 v1, s[8:11], s29 offen nt lds
    s_mov_b32 s29, 98304
    s_add_u32 m0, s41, 4096
    s_nop 0
    buffer_load_dwordx4 v2, s[8:11], s29 offen nt lds
    s_mov_b32 s29, 98304
    s_add_u32 m0, s41, 5120
    s_nop 0
    buffer_load_dwordx4 v3, s[8:11], s29 offen nt lds
    s_mov_b32 s29, 196608
    s_add_u32 m0, s41, 6144
    s_nop 0
    buffer_load_dwordx4 v1, s[8:11], s29 offen nt lds
    s_mov_b32 s29, 196608
    s_add_u32 m0, s41, 7168
    s_nop 0
    buffer_load_dwordx4 v2, s[8:11], s29 offen nt lds
    s_mov_b32 s29, 196608
    s_add_u32 m0, s41, 8192
    s_nop 0
    buffer_load_dwordx4 v3, s[8:11], s29 offen nt lds
    s_mov_b32 s29, 294912
    s_add_u32 m0, s41, 9216
    s_nop 0
    buffer_load_dwordx4 v1, s[8:11], s29 offen nt lds
    s_mov_b32 s29, 294912
    s_add_u32 m0, s41, 10240
    s_nop 0
    buffer_load_dwordx4 v2, s[8:11], s29 offen nt lds
    s_mov_b32 s29, 294912
    s_add_u32 m0, s41, 11264
    s_nop 0
    buffer_load_dwordx4 v3, s[8:11], s29 offen nt lds
    s_mov_b32 s29, 1572864
    s_add_u32 m0, s41, 49152
    s_nop 0
    buffer_load_dwordx4 v1, s[8:11], s29 offen nt lds
    s_mov_b32 s29, 1572864
    s_add_u32 m0, s41, 50176
    s_nop 0
    buffer_load_dwordx4 v2, s[8:11], s29 offen nt lds
    s_mov_b32 s29, 1572864
    s_add_u32 m0, s41, 51200
    s_nop 0
    buffer_load_dwordx4 v3, s[8:11], s29 offen nt lds
    s_mov_b32 s29, 1671168
    s_add_u32 m0, s41, 52224
    s_nop 0
    buffer_load_dwordx4 v1, s[8:11], s29 offen nt lds
    s_mov_b32 s29, 1671168
    s_add_u32 m0, s41, 53248
    s_nop 0
    buffer_load_dwordx4 v2, s[8:11], s29 offen nt lds
    s_mov_b32 s29, 1671168
    s_add_u32 m0, s41, 54272
    s_nop 0
    buffer_load_dwordx4 v3, s[8:11], s29 offen nt lds
    s_mov_b32 s29, 1769472
    s_add_u32 m0, s41, 55296
    s_nop 0
    buffer_load_dwordx4 v1, s[8:11], s29 offen nt lds
    s_mov_b32 s29, 1769472
    s_add_u32 m0, s41, 56320
    s_nop 0
    buffer_load_dwordx4 v2, s[8:11], s29 offen nt lds
    s_mov_b32 s29, 1769472
    s_add_u32 m0, s41, 57344
    s_nop 0
    buffer_load_dwordx4 v3, s[8:11], s29 offen nt lds
    s_mov_b32 s29, 1867776
    s_add_u32 m0, s41, 58368
    s_nop 0
    buffer_load_dwordx4 v1, s[8:11], s29 offen nt lds
    s_mov_b32 s29, 1867776
    s_add_u32 m0, s41, 59392
    s_nop 0
    buffer_load_dwordx4 v2, s[8:11], s29 offen nt lds
    s_mov_b32 s29, 1867776
    s_add_u32 m0, s41, 60416
    s_nop 0
    buffer_load_dwordx4 v3, s[8:11], s29 offen nt lds
    s_waitcnt vmcnt(12)
    s_barrier
    ds_read_b64_tr_b16 a[0:1], v4 offset:0
    ds_read_b64_tr_b16 a[2:3], v4 offset:1536
    ds_read_b64_tr_b16 a[80:81], v4 offset:32
    ds_read_b64_tr_b16 a[82:83], v4 offset:1568
    ds_read_b64_tr_b16 a[160:161], v4 offset:64
    ds_read_b64_tr_b16 a[162:163], v4 offset:1600
    ds_read_b64_tr_b16 a[4:5], v4 offset:12288
    ds_read_b64_tr_b16 a[6:7], v4 offset:13824
    ds_read_b64_tr_b16 a[84:85], v4 offset:12320
    ds_read_b64_tr_b16 a[86:87], v4 offset:13856
    ds_read_b64_tr_b16 a[164:165], v4 offset:12352
    ds_read_b64_tr_b16 a[166:167], v4 offset:13888
    ds_read_b64_tr_b16 a[8:9], v4 offset:24576
    ds_read_b64_tr_b16 a[10:11], v4 offset:26112
    ds_read_b64_tr_b16 a[88:89], v4 offset:24608
    ds_read_b64_tr_b16 a[90:91], v4 offset:26144
    ds_read_b64_tr_b16 a[168:169], v4 offset:24640
    ds_read_b64_tr_b16 a[170:171], v4 offset:26176
    ds_read_b64_tr_b16 a[12:13], v4 offset:36864
    ds_read_b64_tr_b16 a[14:15], v4 offset:38400
    ds_read_b64_tr_b16 a[92:93], v4 offset:36896
    ds_read_b64_tr_b16 a[94:95], v4 offset:38432
    ds_read_b64_tr_b16 a[172:173], v4 offset:36928
    ds_read_b64_tr_b16 a[174:175], v4 offset:38464
    v_add_u32 v4, 49152, v4
    s_waitcnt lgkmcnt(0)
    s_barrier
    s_mov_b32 s29, 3145728
    s_add_u32 m0, s41, 0
    s_nop 0
    buffer_load_dwordx4 v1, s[8:11], s29 offen nt lds
    s_mov_b32 s29, 3145728
    s_add_u32 m0, s41, 1024
    s_nop 0
    buffer_load_dwordx4 v2, s[8:11], s29 offen nt lds
    s_mov_b32 s29, 3145728
    s_add_u32 m0, s41, 2048
    s_nop 0
    buffer_load_dwordx4 v3, s[8:11], s29 offen nt lds
    s_mov_b32 s29, 3244032
    s_add_u32 m0, s41, 3072
    s_nop 0
    buffer_load_dwordx4 v1, s[8:11], s29 offen nt lds
    s_mov_b32 s29, 3244032
    s_add_u32 m0, s41, 4096
    s_nop 0
    buffer_load_dwordx4 v2, s[8:11], s29 offen nt lds
    s_mov_b32 s29, 3244032
    s_add_u32 m0, s41, 5120
    s_nop 0
    buffer_load_dwordx4 v3, s[8:11], s29 offen nt lds
    s_mov_b32 s29, 3342336
    s_add_u32 m0, s41, 6144
    s_nop 0
    buffer_load_dwordx4 v1, s[8:11], s29 offen nt lds
    s_mov_b32 s29, 3342336
    s_add_u32 m0, s41, 7168
    s_nop 0
    buffer_load_dwordx4 v2, s[8:11], s29 offen nt lds
    s_mov_b32 s29, 3342336
    s_add_u32 m0, s41, 8192
    s_nop 0
    buffer_load_dwordx4 v3, s[8:11], s29 offen nt lds
    s_mov_b32 s29, 3440640
    s_add_u32 m0, s41, 9216
    s_nop 0
    buffer_load_dwordx4 v1, s[8:11], s29 offen nt lds
    s_mov_b32 s29, 3440640
    s_add_u32 m0, s41, 10240
    s_nop 0
    buffer_load_dwordx4 v2, s[8:11], s29 offen nt lds
    s_mov_b32 s29, 3440640
    s_add_u32 m0, s41, 11264
    s_nop 0
    buffer_load_dwordx4 v3, s[8:11], s29 offen nt lds
    s_waitcnt vmcnt(12)
    s_barrier
    ds_read_b64_tr_b16 a[16:17], v4 offset:0
    ds_read_b64_tr_b16 a[18:19], v4 offset:1536
    ds_read_b64_tr_b16 a[96:97], v4 offset:32
    ds_read_b64_tr_b16 a[98:99], v4 offset:1568
    ds_read_b64_tr_b16 a[176:177], v4 offset:64
    ds_read_b64_tr_b16 a[178:179], v4 offset:1600
    ds_read_b64_tr_b16 a[20:21], v4 offset:12288
    ds_read_b64_tr_b16 a[22:23], v4 offset:13824
    ds_read_b64_tr_b16 a[100:101], v4 offset:12320
    ds_read_b64_tr_b16 a[102:103], v4 offset:13856
    ds_read_b64_tr_b16 a[180:181], v4 offset:12352
    ds_read_b64_tr_b16 a[182:183], v4 offset:13888
    ds_read_b64_tr_b16 a[24:25], v4 offset:24576
    ds_read_b64_tr_b16 a[26:27], v4 offset:26112
    ds_read_b64_tr_b16 a[104:105], v4 offset:24608
    ds_read_b64_tr_b16 a[106:107], v4 offset:26144
    ds_read_b64_tr_b16 a[184:185], v4 offset:24640
    ds_read_b64_tr_b16 a[186:187], v4 offset:26176
    ds_read_b64_tr_b16 a[28:29], v4 offset:36864
    ds_read_b64_tr_b16 a[30:31], v4 offset:38400
    ds_read_b64_tr_b16 a[108:109], v4 offset:36896
    ds_read_b64_tr_b16 a[110:111], v4 offset:38432
    ds_read_b64_tr_b16 a[188:189], v4 offset:36928
    ds_read_b64_tr_b16 a[190:191], v4 offset:38464
    v_subrev_u32 v4, 49152, v4
    s_waitcnt lgkmcnt(0)
    s_barrier
    s_mov_b32 s29, 4718592
    s_add_u32 m0, s41, 49152
    s_nop 0
    buffer_load_dwordx4 v1, s[8:11], s29 offen nt lds
    s_mov_b32 s29, 4718592
    s_add_u32 m0, s41, 50176
    s_nop 0
    buffer_load_dwordx4 v2, s[8:11], s29 offen nt lds
    s_mov_b32 s29, 4718592
    s_add_u32 m0, s41, 51200
    s_nop 0
    buffer_load_dwordx4 v3, s[8:11], s29 offen nt lds
    s_mov_b32 s29, 4816896
    s_add_u32 m0, s41, 52224
    s_nop 0
    buffer_load_dwordx4 v1, s[8:11], s29 offen nt lds
    s_mov_b32 s29, 4816896
    s_add_u32 m0, s41, 53248
    s_nop 0
    buffer_load_dwordx4 v2, s[8:11], s29 offen nt lds
    s_mov_b32 s29, 4816896
    s_add_u32 m0, s41, 54272
    s_nop 0
    buffer_load_dwordx4 v3, s[8:11], s29 offen nt lds
    s_mov_b32 s29, 4915200
    s_add_u32 m0, s41, 55296
    s_nop 0
    buffer_load_dwordx4 v1, s[8:11], s29 offen nt lds
    s_mov_b32 s29, 4915200
    s_add_u32 m0, s41, 56320
    s_nop 0
    buffer_load_dwordx4 v2, s[8:11], s29 offen nt lds
    s_mov_b32 s29, 4915200
    s_add_u32 m0, s41, 57344
    s_nop 0
    buffer_load_dwordx4 v3, s[8:11], s29 offen nt lds
    s_mov_b32 s29, 5013504
    s_add_u32 m0, s41, 58368
    s_nop 0
    buffer_load_dwordx4 v1, s[8:11], s29 offen nt lds
    s_mov_b32 s29, 5013504
    s_add_u32 m0, s41, 59392
    s_nop 0
    buffer_load_dwordx4 v2, s[8:11], s29 offen nt lds
    s_mov_b32 s29, 5013504
    s_add_u32 m0, s41, 60416
    s_nop 0
    buffer_load_dwordx4 v3, s[8:11], s29 offen nt lds
    s_waitcnt vmcnt(12)
    s_barrier
    ds_read_b64_tr_b16 a[32:33], v4 offset:0
    ds_read_b64_tr_b16 a[34:35], v4 offset:1536
    ds_read_b64_tr_b16 a[112:113], v4 offset:32
    ds_read_b64_tr_b16 a[114:115], v4 offset:1568
    ds_read_b64_tr_b16 a[192:193], v4 offset:64
    ds_read_b64_tr_b16 a[194:195], v4 offset:1600
    ds_read_b64_tr_b16 a[36:37], v4 offset:12288
    ds_read_b64_tr_b16 a[38:39], v4 offset:13824
    ds_read_b64_tr_b16 a[116:117], v4 offset:12320
    ds_read_b64_tr_b16 a[118:119], v4 offset:13856
    ds_read_b64_tr_b16 a[196:197], v4 offset:12352
    ds_read_b64_tr_b16 a[198:199], v4 offset:13888
    ds_read_b64_tr_b16 a[40:41], v4 offset:24576
    ds_read_b64_tr_b16 a[42:43], v4 offset:26112
    ds_read_b64_tr_b16 a[120:121], v4 offset:24608
    ds_read_b64_tr_b16 a[122:123], v4 offset:26144
    ds_read_b64_tr_b16 a[200:201], v4 offset:24640
    ds_read_b64_tr_b16 a[202:203], v4 offset:26176
    ds_read_b64_tr_b16 a[44:45], v4 offset:36864
    ds_read_b64_tr_b16 a[46:47], v4 offset:38400
    ds_read_b64_tr_b16 a[124:125], v4 offset:36896
    ds_read_b64_tr_b16 a[126:127], v4 offset:38432
    ds_read_b64_tr_b16 a[204:205], v4 offset:36928
    ds_read_b64_tr_b16 a[206:207], v4 offset:38464
    v_add_u32 v4, 49152, v4
    s_waitcnt lgkmcnt(0)
    s_barrier
    s_mov_b32 s29, 6291456
    s_add_u32 m0, s41, 0
    s_nop 0
    buffer_load_dwordx4 v1, s[8:11], s29 offen nt lds
    s_mov_b32 s29, 6291456
    s_add_u32 m0, s41, 1024
    s_nop 0
    buffer_load_dwordx4 v2, s[8:11], s29 offen nt lds
    s_mov_b32 s29, 6291456
    s_add_u32 m0, s41, 2048
    s_nop 0
    buffer_load_dwordx4 v3, s[8:11], s29 offen nt lds
    s_mov_b32 s29, 6389760
    s_add_u32 m0, s41, 3072
    s_nop 0
    buffer_load_dwordx4 v1, s[8:11], s29 offen nt lds
    s_mov_b32 s29, 6389760
    s_add_u32 m0, s41, 4096
    s_nop 0
    buffer_load_dwordx4 v2, s[8:11], s29 offen nt lds
    s_mov_b32 s29, 6389760
    s_add_u32 m0, s41, 5120
    s_nop 0
    buffer_load_dwordx4 v3, s[8:11], s29 offen nt lds
    s_mov_b32 s29, 6488064
    s_add_u32 m0, s41, 6144
    s_nop 0
    buffer_load_dwordx4 v1, s[8:11], s29 offen nt lds
    s_mov_b32 s29, 6488064
    s_add_u32 m0, s41, 7168
    s_nop 0
    buffer_load_dwordx4 v2, s[8:11], s29 offen nt lds
    s_mov_b32 s29, 6488064
    s_add_u32 m0, s41, 8192
    s_nop 0
    buffer_load_dwordx4 v3, s[8:11], s29 offen nt lds
    s_mov_b32 s29, 6586368
    s_add_u32 m0, s41, 9216
    s_nop 0
    buffer_load_dwordx4 v1, s[8:11], s29 offen nt lds
    s_mov_b32 s29, 6586368
    s_add_u32 m0, s41, 10240
    s_nop 0
    buffer_load_dwordx4 v2, s[8:11], s29 offen nt lds
    s_mov_b32 s29, 6586368
    s_add_u32 m0, s41, 11264
    s_nop 0
    buffer_load_dwordx4 v3, s[8:11], s29 offen nt lds
    s_waitcnt vmcnt(12)
    s_barrier
    ds_read_b64_tr_b16 a[48:49], v4 offset:0
    ds_read_b64_tr_b16 a[50:51], v4 offset:1536
    ds_read_b64_tr_b16 a[128:129], v4 offset:32
    ds_read_b64_tr_b16 a[130:131], v4 offset:1568
    ds_read_b64_tr_b16 a[208:209], v4 offset:64
    ds_read_b64_tr_b16 a[210:211], v4 offset:1600
    ds_read_b64_tr_b16 a[52:53], v4 offset:12288
    ds_read_b64_tr_b16 a[54:55], v4 offset:13824
    ds_read_b64_tr_b16 a[132:133], v4 offset:12320
    ds_read_b64_tr_b16 a[134:135], v4 offset:13856
    ds_read_b64_tr_b16 a[212:213], v4 offset:12352
    ds_read_b64_tr_b16 a[214:215], v4 offset:13888
    ds_read_b64_tr_b16 a[56:57], v4 offset:24576
    ds_read_b64_tr_b16 a[58:59], v4 offset:26112
    ds_read_b64_tr_b16 a[136:137], v4 offset:24608
    ds_read_b64_tr_b16 a[138:139], v4 offset:26144
    ds_read_b64_tr_b16 a[216:217], v4 offset:24640
    ds_read_b64_tr_b16 a[218:219], v4 offset:26176
    ds_read_b64_tr_b16 a[60:61], v4 offset:36864
    ds_read_b64_tr_b16 a[62:63], v4 offset:38400
    ds_read_b64_tr_b16 a[140:141], v4 offset:36896
    ds_read_b64_tr_b16 a[142:143], v4 offset:38432
    ds_read_b64_tr_b16 a[220:221], v4 offset:36928
    ds_read_b64_tr_b16 a[222:223], v4 offset:38464
    v_subrev_u32 v4, 49152, v4
    s_waitcnt lgkmcnt(0)
    s_barrier
    s_waitcnt vmcnt(0)
    s_barrier
    ds_read_b64_tr_b16 a[64:65], v4 offset:0
    ds_read_b64_tr_b16 a[66:67], v4 offset:1536
    ds_read_b64_tr_b16 a[144:145], v4 offset:32
    ds_read_b64_tr_b16 a[146:147], v4 offset:1568
    ds_read_b64_tr_b16 a[224:225], v4 offset:64
    ds_read_b64_tr_b16 a[226:227], v4 offset:1600
    ds_read_b64_tr_b16 a[68:69], v4 offset:12288
    ds_read_b64_tr_b16 a[70:71], v4 offset:13824
    ds_read_b64_tr_b16 a[148:149], v4 offset:12320
    ds_read_b64_tr_b16 a[150:151], v4 offset:13856
    ds_read_b64_tr_b16 a[228:229], v4 offset:12352
    ds_read_b64_tr_b16 a[230:231], v4 offset:13888
    ds_read_b64_tr_b16 a[72:73], v4 offset:24576
    ds_read_b64_tr_b16 a[74:75], v4 offset:26112
    ds_read_b64_tr_b16 a[152:153], v4 offset:24608
    ds_read_b64_tr_b16 a[154:155], v4 offset:26144
    ds_read_b64_tr_b16 a[232:233], v4 offset:24640
    ds_read_b64_tr_b16 a[234:235], v4 offset:26176
    ds_read_b64_tr_b16 a[76:77], v4 offset:36864
    ds_read_b64_tr_b16 a[78:79], v4 offset:38400
    ds_read_b64_tr_b16 a[156:157], v4 offset:36896
    ds_read_b64_tr_b16 a[158:159], v4 offset:38432
    ds_read_b64_tr_b16 a[236:237], v4 offset:36928
    ds_read_b64_tr_b16 a[238:239], v4 offset:38464
    v_add_u32 v4, 49152, v4
    s_waitcnt lgkmcnt(0)
    s_barrier
    s_mul_i32 s56, s18, 163840
    s_load_dwordx2 s[8:9], s[88:89], 0
    s_mov_b32 s10, 2621440
    v_lshrrev_b32 v5, 3, v0
    v_xor_b32 v6, v5, v0
    v_and_b32 v6, 7, v6
    v_mul_u32_u24 v5, 1280, v5
    v_lshl_add_u32 v5, v6, 4, v5
    s_mul_i32 s30, s16, 10240
    v_add_u32 v1, s30, v5
    s_mul_i32 s41, s16, 5120
    v_lshrrev_b32 v5, 4, v0
    v_xor_b32 v5, v5, v0
    v_and_b32 v5, 7, v5
    v_and_b32 v6, 7, v0
    v_lshlrev_b32 v6, 7, v6
    v_lshl_add_u32 v5, v5, 4, v6
    v_bfe_u32 v6, v0, 3, 1
    v_mul_u32_u24 v6, 5120, v6
    v_add_u32 v2, v5, v6
    v_add_u32 v3, 20480, v2
    v_xor_b32 v218, 64, v2
    v_xor_b32 v219, 64, v3
    s_mov_b32 s34, s56
    s_mov_b32 s35, s41
    s_waitcnt lgkmcnt(0)
    s_add_u32 m0, s35, 0
    s_nop 0
    buffer_load_dwordx4 v1, s[8:11], s34 offen offset:0 lds
    s_add_u32 m0, s35, 896
    s_nop 0
    buffer_load_dwordx4 v1, s[8:11], s34 offen offset:128 lds
    s_add_u32 m0, s35, 1792
    s_nop 0
    buffer_load_dwordx4 v1, s[8:11], s34 offen offset:256 lds
    s_add_u32 m0, s35, 2688
    s_nop 0
    buffer_load_dwordx4 v1, s[8:11], s34 offen offset:384 lds
    s_add_u32 m0, s35, 3584
    s_nop 0
    buffer_load_dwordx4 v1, s[8:11], s34 offen offset:512 lds
    s_add_u32 s34, s34, 640
    s_add_u32 s35, s35, 20480
    s_add_u32 s29, s41, 102400
    s_cmp_ge_u32 s35, s29
    s_cselect_b32 s35, s41, s35
    s_add_u32 m0, s35, 0
    s_nop 0
    buffer_load_dwordx4 v1, s[8:11], s34 offen offset:0 lds
    s_add_u32 m0, s35, 896
    s_nop 0
    buffer_load_dwordx4 v1, s[8:11], s34 offen offset:128 lds
    s_add_u32 m0, s35, 1792
    s_nop 0
    buffer_load_dwordx4 v1, s[8:11], s34 offen offset:256 lds
    s_add_u32 m0, s35, 2688
    s_nop 0
    buffer_load_dwordx4 v1, s[8:11], s34 offen offset:384 lds
    s_add_u32 m0, s35, 3584
    s_nop 0
    buffer_load_dwordx4 v1, s[8:11], s34 offen offset:512 lds
    s_add_u32 s34, s34, 40320
    s_add_u32 s35, s35, 20480
    s_add_u32 s29, s41, 102400
    s_cmp_ge_u32 s35, s29
    s_cselect_b32 s35, s41, s35
    s_add_u32 m0, s35, 0
    s_nop 0
    buffer_load_dwordx4 v1, s[8:11], s34 offen offset:0 lds
    s_add_u32 m0, s35, 896
    s_nop 0
    buffer_load_dwordx4 v1, s[8:11], s34 offen offset:128 lds
    s_add_u32 m0, s35, 1792
    s_nop 0
    buffer_load_dwordx4 v1, s[8:11], s34 offen offset:256 lds
    s_add_u32 m0, s35, 2688
    s_nop 0
    buffer_load_dwordx4 v1, s[8:11], s34 offen offset:384 lds
    s_add_u32 m0, s35, 3584
    s_nop 0
    buffer_load_dwordx4 v1, s[8:11], s34 offen offset:512 lds
    s_add_u32 s34, s34, 640
    s_add_u32 s35, s35, 20480
    s_add_u32 s29, s41, 102400
    s_cmp_ge_u32 s35, s29
    s_cselect_b32 s35, s41, s35
    s_waitcnt vmcnt(0)
    s_barrier
    ds_read_b128 v[16:19], v2 offset:0
    ds_read_b128 v[20:23], v2 offset:10240
    ds_read_b128 v[24:27], v218 offset:0
    ds_read_b128 v[28:31], v218 offset:10240
    v_lshlrev_b32 v4, 4, v0
    v_mov_b32 v10, 0
    s_mov_b32 s36, s18
    s_mov_b32 s43, 0
    s_mov_b32 s58, -1
    v_and_b32 v224, 15, v0
    v_lshrrev_b32 v225, 4, v0
    v_lshlrev_b32 v11, 7, v0
    v_and_b32 v13, 7, v224
    v_lshlrev_b32 v13, 4, v13
    v_lshl_add_u32 v5, v225, 7, v13
    v_and_b32 v13, 31, v0
    v_lshlrev_b32 v6, 4, v13
    s_lshr_b32 s30, s16, 1
    s_and_b32 s32, s16, 1
    s_mul_i32 s31, s30, 3072
    s_mul_i32 s29, s32, 1024
    s_add_u32 s31, s31, s29
    s_add_u32 s31, s31, 102400
    v_add_u32 v7, s31, v4
    s_mul_i32 s31, s30, 3072
    s_mul_i32 s29, s32, 8
    s_add_u32 s31, s31, s29
    s_add_u32 s31, s31, 104448
    v_add_u32 v8, s31, v4
    s_mul_i32 s31, s16, 12288
    s_add_u32 s31, s31, 102400
    v_add_u32 v9, s31, v4
    v_mov_b32 v14, 0xf149f2ca
    v_cmp_lt_u32 vcc, 1, v225
    s_nop 1
    v_cndmask_b32 v216, 0, v14, vcc
    v_lshl_add_u32 v13, v225, 2, 0
    v_cmp_gt_u32 vcc, v13, v224
    s_nop 1
    v_cndmask_b32 v220, 0, v14, vcc
    v_lshl_add_u32 v13, v225, 2, 1
    v_cmp_gt_u32 vcc, v13, v224
    s_nop 1
    v_cndmask_b32 v221, 0, v14, vcc
    v_lshl_add_u32 v13, v225, 2, 2
    v_cmp_gt_u32 vcc, v13, v224
    s_nop 1
    v_cndmask_b32 v222, 0, v14, vcc
    v_lshl_add_u32 v13, v225, 2, 3
    v_cmp_gt_u32 vcc, v13, v224
    s_nop 1
    v_cndmask_b32 v223, 0, v14, vcc
    s_mov_b32 s44, 0x3dd53b95
    s_mul_i32 s31, s17, 32
    s_add_u32 s31, s31, s20
    s_mul_i32 s37, s31, 790784
    s_mul_i32 s29, s16, 12288
    s_add_u32 s37, s37, s29
    s_mul_i32 s29, s18, 49152
    s_add_u32 s37, s37, s29
    s_mul_i32 s38, s31, 197888
    s_mul_i32 s29, s16, 3072
    s_add_u32 s38, s38, s29
    s_mul_i32 s29, s18, 12288
    s_add_u32 s38, s38, s29
    s_add_u32 s38, s38, 151552000
    s_mul_i32 s39, s17, 25165824
    s_mul_i32 s29, s16, 393216
    s_add_u32 s39, s39, s29
    s_mul_i32 s29, s20, 6144
    s_add_u32 s39, s39, s29
    s_mul_i32 s29, s18, 1572864
    s_add_u32 s39, s39, s29
    s_add_u32 s39, s39, 101220352
    s_mul_i32 s45, s31, 256
    s_add_u32 s45, s45, 181862400
    s_mul_i32 s30, s31, 256
    s_add_u32 s30, s30, 181846016
    s_mov_b32 s31, 64
    s_mov_b64 exec, 3
L_64:
    buffer_load_dword v13, v11, s[4:7], s30 offen sc1
    s_waitcnt vmcnt(0)
    v_cmp_gt_u32 vcc, s31, v13
    s_cbranch_vccz L_66
    s_sleep 4
    s_branch L_spin_67
L_66:
    s_mov_b64 exec, -1
L_65:
.p2align 6
L_qa_loop:
    s_cmp_lt_u32 s36, 4
    s_cselect_b32 s57, 2, 1
    s_cselect_b32 s56, 163840, 0
    s_add_u32 s46, s37, 4096
    s_add_u32 s47, s37, 6144
    s_add_u32 s48, s37, 50610176
    s_add_u32 s49, s48, 4096
    s_add_u32 s50, s48, 8192
    s_add_u32 s51, s38, 12664832
    s_add_u32 s40, s37, 10240
    s_waitcnt lgkmcnt(2)
    v_mfma_f32_16x16x32_bf16 v[48:51], a[0:3], v[16:19], 0
    ds_read_b128 v[32:35], v2 offset:1024
    v_mfma_f32_16x16x32_bf16 v[52:55], a[0:3], v[20:23], 0
    v_mfma_f32_16x16x32_bf16 v[56:59], a[80:83], v[16:19], 0
    ds_read_b128 v[36:39], v2 offset:11264
    v_mfma_f32_16x16x32_bf16 v[60:63], a[80:83], v[20:23], 0
    v_mfma_f32_16x16x32_bf16 v[64:67], a[160:163], v[16:19], 0
    s_add_u32 m0, s35, 0
    s_nop 0
    buffer_load_dwordx4 v1, s[8:11], s34 offen offset:0 lds
    v_mfma_f32_16x16x32_bf16 v[68:71], a[160:163], v[20:23], 0
    s_waitcnt lgkmcnt(2)
    v_mfma_f32_16x16x32_bf16 v[48:51], a[4:7], v[24:27], v[48:51]
    ds_read_b128 v[40:43], v218 offset:1024
    v_mfma_f32_16x16x32_bf16 v[52:55], a[4:7], v[28:31], v[52:55]
    v_mfma_f32_16x16x32_bf16 v[56:59], a[84:87], v[24:27], v[56:59]
    ds_read_b128 v[44:47], v218 offset:11264
    v_mfma_f32_16x16x32_bf16 v[60:63], a[84:87], v[28:31], v[60:63]
    v_mfma_f32_16x16x32_bf16 v[64:67], a[164:167], v[24:27], v[64:67]
    s_add_u32 m0, s35, 896
    s_nop 0
    buffer_load_dwordx4 v1, s[8:11], s34 offen offset:128 lds
    v_mfma_f32_16x16x32_bf16 v[68:71], a[164:167], v[28:31], v[68:71]
    s_waitcnt lgkmcnt(2)
    v_mfma_f32_16x16x32_bf16 v[48:51], a[8:11], v[32:35], v[48:51]
    ds_read_b128 v[16:19], v2 offset:2048
    v_mfma_f32_16x16x32_bf16 v[52:55], a[8:11], v[36:39], v[52:55]
    v_mfma_f32_16x16x32_bf16 v[56:59], a[88:91], v[32:35], v[56:59]
    ds_read_b128 v[20:23], v2 offset:12288
    v_mfma_f32_16x16x32_bf16 v[60:63], a[88:91], v[36:39], v[60:63]
    v_mfma_f32_16x16x32_bf16 v[64:67], a[168:171], v[32:35], v[64:67]
    s_add_u32 m0, s35, 1792
    s_nop 0
    buffer_load_dwordx4 v1, s[8:11], s34 offen offset:256 lds
    v_mfma_f32_16x16x32_bf16 v[68:71], a[168:171], v[36:39], v[68:71]
    s_waitcnt lgkmcnt(2)
    v_mfma_f32_16x16x32_bf16 v[48:51], a[12:15], v[40:43], v[48:51]
    ds_read_b128 v[24:27], v218 offset:2048
    v_mfma_f32_16x16x32_bf16 v[52:55], a[12:15], v[44:47], v[52:55]
    v_mfma_f32_16x16x32_bf16 v[56:59], a[92:95], v[40:43], v[56:59]
    ds_read_b128 v[28:31], v218 offset:12288
    v_mfma_f32_16x16x32_bf16 v[60:63], a[92:95], v[44:47], v[60:63]
    v_mfma_f32_16x16x32_bf16 v[64:67], a[172:175], v[40:43], v[64:67]
    s_add_u32 m0, s35, 2688
    s_nop 0
    buffer_load_dwordx4 v1, s[8:11], s34 offen offset:384 lds
    v_mfma_f32_16x16x32_bf16 v[68:71], a[172:175], v[44:47], v[68:71]
    s_waitcnt lgkmcnt(2)
    v_mfma_f32_16x16x32_bf16 v[48:51], a[16:19], v[16:19], v[48:51]
    ds_read_b128 v[32:35], v2 offset:3072
    v_mfma_f32_16x16x32_bf16 v[52:55], a[16:19], v[20:23], v[52:55]
    v_mfma_f32_16x16x32_bf16 v[56:59], a[96:99], v[16:19], v[56:59]
    ds_read_b128 v[36:39], v2 offset:13312
    v_mfma_f32_16x16x32_bf16 v[60:63], a[96:99], v[20:23], v[60:63]
    v_mfma_f32_16x16x32_bf16 v[64:67], a[176:179], v[16:19], v[64:67]
    s_add_u32 m0, s35, 3584
    s_nop 0
    buffer_load_dwordx4 v1, s[8:11], s34 offen offset:512 lds
    s_add_u32 s34, s34, 40320
    s_add_u32 s35, s35, 20480
    s_add_u32 s29, s41, 102400
    s_cmp_ge_u32 s35, s29
    s_cselect_b32 s35, s41, s35
    v_mfma_f32_16x16x32_bf16 v[68:71], a[176:179], v[20:23], v[68:71]
    s_waitcnt lgkmcnt(2)
    v_mfma_f32_16x16x32_bf16 v[48:51], a[20:23], v[24:27], v[48:51]
    ds_read_b128 v[40:43], v218 offset:3072
    v_mfma_f32_16x16x32_bf16 v[52:55], a[20:23], v[28:31], v[52:55]
    v_mfma_f32_16x16x32_bf16 v[56:59], a[100:103], v[24:27], v[56:59]
    ds_read_b128 v[44:47], v218 offset:13312
    v_mfma_f32_16x16x32_bf16 v[60:63], a[100:103], v[28:31], v[60:63]
    v_mfma_f32_16x16x32_bf16 v[64:67], a[180:183], v[24:27], v[64:67]
    v_mfma_f32_16x16x32_bf16 v[68:71], a[180:183], v[28:31], v[68:71]
    s_waitcnt lgkmcnt(2)
    v_mfma_f32_16x16x32_bf16 v[48:51], a[24:27], v[32:35], v[48:51]
    ds_read_b128 v[16:19], v2 offset:4096
    v_mfma_f32_16x16x32_bf16 v[52:55], a[24:27], v[36:39], v[52:55]
    v_mfma_f32_16x16x32_bf16 v[56:59], a[104:107], v[32:35], v[56:59]
    ds_read_b128 v[20:23], v2 offset:14336
    v_mfma_f32_16x16x32_bf16 v[60:63], a[104:107], v[36:39], v[60:63]
    v_mfma_f32_16x16x32_bf16 v[64:67], a[184:187], v[32:35], v[64:67]
    v_mfma_f32_16x16x32_bf16 v[68:71], a[184:187], v[36:39], v[68:71]
    s_waitcnt lgkmcnt(2)
    v_mfma_f32_16x16x32_bf16 v[48:51], a[28:31], v[40:43], v[48:51]
    ds_read_b128 v[24:27], v218 offset:4096
    v_mfma_f32_16x16x32_bf16 v[52:55], a[28:31], v[44:47], v[52:55]
    v_mfma_f32_16x16x32_bf16 v[56:59], a[108:111], v[40:43], v[56:59]
    ds_read_b128 v[28:31], v218 offset:14336
    v_mfma_f32_16x16x32_bf16 v[60:63], a[108:111], v[44:47], v[60:63]
    v_mfma_f32_16x16x32_bf16 v[64:67], a[188:191], v[40:43], v[64:67]
    v_mfma_f32_16x16x32_bf16 v[68:71], a[188:191], v[44:47], v[68:71]
    s_waitcnt vmcnt(22)
    s_barrier
    v_add_u32 v2, 40960, v2
    v_subrev_u32 v12, 102400, v2
    v_min_u32 v2, v2, v12
    v_xor_b32 v218, 64, v2
    s_waitcnt lgkmcnt(2)
    v_mfma_f32_16x16x32_bf16 v[48:51], a[32:35], v[16:19], v[48:51]
    ds_read_b128 v[32:35], v3 offset:0
    v_mfma_f32_16x16x32_bf16 v[52:55], a[32:35], v[20:23], v[52:55]
    v_mfma_f32_16x16x32_bf16 v[56:59], a[112:115], v[16:19], v[56:59]
    ds_read_b128 v[36:39], v3 offset:10240
    v_mfma_f32_16x16x32_bf16 v[60:63], a[112:115], v[20:23], v[60:63]
    v_mfma_f32_16x16x32_bf16 v[64:67], a[192:195], v[16:19], v[64:67]
    v_mfma_f32_16x16x32_bf16 v[68:71], a[192:195], v[20:23], v[68:71]
    s_waitcnt lgkmcnt(2)
    v_mfma_f32_16x16x32_bf16 v[48:51], a[36:39], v[24:27], v[48:51]
    ds_read_b128 v[40:43], v219 offset:0
    v_mfma_f32_16x16x32_bf16 v[52:55], a[36:39], v[28:31], v[52:55]
    v_mfma_f32_16x16x32_bf16 v[56:59], a[116:119], v[24:27], v[56:59]
    ds_read_b128 v[44:47], v219 offset:10240
    v_mfma_f32_16x16x32_bf16 v[60:63], a[116:119], v[28:31], v[60:63]
    v_mfma_f32_16x16x32_bf16 v[64:67], a[196:199], v[24:27], v[64:67]
    v_mfma_f32_16x16x32_bf16 v[68:71], a[196:199], v[28:31], v[68:71]
    s_waitcnt lgkmcnt(2)
    v_mfma_f32_16x16x32_bf16 v[48:51], a[40:43], v[32:35], v[48:51]
    ds_read_b128 v[16:19], v3 offset:1024
    v_mfma_f32_16x16x32_bf16 v[52:55], a[40:43], v[36:39], v[52:55]
    v_mfma_f32_16x16x32_bf16 v[56:59], a[120:123], v[32:35], v[56:59]
    ds_read_b128 v[20:23], v3 offset:11264
    v_mfma_f32_16x16x32_bf16 v[60:63], a[120:123], v[36:39], v[60:63]
    v_mfma_f32_16x16x32_bf16 v[64:67], a[200:203], v[32:35], v[64:67]
    s_add_u32 m0, s35, 0
    s_nop 0
    buffer_load_dwordx4 v1, s[8:11], s34 offen offset:0 lds
    v_mfma_f32_16x16x32_bf16 v[68:71], a[200:203], v[36:39], v[68:71]
    s_waitcnt lgkmcnt(2)
    v_mfma_f32_16x16x32_bf16 v[48:51], a[44:47], v[40:43], v[48:51]
    ds_read_b128 v[24:27], v219 offset:1024
    v_mfma_f32_16x16x32_bf16 v[52:55], a[44:47], v[44:47], v[52:55]
    v_mfma_f32_16x16x32_bf16 v[56:59], a[124:127], v[40:43], v[56:59]
    ds_read_b128 v[28:31], v219 offset:11264
    v_mfma_f32_16x16x32_bf16 v[60:63], a[124:127], v[44:47], v[60:63]
    v_mfma_f32_16x16x32_bf16 v[64:67], a[204:207], v[40:43], v[64:67]
    s_add_u32 m0, s35, 896
    s_nop 0
    buffer_load_dwordx4 v1, s[8:11], s34 offen offset:128 lds
    v_mfma_f32_16x16x32_bf16 v[68:71], a[204:207], v[44:47], v[68:71]
    s_waitcnt lgkmcnt(2)
    v_mfma_f32_16x16x32_bf16 v[48:51], a[48:51], v[16:19], v[48:51]
    ds_read_b128 v[32:35], v3 offset:2048
    v_mfma_f32_16x16x32_bf16 v[52:55], a[48:51], v[20:23], v[52:55]
    v_mfma_f32_16x16x32_bf16 v[56:59], a[128:131], v[16:19], v[56:59]
    ds_read_b128 v[36:39], v3 offset:12288
    v_mfma_f32_16x16x32_bf16 v[60:63], a[128:131], v[20:23], v[60:63]
    v_mfma_f32_16x16x32_bf16 v[64:67], a[208:211], v[16:19], v[64:67]
    s_add_u32 m0, s35, 1792
    s_nop 0
    buffer_load_dwordx4 v1, s[8:11], s34 offen offset:256 lds
    v_mfma_f32_16x16x32_bf16 v[68:71], a[208:211], v[20:23], v[68:71]
    s_waitcnt lgkmcnt(2)
    v_mfma_f32_16x16x32_bf16 v[48:51], a[52:55], v[24:27], v[48:51]
    ds_read_b128 v[40:43], v219 offset:2048
    v_mfma_f32_16x16x32_bf16 v[52:55], a[52:55], v[28:31], v[52:55]
    v_mfma_f32_16x16x32_bf16 v[56:59], a[132:135], v[24:27], v[56:59]
    ds_read_b128 v[44:47], v219 offset:12288
    v_mfma_f32_16x16x32_bf16 v[60:63], a[132:135], v[28:31], v[60:63]
    v_mfma_f32_16x16x32_bf16 v[64:67], a[212:215], v[24:27], v[64:67]
    s_add_u32 m0, s35, 2688
    s_nop 0
    buffer_load_dwordx4 v1, s[8:11], s34 offen offset:384 lds
    v_mfma_f32_16x16x32_bf16 v[68:71], a[212:215], v[28:31], v[68:71]
    s_waitcnt lgkmcnt(2)
    v_mfma_f32_16x16x32_bf16 v[48:51], a[56:59], v[32:35], v[48:51]
    ds_read_b128 v[16:19], v3 offset:3072
    v_mfma_f32_16x16x32_bf16 v[52:55], a[56:59], v[36:39], v[52:55]
    v_mfma_f32_16x16x32_bf16 v[56:59], a[136:139], v[32:35], v[56:59]
    ds_read_b128 v[20:23], v3 offset:13312
    v_mfma_f32_16x16x32_bf16 v[60:63], a[136:139], v[36:39], v[60:63]
    v_mfma_f32_16x16x32_bf16 v[64:67], a[216:219], v[32:35], v[64:67]
    s_add_u32 m0, s35, 3584
    s_nop 0
    buffer_load_dwordx4 v1, s[8:11], s34 offen offset:512 lds
    s_add_u32 s34, s34, 640
    s_add_u32 s35, s35, 20480
    s_add_u32 s29, s41, 102400
    s_cmp_ge_u32 s35, s29
    s_cselect_b32 s35, s41, s35
    v_mfma_f32_16x16x32_bf16 v[68:71], a[216:219], v[36:39], v[68:71]
    s_waitcnt lgkmcnt(2)
    v_mfma_f32_16x16x32_bf16 v[48:51], a[60:63], v[40:43], v[48:51]
    ds_read_b128 v[24:27], v219 offset:3072
    v_mfma_f32_16x16x32_bf16 v[52:55], a[60:63], v[44:47], v[52:55]
    v_mfma_f32_16x16x32_bf16 v[56:59], a[140:143], v[40:43], v[56:59]
    ds_read_b128 v[28:31], v219 offset:13312
    v_mfma_f32_16x16x32_bf16 v[60:63], a[140:143], v[44:47], v[60:63]
    v_mfma_f32_16x16x32_bf16 v[64:67], a[220:223], v[40:43], v[64:67]
    v_mfma_f32_16x16x32_bf16 v[68:71], a[220:223], v[44:47], v[68:71]
    buffer_load_dwordx4 v[96:99], v4, s[4:7], s37 offen offset:0 sc1
    s_waitcnt lgkmcnt(2)
    v_mfma_f32_16x16x32_bf16 v[48:51], a[64:67], v[16:19], v[48:51]
    ds_read_b128 v[32:35], v3 offset:4096
    v_mfma_f32_16x16x32_bf16 v[52:55], a[64:67], v[20:23], v[52:55]
    v_mfma_f32_16x16x32_bf16 v[56:59], a[144:147], v[16:19], v[56:59]
    ds_read_b128 v[36:39], v3 offset:14336
    v_mfma_f32_16x16x32_bf16 v[60:63], a[144:147], v[20:23], v[60:63]
    v_mfma_f32_16x16x32_bf16 v[64:67], a[224:227], v[16:19], v[64:67]
    v_mfma_f32_16x16x32_bf16 v[68:71], a[224:227], v[20:23], v[68:71]
    buffer_load_dwordx4 v[100:103], v4, s[4:7], s37 offen offset:1024 sc1
    s_waitcnt lgkmcnt(2)
    v_mfma_f32_16x16x32_bf16 v[48:51], a[68:71], v[24:27], v[48:51]
    ds_read_b128 v[40:43], v219 offset:4096
    v_mfma_f32_16x16x32_bf16 v[52:55], a[68:71], v[28:31], v[52:55]
    v_mfma_f32_16x16x32_bf16 v[56:59], a[148:151], v[24:27], v[56:59]
    ds_read_b128 v[44:47], v219 offset:14336
    v_mfma_f32_16x16x32_bf16 v[60:63], a[148:151], v[28:31], v[60:63]
    v_mfma_f32_16x16x32_bf16 v[64:67], a[228:231], v[24:27], v[64:67]
    v_mfma_f32_16x16x32_bf16 v[68:71], a[228:231], v[28:31], v[68:71]
    buffer_load_dwordx4 v[104:107], v4, s[4:7], s46 offen offset:0 sc1
    s_waitcnt vmcnt(13)
    s_barrier
    v_add_u32 v3, 40960, v3
    v_subrev_u32 v12, 102400, v3
    v_min_u32 v3, v3, v12
    v_xor_b32 v219, 64, v3
    s_waitcnt lgkmcnt(2)
    v_mfma_f32_16x16x32_bf16 v[48:51], a[72:75], v[32:35], v[48:51]
    ds_read_b128 v[16:19], v2 offset:0
    v_mfma_f32_16x16x32_bf16 v[52:55], a[72:75], v[36:39], v[52:55]
    v_mfma_f32_16x16x32_bf16 v[56:59], a[152:155], v[32:35], v[56:59]
    ds_read_b128 v[20:23], v2 offset:10240
    v_mfma_f32_16x16x32_bf16 v[60:63], a[152:155], v[36:39], v[60:63]
    v_mfma_f32_16x16x32_bf16 v[64:67], a[232:235], v[32:35], v[64:67]
    v_mfma_f32_16x16x32_bf16 v[68:71], a[232:235], v[36:39], v[68:71]
    buffer_load_dwordx4 v[120:123], v4, s[4:7], s37 offen offset:2048 sc1
    s_cmp_lg_u32 s16, 0
    s_cbranch_scc1 L_68
    s_cmp_eq_u32 s58, -1
    s_cbranch_scc1 L_68
    s_lshl_b32 s30, s17, 4
    s_add_u32 s29, s58, s30
    s_lshl_b32 s29, s29, 7
    s_add_u32 s29, s29, 184512512
    v_mov_b32 v13, 1
    s_mov_b64 exec, 1
    buffer_atomic_add v13, v10, s[4:7], s29 offen
    s_mov_b64 exec, -1
    L_68:
    s_waitcnt lgkmcnt(2)
    v_mfma_f32_16x16x32_bf16 v[48:51], a[76:79], v[40:43], v[48:51]
    ds_read_b128 v[24:27], v218 offset:0
    v_mfma_f32_16x16x32_bf16 v[52:55], a[76:79], v[44:47], v[52:55]
    v_mfma_f32_16x16x32_bf16 v[56:59], a[156:159], v[40:43], v[56:59]
    ds_read_b128 v[28:31], v218 offset:10240
    v_mfma_f32_16x16x32_bf16 v[60:63], a[156:159], v[44:47], v[60:63]
    v_mfma_f32_16x16x32_bf16 v[64:67], a[236:239], v[40:43], v[64:67]
    v_mfma_f32_16x16x32_bf16 v[68:71], a[236:239], v[44:47], v[68:71]
    buffer_load_dwordx4 v[124:127], v4, s[4:7], s37 offen offset:3072 sc1
    s_nop 1
    v_cvt_pk_bf16_f32 v224, v48, v49
    v_cvt_pk_bf16_f32 v225, v50, v51
    v_cvt_pk_bf16_f32 v228, v52, v53
    v_cvt_pk_bf16_f32 v229, v54, v55
    v_cvt_pk_bf16_f32 v226, v56, v57
    v_cvt_pk_bf16_f32 v227, v58, v59
    v_cvt_pk_bf16_f32 v230, v60, v61
    v_cvt_pk_bf16_f32 v231, v62, v63
    v_cvt_pk_bf16_f32 v232, v64, v65
    v_cvt_pk_bf16_f32 v233, v66, v67
    v_cvt_pk_bf16_f32 v234, v68, v69
    v_cvt_pk_bf16_f32 v235, v70, v71
    s_waitcnt lgkmcnt(2)
    v_mfma_f32_16x16x32_bf16 v[48:51], a[0:3], v[16:19], 0
    ds_read_b128 v[32:35], v2 offset:1024
    v_mfma_f32_16x16x32_bf16 v[52:55], a[0:3], v[20:23], 0
    v_mfma_f32_16x16x32_bf16 v[56:59], a[80:83], v[16:19], 0
    ds_read_b128 v[36:39], v2 offset:11264
    v_mfma_f32_16x16x32_bf16 v[60:63], a[80:83], v[20:23], 0
    v_mfma_f32_16x16x32_bf16 v[64:67], a[160:163], v[16:19], 0
    s_add_u32 m0, s35, 0
    s_nop 0
    buffer_load_dwordx4 v1, s[8:11], s34 offen offset:0 lds
    v_mfma_f32_16x16x32_bf16 v[68:71], a[160:163], v[20:23], 0
    ds_write_b128 v7, v[224:227] offset:0
    ds_write_b64 v8, v[232:233] offset:0
    s_waitcnt lgkmcnt(2)
    v_mfma_f32_16x16x32_bf16 v[48:51], a[4:7], v[24:27], v[48:51]
    ds_read_b128 v[40:43], v218 offset:1024
    v_mfma_f32_16x16x32_bf16 v[52:55], a[4:7], v[28:31], v[52:55]
    v_mfma_f32_16x16x32_bf16 v[56:59], a[84:87], v[24:27], v[56:59]
    ds_read_b128 v[44:47], v218 offset:11264
    v_mfma_f32_16x16x32_bf16 v[60:63], a[84:87], v[28:31], v[60:63]
    v_mfma_f32_16x16x32_bf16 v[64:67], a[164:167], v[24:27], v[64:67]
    s_add_u32 m0, s35, 896
    s_nop 0
    buffer_load_dwordx4 v1, s[8:11], s34 offen offset:128 lds
    v_mfma_f32_16x16x32_bf16 v[68:71], a[164:167], v[28:31], v[68:71]
    ds_write_b128 v7, v[228:231] offset:6144
    ds_write_b64 v8, v[234:235] offset:6144
    s_waitcnt lgkmcnt(2)
    v_mfma_f32_16x16x32_bf16 v[48:51], a[8:11], v[32:35], v[48:51]
    ds_read_b128 v[16:19], v2 offset:2048
    v_mfma_f32_16x16x32_bf16 v[52:55], a[8:11], v[36:39], v[52:55]
    v_mfma_f32_16x16x32_bf16 v[56:59], a[88:91], v[32:35], v[56:59]
    ds_read_b128 v[20:23], v2 offset:12288
    v_mfma_f32_16x16x32_bf16 v[60:63], a[88:91], v[36:39], v[60:63]
    v_mfma_f32_16x16x32_bf16 v[64:67], a[168:171], v[32:35], v[64:67]
    s_add_u32 m0, s35, 1792
    s_nop 0
    buffer_load_dwordx4 v1, s[8:11], s34 offen offset:256 lds
    v_mfma_f32_16x16x32_bf16 v[68:71], a[168:171], v[36:39], v[68:71]
    s_waitcnt lgkmcnt(2)
    v_mfma_f32_16x16x32_bf16 v[48:51], a[12:15], v[40:43], v[48:51]
    ds_read_b128 v[24:27], v218 offset:2048
    v_mfma_f32_16x16x32_bf16 v[52:55], a[12:15], v[44:47], v[52:55]
    v_mfma_f32_16x16x32_bf16 v[56:59], a[92:95], v[40:43], v[56:59]
    ds_read_b128 v[28:31], v218 offset:12288
    v_mfma_f32_16x16x32_bf16 v[60:63], a[92:95], v[44:47], v[60:63]
    v_mfma_f32_16x16x32_bf16 v[64:67], a[172:175], v[40:43], v[64:67]
    s_add_u32 m0, s35, 2688
    s_nop 0
    buffer_load_dwordx4 v1, s[8:11], s34 offen offset:384 lds
    v_mfma_f32_16x16x32_bf16 v[68:71], a[172:175], v[44:47], v[68:71]
    s_waitcnt lgkmcnt(2)
    v_mfma_f32_16x16x32_bf16 v[48:51], a[16:19], v[16:19], v[48:51]
    ds_read_b128 v[32:35], v2 offset:3072
    v_mfma_f32_16x16x32_bf16 v[52:55], a[16:19], v[20:23], v[52:55]
    v_mfma_f32_16x16x32_bf16 v[56:59], a[96:99], v[16:19], v[56:59]
    ds_read_b128 v[36:39], v2 offset:13312
    v_mfma_f32_16x16x32_bf16 v[60:63], a[96:99], v[20:23], v[60:63]
    v_mfma_f32_16x16x32_bf16 v[64:67], a[176:179], v[16:19], v[64:67]
    s_add_u32 m0, s35, 3584
    s_nop 0
    buffer_load_dwordx4 v1, s[8:11], s34 offen offset:512 lds
    s_add_u32 s34, s34, 40320
    s_add_u32 s35, s35, 20480
    s_add_u32 s29, s41, 102400
    s_cmp_ge_u32 s35, s29
    s_cselect_b32 s35, s41, s35
    v_mfma_f32_16x16x32_bf16 v[68:71], a[176:179], v[20:23], v[68:71]
    s_waitcnt lgkmcnt(2)
    v_mfma_f32_16x16x32_bf16 v[48:51], a[20:23], v[24:27], v[48:51]
    ds_read_b128 v[40:43], v218 offset:3072
    v_mfma_f32_16x16x32_bf16 v[52:55], a[20:23], v[28:31], v[52:55]
    v_mfma_f32_16x16x32_bf16 v[56:59], a[100:103], v[24:27], v[56:59]
    ds_read_b128 v[44:47], v218 offset:13312
    v_mfma_f32_16x16x32_bf16 v[60:63], a[100:103], v[28:31], v[60:63]
    v_mfma_f32_16x16x32_bf16 v[64:67], a[180:183], v[24:27], v[64:67]
    v_mfma_f32_16x16x32_bf16 v[68:71], a[180:183], v[28:31], v[68:71]
    buffer_load_dwordx4 v[128:131], v4, s[4:7], s46 offen offset:1024 sc1
    s_waitcnt lgkmcnt(2)
    v_mfma_f32_16x16x32_bf16 v[48:51], a[24:27], v[32:35], v[48:51]
    ds_read_b128 v[16:19], v2 offset:4096
    v_mfma_f32_16x16x32_bf16 v[52:55], a[24:27], v[36:39], v[52:55]
    v_mfma_f32_16x16x32_bf16 v[56:59], a[104:107], v[32:35], v[56:59]
    ds_read_b128 v[20:23], v2 offset:14336
    v_mfma_f32_16x16x32_bf16 v[60:63], a[104:107], v[36:39], v[60:63]
    v_mfma_f32_16x16x32_bf16 v[64:67], a[184:187], v[32:35], v[64:67]
    v_mfma_f32_16x16x32_bf16 v[68:71], a[184:187], v[36:39], v[68:71]
    buffer_load_dwordx4 v[108:111], v4, s[4:7], s47 offen offset:0 sc1
    s_waitcnt lgkmcnt(2)
    v_mfma_f32_16x16x32_bf16 v[48:51], a[28:31], v[40:43], v[48:51]
    ds_read_b128 v[24:27], v218 offset:4096
    v_mfma_f32_16x16x32_bf16 v[52:55], a[28:31], v[44:47], v[52:55]
    v_mfma_f32_16x16x32_bf16 v[56:59], a[108:111], v[40:43], v[56:59]
    ds_read_b128 v[28:31], v218 offset:14336
    v_mfma_f32_16x16x32_bf16 v[60:63], a[108:111], v[44:47], v[60:63]
    v_mfma_f32_16x16x32_bf16 v[64:67], a[188:191], v[40:43], v[64:67]
    v_mfma_f32_16x16x32_bf16 v[68:71], a[188:191], v[44:47], v[68:71]
    buffer_load_dwordx4 v[112:115], v4, s[4:7], s47 offen offset:1024 sc1
    s_waitcnt vmcnt(18)
    s_barrier
    v_add_u32 v2, 40960, v2
    v_subrev_u32 v12, 102400, v2
    v_min_u32 v2, v2, v12
    v_xor_b32 v218, 64, v2
    s_waitcnt lgkmcnt(2)
    v_mfma_f32_16x16x32_bf16 v[48:51], a[32:35], v[16:19], v[48:51]
    ds_read_b128 v[32:35], v3 offset:0
    v_mfma_f32_16x16x32_bf16 v[52:55], a[32:35], v[20:23], v[52:55]
    v_mfma_f32_16x16x32_bf16 v[56:59], a[112:115], v[16:19], v[56:59]
    ds_read_b128 v[36:39], v3 offset:10240
    v_mfma_f32_16x16x32_bf16 v[60:63], a[112:115], v[20:23], v[60:63]
    v_mfma_f32_16x16x32_bf16 v[64:67], a[192:195], v[16:19], v[64:67]
    v_mfma_f32_16x16x32_bf16 v[68:71], a[192:195], v[20:23], v[68:71]
    buffer_load_dwordx4 v[116:119], v4, s[4:7], s40 offen offset:0 sc1
    s_waitcnt lgkmcnt(2)
    v_mfma_f32_16x16x32_bf16 v[48:51], a[36:39], v[24:27], v[48:51]
    ds_read_b128 v[40:43], v219 offset:0
    v_mfma_f32_16x16x32_bf16 v[52:55], a[36:39], v[28:31], v[52:55]
    v_mfma_f32_16x16x32_bf16 v[56:59], a[116:119], v[24:27], v[56:59]
    ds_read_b128 v[44:47], v219 offset:10240
    v_mfma_f32_16x16x32_bf16 v[60:63], a[116:119], v[28:31], v[60:63]
    v_mfma_f32_16x16x32_bf16 v[64:67], a[196:199], v[24:27], v[64:67]
    v_mfma_f32_16x16x32_bf16 v[68:71], a[196:199], v[28:31], v[68:71]
    buffer_load_dwordx4 v[132:135], v4, s[4:7], s47 offen offset:2048 sc1
    s_waitcnt lgkmcnt(2)
    v_mfma_f32_16x16x32_bf16 v[48:51], a[40:43], v[32:35], v[48:51]
    ds_read_b128 v[16:19], v3 offset:1024
    v_mfma_f32_16x16x32_bf16 v[52:55], a[40:43], v[36:39], v[52:55]
    v_mfma_f32_16x16x32_bf16 v[56:59], a[120:123], v[32:35], v[56:59]
    ds_read_b128 v[20:23], v3 offset:11264
    v_mfma_f32_16x16x32_bf16 v[60:63], a[120:123], v[36:39], v[60:63]
    v_mfma_f32_16x16x32_bf16 v[64:67], a[200:203], v[32:35], v[64:67]
    s_add_u32 m0, s35, 0
    s_nop 0
    buffer_load_dwordx4 v1, s[8:11], s34 offen offset:0 lds
    v_mfma_f32_16x16x32_bf16 v[68:71], a[200:203], v[36:39], v[68:71]
    s_waitcnt lgkmcnt(2)
    v_mfma_f32_16x16x32_bf16 v[48:51], a[44:47], v[40:43], v[48:51]
    ds_read_b128 v[24:27], v219 offset:1024
    v_mfma_f32_16x16x32_bf16 v[52:55], a[44:47], v[44:47], v[52:55]
    v_mfma_f32_16x16x32_bf16 v[56:59], a[124:127], v[40:43], v[56:59]
    ds_read_b128 v[28:31], v219 offset:11264
    v_mfma_f32_16x16x32_bf16 v[60:63], a[124:127], v[44:47], v[60:63]
    v_mfma_f32_16x16x32_bf16 v[64:67], a[204:207], v[40:43], v[64:67]
    s_add_u32 m0, s35, 896
    s_nop 0
    buffer_load_dwordx4 v1, s[8:11], s34 offen offset:128 lds
    v_mfma_f32_16x16x32_bf16 v[68:71], a[204:207], v[44:47], v[68:71]
    s_waitcnt lgkmcnt(2)
    v_mfma_f32_16x16x32_bf16 v[48:51], a[48:51], v[16:19], v[48:51]
    ds_read_b128 v[32:35], v3 offset:2048
    v_mfma_f32_16x16x32_bf16 v[52:55], a[48:51], v[20:23], v[52:55]
    v_mfma_f32_16x16x32_bf16 v[56:59], a[128:131], v[16:19], v[56:59]
    ds_read_b128 v[36:39], v3 offset:12288
    v_mfma_f32_16x16x32_bf16 v[60:63], a[128:131], v[20:23], v[60:63]
    v_mfma_f32_16x16x32_bf16 v[64:67], a[208:211], v[16:19], v[64:67]
    s_add_u32 m0, s35, 1792
    s_nop 0
    buffer_load_dwordx4 v1, s[8:11], s34 offen offset:256 lds
    v_mfma_f32_16x16x32_bf16 v[68:71], a[208:211], v[20:23], v[68:71]
    s_waitcnt lgkmcnt(2)
    v_mfma_f32_16x16x32_bf16 v[48:51], a[52:55], v[24:27], v[48:51]
    ds_read_b128 v[40:43], v219 offset:2048
    v_mfma_f32_16x16x32_bf16 v[52:55], a[52:55], v[28:31], v[52:55]
    v_mfma_f32_16x16x32_bf16 v[56:59], a[132:135], v[24:27], v[56:59]
    ds_read_b128 v[44:47], v219 offset:12288
    v_mfma_f32_16x16x32_bf16 v[60:63], a[132:135], v[28:31], v[60:63]
    v_mfma_f32_16x16x32_bf16 v[64:67], a[212:215], v[24:27], v[64:67]
    s_add_u32 m0, s35, 2688
    s_nop 0
    buffer_load_dwordx4 v1, s[8:11], s34 offen offset:384 lds
    v_mfma_f32_16x16x32_bf16 v[68:71], a[212:215], v[28:31], v[68:71]
    s_waitcnt lgkmcnt(2)
    v_mfma_f32_16x16x32_bf16 v[48:51], a[56:59], v[32:35], v[48:51]
    ds_read_b128 v[16:19], v3 offset:3072
    v_mfma_f32_16x16x32_bf16 v[52:55], a[56:59], v[36:39], v[52:55]
    v_mfma_f32_16x16x32_bf16 v[56:59], a[136:139], v[32:35], v[56:59]
    ds_read_b128 v[20:23], v3 offset:13312
    v_mfma_f32_16x16x32_bf16 v[60:63], a[136:139], v[36:39], v[60:63]
    v_mfma_f32_16x16x32_bf16 v[64:67], a[216:219], v[32:35], v[64:67]
    s_add_u32 m0, s35, 3584
    s_nop 0
    buffer_load_dwordx4 v1, s[8:11], s34 offen offset:512 lds
    s_add_u32 s34, s34, 640
    s_add_u32 s35, s35, 20480
    s_add_u32 s29, s41, 102400
    s_cmp_ge_u32 s35, s29
    s_cselect_b32 s35, s41, s35
    v_mfma_f32_16x16x32_bf16 v[68:71], a[216:219], v[36:39], v[68:71]
    s_waitcnt lgkmcnt(2)
    v_mfma_f32_16x16x32_bf16 v[48:51], a[60:63], v[40:43], v[48:51]
    ds_read_b128 v[24:27], v219 offset:3072
    v_mfma_f32_16x16x32_bf16 v[52:55], a[60:63], v[44:47], v[52:55]
    v_mfma_f32_16x16x32_bf16 v[56:59], a[140:143], v[40:43], v[56:59]
    ds_read_b128 v[28:31], v219 offset:13312
    v_mfma_f32_16x16x32_bf16 v[60:63], a[140:143], v[44:47], v[60:63]
    v_mfma_f32_16x16x32_bf16 v[64:67], a[220:223], v[40:43], v[64:67]
    v_mfma_f32_16x16x32_bf16 v[68:71], a[220:223], v[44:47], v[68:71]
    buffer_load_dwordx4 v[136:139], v4, s[4:7], s47 offen offset:3072 sc1
    s_waitcnt lgkmcnt(2)
    v_mfma_f32_16x16x32_bf16 v[48:51], a[64:67], v[16:19], v[48:51]
    ds_read_b128 v[32:35], v3 offset:4096
    v_mfma_f32_16x16x32_bf16 v[52:55], a[64:67], v[20:23], v[52:55]
    v_mfma_f32_16x16x32_bf16 v[56:59], a[144:147], v[16:19], v[56:59]
    ds_read_b128 v[36:39], v3 offset:14336
    v_mfma_f32_16x16x32_bf16 v[60:63], a[144:147], v[20:23], v[60:63]
    v_mfma_f32_16x16x32_bf16 v[64:67], a[224:227], v[16:19], v[64:67]
    v_mfma_f32_16x16x32_bf16 v[68:71], a[224:227], v[20:23], v[68:71]
    buffer_load_dwordx4 v[140:143], v4, s[4:7], s40 offen offset:1024 sc1
    s_waitcnt lgkmcnt(2)
    v_mfma_f32_16x16x32_bf16 v[48:51], a[68:71], v[24:27], v[48:51]
    ds_read_b128 v[40:43], v219 offset:4096
    v_mfma_f32_16x16x32_bf16 v[52:55], a[68:71], v[28:31], v[52:55]
    v_mfma_f32_16x16x32_bf16 v[56:59], a[148:151], v[24:27], v[56:59]
    ds_read_b128 v[44:47], v219 offset:14336
    v_mfma_f32_16x16x32_bf16 v[60:63], a[148:151], v[28:31], v[60:63]
    v_mfma_f32_16x16x32_bf16 v[64:67], a[228:231], v[24:27], v[64:67]
    v_mfma_f32_16x16x32_bf16 v[68:71], a[228:231], v[28:31], v[68:71]
    buffer_load_dwordx4 v[144:147], v4, s[4:7], s48 offen offset:0 sc1
    s_waitcnt vmcnt(23)
    s_barrier
    v_add_u32 v3, 40960, v3
    v_subrev_u32 v12, 102400, v3
    v_min_u32 v3, v3, v12
    v_xor_b32 v219, 64, v3
    s_waitcnt lgkmcnt(2)
    v_mfma_f32_16x16x32_bf16 v[48:51], a[72:75], v[32:35], v[48:51]
    ds_read_b128 v[16:19], v2 offset:0
    v_mfma_f32_16x16x32_bf16 v[52:55], a[72:75], v[36:39], v[52:55]
    v_mfma_f32_16x16x32_bf16 v[56:59], a[152:155], v[32:35], v[56:59]
    ds_read_b128 v[20:23], v2 offset:10240
    v_mfma_f32_16x16x32_bf16 v[60:63], a[152:155], v[36:39], v[60:63]
    v_mfma_f32_16x16x32_bf16 v[64:67], a[232:235], v[32:35], v[64:67]
    v_mfma_f32_16x16x32_bf16 v[68:71], a[232:235], v[36:39], v[68:71]
    buffer_load_dwordx4 v[148:151], v4, s[4:7], s48 offen offset:1024 sc1
    s_waitcnt lgkmcnt(2)
    v_mfma_f32_16x16x32_bf16 v[48:51], a[76:79], v[40:43], v[48:51]
    ds_read_b128 v[24:27], v218 offset:0
    v_mfma_f32_16x16x32_bf16 v[52:55], a[76:79], v[44:47], v[52:55]
    v_mfma_f32_16x16x32_bf16 v[56:59], a[156:159], v[40:43], v[56:59]
    ds_read_b128 v[28:31], v218 offset:10240
    v_mfma_f32_16x16x32_bf16 v[60:63], a[156:159], v[44:47], v[60:63]
    v_mfma_f32_16x16x32_bf16 v[64:67], a[236:239], v[40:43], v[64:67]
    v_mfma_f32_16x16x32_bf16 v[68:71], a[236:239], v[44:47], v[68:71]
    buffer_load_dwordx4 v[152:155], v4, s[4:7], s48 offen offset:2048 sc1
    s_nop 1
    v_cvt_pk_bf16_f32 v224, v48, v49
    v_cvt_pk_bf16_f32 v225, v50, v51
    v_cvt_pk_bf16_f32 v228, v52, v53
    v_cvt_pk_bf16_f32 v229, v54, v55
    v_cvt_pk_bf16_f32 v226, v56, v57
    v_cvt_pk_bf16_f32 v227, v58, v59
    v_cvt_pk_bf16_f32 v230, v60, v61
    v_cvt_pk_bf16_f32 v231, v62, v63
    v_cvt_pk_bf16_f32 v232, v64, v65
    v_cvt_pk_bf16_f32 v233, v66, v67
    v_cvt_pk_bf16_f32 v234, v68, v69
    v_cvt_pk_bf16_f32 v235, v70, v71
    s_waitcnt lgkmcnt(2)
    v_mfma_f32_16x16x32_bf16 v[48:51], a[0:3], v[16:19], 0
    ds_read_b128 v[32:35], v2 offset:1024
    v_mfma_f32_16x16x32_bf16 v[52:55], a[0:3], v[20:23], 0
    v_mfma_f32_16x16x32_bf16 v[56:59], a[80:83], v[16:19], 0
    ds_read_b128 v[36:39], v2 offset:11264
    v_mfma_f32_16x16x32_bf16 v[60:63], a[80:83], v[20:23], 0
    v_mfma_f32_16x16x32_bf16 v[64:67], a[160:163], v[16:19], 0
    s_add_u32 m0, s35, 0
    s_nop 0
    buffer_load_dwordx4 v1, s[8:11], s34 offen offset:0 lds
    v_mfma_f32_16x16x32_bf16 v[68:71], a[160:163], v[20:23], 0
    ds_write_b128 v7, v[224:227] offset:12288
    ds_write_b64 v8, v[232:233] offset:12288
    s_waitcnt lgkmcnt(2)
    v_mfma_f32_16x16x32_bf16 v[48:51], a[4:7], v[24:27], v[48:51]
    ds_read_b128 v[40:43], v218 offset:1024
    v_mfma_f32_16x16x32_bf16 v[52:55], a[4:7], v[28:31], v[52:55]
    v_mfma_f32_16x16x32_bf16 v[56:59], a[84:87], v[24:27], v[56:59]
    ds_read_b128 v[44:47], v218 offset:11264
    v_mfma_f32_16x16x32_bf16 v[60:63], a[84:87], v[28:31], v[60:63]
    v_mfma_f32_16x16x32_bf16 v[64:67], a[164:167], v[24:27], v[64:67]
    s_add_u32 m0, s35, 896
    s_nop 0
    buffer_load_dwordx4 v1, s[8:11], s34 offen offset:128 lds
    v_mfma_f32_16x16x32_bf16 v[68:71], a[164:167], v[28:31], v[68:71]
    ds_write_b128 v7, v[228:231] offset:18432
    ds_write_b64 v8, v[234:235] offset:18432
    s_waitcnt lgkmcnt(2)
    v_mfma_f32_16x16x32_bf16 v[48:51], a[8:11], v[32:35], v[48:51]
    ds_read_b128 v[16:19], v2 offset:2048
    v_mfma_f32_16x16x32_bf16 v[52:55], a[8:11], v[36:39], v[52:55]
    v_mfma_f32_16x16x32_bf16 v[56:59], a[88:91], v[32:35], v[56:59]
    ds_read_b128 v[20:23], v2 offset:12288
    v_mfma_f32_16x16x32_bf16 v[60:63], a[88:91], v[36:39], v[60:63]
    v_mfma_f32_16x16x32_bf16 v[64:67], a[168:171], v[32:35], v[64:67]
    s_add_u32 m0, s35, 1792
    s_nop 0
    buffer_load_dwordx4 v1, s[8:11], s34 offen offset:256 lds
    v_mfma_f32_16x16x32_bf16 v[68:71], a[168:171], v[36:39], v[68:71]
    s_waitcnt lgkmcnt(2)
    v_mfma_f32_16x16x32_bf16 v[48:51], a[12:15], v[40:43], v[48:51]
    ds_read_b128 v[24:27], v218 offset:2048
    v_mfma_f32_16x16x32_bf16 v[52:55], a[12:15], v[44:47], v[52:55]
    v_mfma_f32_16x16x32_bf16 v[56:59], a[92:95], v[40:43], v[56:59]
    ds_read_b128 v[28:31], v218 offset:12288
    v_mfma_f32_16x16x32_bf16 v[60:63], a[92:95], v[44:47], v[60:63]
    v_mfma_f32_16x16x32_bf16 v[64:67], a[172:175], v[40:43], v[64:67]
    s_add_u32 m0, s35, 2688
    s_nop 0
    buffer_load_dwordx4 v1, s[8:11], s34 offen offset:384 lds
    v_mfma_f32_16x16x32_bf16 v[68:71], a[172:175], v[44:47], v[68:71]
    s_waitcnt lgkmcnt(2)
    v_mfma_f32_16x16x32_bf16 v[48:51], a[16:19], v[16:19], v[48:51]
    ds_read_b128 v[32:35], v2 offset:3072
    v_mfma_f32_16x16x32_bf16 v[52:55], a[16:19], v[20:23], v[52:55]
    v_mfma_f32_16x16x32_bf16 v[56:59], a[96:99], v[16:19], v[56:59]
    ds_read_b128 v[36:39], v2 offset:13312
    v_mfma_f32_16x16x32_bf16 v[60:63], a[96:99], v[20:23], v[60:63]
    v_mfma_f32_16x16x32_bf16 v[64:67], a[176:179], v[16:19], v[64:67]
    s_add_u32 m0, s35, 3584
    s_nop 0
    buffer_load_dwordx4 v1, s[8:11], s34 offen offset:512 lds
    s_add_u32 s34, s34, 40320
    s_add_u32 s35, s35, 20480
    s_add_u32 s29, s41, 102400
    s_cmp_ge_u32 s35, s29
    s_cselect_b32 s35, s41, s35
    s_add_u32 s34, s34, s56
    v_mfma_f32_16x16x32_bf16 v[68:71], a[176:179], v[20:23], v[68:71]
    s_waitcnt lgkmcnt(2)
    v_mfma_f32_16x16x32_bf16 v[48:51], a[20:23], v[24:27], v[48:51]
    ds_read_b128 v[40:43], v218 offset:3072
    v_mfma_f32_16x16x32_bf16 v[52:55], a[20:23], v[28:31], v[52:55]
    v_mfma_f32_16x16x32_bf16 v[56:59], a[100:103], v[24:27], v[56:59]
    ds_read_b128 v[44:47], v218 offset:13312
    v_mfma_f32_16x16x32_bf16 v[60:63], a[100:103], v[28:31], v[60:63]
    v_mfma_f32_16x16x32_bf16 v[64:67], a[180:183], v[24:27], v[64:67]
    v_mfma_f32_16x16x32_bf16 v[68:71], a[180:183], v[28:31], v[68:71]
    buffer_load_dwordx4 v[156:159], v4, s[4:7], s48 offen offset:3072 sc1
    s_waitcnt lgkmcnt(2)
    v_mfma_f32_16x16x32_bf16 v[48:51], a[24:27], v[32:35], v[48:51]
    ds_read_b128 v[16:19], v2 offset:4096
    v_mfma_f32_16x16x32_bf16 v[52:55], a[24:27], v[36:39], v[52:55]
    v_mfma_f32_16x16x32_bf16 v[56:59], a[104:107], v[32:35], v[56:59]
    ds_read_b128 v[20:23], v2 offset:14336
    v_mfma_f32_16x16x32_bf16 v[60:63], a[104:107], v[36:39], v[60:63]
    v_mfma_f32_16x16x32_bf16 v[64:67], a[184:187], v[32:35], v[64:67]
    v_mfma_f32_16x16x32_bf16 v[68:71], a[184:187], v[36:39], v[68:71]
    buffer_load_dwordx4 v[160:163], v4, s[4:7], s49 offen offset:0 sc1
    s_waitcnt lgkmcnt(2)
    v_mfma_f32_16x16x32_bf16 v[48:51], a[28:31], v[40:43], v[48:51]
    ds_read_b128 v[24:27], v218 offset:4096
    v_mfma_f32_16x16x32_bf16 v[52:55], a[28:31], v[44:47], v[52:55]
    v_mfma_f32_16x16x32_bf16 v[56:59], a[108:111], v[40:43], v[56:59]
    ds_read_b128 v[28:31], v218 offset:14336
    v_mfma_f32_16x16x32_bf16 v[60:63], a[108:111], v[44:47], v[60:63]
    v_mfma_f32_16x16x32_bf16 v[64:67], a[188:191], v[40:43], v[64:67]
    v_mfma_f32_16x16x32_bf16 v[68:71], a[188:191], v[44:47], v[68:71]
    buffer_load_dwordx4 v[164:167], v4, s[4:7], s49 offen offset:1024 sc1
    s_waitcnt vmcnt(23)
    s_barrier
    v_add_u32 v2, 40960, v2
    v_subrev_u32 v12, 102400, v2
    v_min_u32 v2, v2, v12
    v_xor_b32 v218, 64, v2
    s_waitcnt lgkmcnt(2)
    v_mfma_f32_16x16x32_bf16 v[48:51], a[32:35], v[16:19], v[48:51]
    ds_read_b128 v[32:35], v3 offset:0
    v_mfma_f32_16x16x32_bf16 v[52:55], a[32:35], v[20:23], v[52:55]
    v_mfma_f32_16x16x32_bf16 v[56:59], a[112:115], v[16:19], v[56:59]
    ds_read_b128 v[36:39], v3 offset:10240
    v_mfma_f32_16x16x32_bf16 v[60:63], a[112:115], v[20:23], v[60:63]
    v_mfma_f32_16x16x32_bf16 v[64:67], a[192:195], v[16:19], v[64:67]
    v_mfma_f32_16x16x32_bf16 v[68:71], a[192:195], v[20:23], v[68:71]
    buffer_load_dwordx4 v[168:171], v4, s[4:7], s49 offen offset:2048 sc1
    s_waitcnt lgkmcnt(2)
    v_mfma_f32_16x16x32_bf16 v[48:51], a[36:39], v[24:27], v[48:51]
    ds_read_b128 v[40:43], v219 offset:0
    v_mfma_f32_16x16x32_bf16 v[52:55], a[36:39], v[28:31], v[52:55]
    v_mfma_f32_16x16x32_bf16 v[56:59], a[116:119], v[24:27], v[56:59]
    ds_read_b128 v[44:47], v219 offset:10240
    v_mfma_f32_16x16x32_bf16 v[60:63], a[116:119], v[28:31], v[60:63]
    v_mfma_f32_16x16x32_bf16 v[64:67], a[196:199], v[24:27], v[64:67]
    v_mfma_f32_16x16x32_bf16 v[68:71], a[196:199], v[28:31], v[68:71]
    buffer_load_dwordx4 v[172:175], v4, s[4:7], s49 offen offset:3072 sc1
    s_waitcnt lgkmcnt(2)
    v_mfma_f32_16x16x32_bf16 v[48:51], a[40:43], v[32:35], v[48:51]
    ds_read_b128 v[16:19], v3 offset:1024
    v_mfma_f32_16x16x32_bf16 v[52:55], a[40:43], v[36:39], v[52:55]
    v_mfma_f32_16x16x32_bf16 v[56:59], a[120:123], v[32:35], v[56:59]
    ds_read_b128 v[20:23], v3 offset:11264
    v_mfma_f32_16x16x32_bf16 v[60:63], a[120:123], v[36:39], v[60:63]
    v_mfma_f32_16x16x32_bf16 v[64:67], a[200:203], v[32:35], v[64:67]
    s_add_u32 m0, s35, 0
    s_nop 0
    buffer_load_dwordx4 v1, s[8:11], s34 offen offset:0 lds
    v_mfma_f32_16x16x32_bf16 v[68:71], a[200:203], v[36:39], v[68:71]
    s_waitcnt lgkmcnt(2)
    v_mfma_f32_16x16x32_bf16 v[48:51], a[44:47], v[40:43], v[48:51]
    ds_read_b128 v[24:27], v219 offset:1024
    v_mfma_f32_16x16x32_bf16 v[52:55], a[44:47], v[44:47], v[52:55]
    v_mfma_f32_16x16x32_bf16 v[56:59], a[124:127], v[40:43], v[56:59]
    ds_read_b128 v[28:31], v219 offset:11264
    v_mfma_f32_16x16x32_bf16 v[60:63], a[124:127], v[44:47], v[60:63]
    v_mfma_f32_16x16x32_bf16 v[64:67], a[204:207], v[40:43], v[64:67]
    s_add_u32 m0, s35, 896
    s_nop 0
    buffer_load_dwordx4 v1, s[8:11], s34 offen offset:128 lds
    v_mfma_f32_16x16x32_bf16 v[68:71], a[204:207], v[44:47], v[68:71]
    s_waitcnt lgkmcnt(2)
    v_mfma_f32_16x16x32_bf16 v[48:51], a[48:51], v[16:19], v[48:51]
    ds_read_b128 v[32:35], v3 offset:2048
    v_mfma_f32_16x16x32_bf16 v[52:55], a[48:51], v[20:23], v[52:55]
    v_mfma_f32_16x16x32_bf16 v[56:59], a[128:131], v[16:19], v[56:59]
    ds_read_b128 v[36:39], v3 offset:12288
    v_mfma_f32_16x16x32_bf16 v[60:63], a[128:131], v[20:23], v[60:63]
    v_mfma_f32_16x16x32_bf16 v[64:67], a[208:211], v[16:19], v[64:67]
    s_add_u32 m0, s35, 1792
    s_nop 0
    buffer_load_dwordx4 v1, s[8:11], s34 offen offset:256 lds
    v_mfma_f32_16x16x32_bf16 v[68:71], a[208:211], v[20:23], v[68:71]
    s_waitcnt lgkmcnt(2)
    v_mfma_f32_16x16x32_bf16 v[48:51], a[52:55], v[24:27], v[48:51]
    ds_read_b128 v[40:43], v219 offset:2048
    v_mfma_f32_16x16x32_bf16 v[52:55], a[52:55], v[28:31], v[52:55]
    v_mfma_f32_16x16x32_bf16 v[56:59], a[132:135], v[24:27], v[56:59]
    ds_read_b128 v[44:47], v219 offset:12288
    v_mfma_f32_16x16x32_bf16 v[60:63], a[132:135], v[28:31], v[60:63]
    v_mfma_f32_16x16x32_bf16 v[64:67], a[212:215], v[24:27], v[64:67]
    s_add_u32 m0, s35, 2688
    s_nop 0
    buffer_load_dwordx4 v1, s[8:11], s34 offen offset:384 lds
    v_mfma_f32_16x16x32_bf16 v[68:71], a[212:215], v[28:31], v[68:71]
    s_waitcnt lgkmcnt(2)
    v_mfma_f32_16x16x32_bf16 v[48:51], a[56:59], v[32:35], v[48:51]
    ds_read_b128 v[16:19], v3 offset:3072
    v_mfma_f32_16x16x32_bf16 v[52:55], a[56:59], v[36:39], v[52:55]
    v_mfma_f32_16x16x32_bf16 v[56:59], a[136:139], v[32:35], v[56:59]
    ds_read_b128 v[20:23], v3 offset:13312
    v_mfma_f32_16x16x32_bf16 v[60:63], a[136:139], v[36:39], v[60:63]
    v_mfma_f32_16x16x32_bf16 v[64:67], a[216:219], v[32:35], v[64:67]
    s_add_u32 m0, s35, 3584
    s_nop 0
    buffer_load_dwordx4 v1, s[8:11], s34 offen offset:512 lds
    s_add_u32 s34, s34, 640
    s_add_u32 s35, s35, 20480
    s_add_u32 s29, s41, 102400
    s_cmp_ge_u32 s35, s29
    s_cselect_b32 s35, s41, s35
    v_mfma_f32_16x16x32_bf16 v[68:71], a[216:219], v[36:39], v[68:71]
    s_waitcnt lgkmcnt(2)
    v_mfma_f32_16x16x32_bf16 v[48:51], a[60:63], v[40:43], v[48:51]
    ds_read_b128 v[24:27], v219 offset:3072
    v_mfma_f32_16x16x32_bf16 v[52:55], a[60:63], v[44:47], v[52:55]
    v_mfma_f32_16x16x32_bf16 v[56:59], a[140:143], v[40:43], v[56:59]
    ds_read_b128 v[28:31], v219 offset:13312
    v_mfma_f32_16x16x32_bf16 v[60:63], a[140:143], v[44:47], v[60:63]
    v_mfma_f32_16x16x32_bf16 v[64:67], a[220:223], v[40:43], v[64:67]
    v_mfma_f32_16x16x32_bf16 v[68:71], a[220:223], v[44:47], v[68:71]
    buffer_load_dwordx4 v[176:179], v4, s[4:7], s50 offen offset:0 sc1
    s_waitcnt lgkmcnt(2)
    v_mfma_f32_16x16x32_bf16 v[48:51], a[64:67], v[16:19], v[48:51]
    ds_read_b128 v[32:35], v3 offset:4096
    v_mfma_f32_16x16x32_bf16 v[52:55], a[64:67], v[20:23], v[52:55]
    v_mfma_f32_16x16x32_bf16 v[56:59], a[144:147], v[16:19], v[56:59]
    ds_read_b128 v[36:39], v3 offset:14336
    v_mfma_f32_16x16x32_bf16 v[60:63], a[144:147], v[20:23], v[60:63]
    v_mfma_f32_16x16x32_bf16 v[64:67], a[224:227], v[16:19], v[64:67]
    v_mfma_f32_16x16x32_bf16 v[68:71], a[224:227], v[20:23], v[68:71]
    buffer_load_dwordx4 v[180:183], v4, s[4:7], s50 offen offset:1024 sc1
    s_waitcnt lgkmcnt(2)
    v_mfma_f32_16x16x32_bf16 v[48:51], a[68:71], v[24:27], v[48:51]
    ds_read_b128 v[40:43], v219 offset:4096
    v_mfma_f32_16x16x32_bf16 v[52:55], a[68:71], v[28:31], v[52:55]
    v_mfma_f32_16x16x32_bf16 v[56:59], a[148:151], v[24:27], v[56:59]
    ds_read_b128 v[44:47], v219 offset:14336
    v_mfma_f32_16x16x32_bf16 v[60:63], a[148:151], v[28:31], v[60:63]
    v_mfma_f32_16x16x32_bf16 v[64:67], a[228:231], v[24:27], v[64:67]
    v_mfma_f32_16x16x32_bf16 v[68:71], a[228:231], v[28:31], v[68:71]
    buffer_load_dwordx4 v[184:187], v4, s[4:7], s50 offen offset:2048 sc1
    s_waitcnt vmcnt(23)
    s_barrier
    v_add_u32 v3, 40960, v3
    v_subrev_u32 v12, 102400, v3
    v_min_u32 v3, v3, v12
    v_xor_b32 v219, 64, v3
    s_waitcnt lgkmcnt(2)
    v_mfma_f32_16x16x32_bf16 v[48:51], a[72:75], v[32:35], v[48:51]
    ds_read_b128 v[16:19], v2 offset:0
    v_mfma_f32_16x16x32_bf16 v[52:55], a[72:75], v[36:39], v[52:55]
    v_mfma_f32_16x16x32_bf16 v[56:59], a[152:155], v[32:35], v[56:59]
    ds_read_b128 v[20:23], v2 offset:10240
    v_mfma_f32_16x16x32_bf16 v[60:63], a[152:155], v[36:39], v[60:63]
    v_mfma_f32_16x16x32_bf16 v[64:67], a[232:235], v[32:35], v[64:67]
    v_mfma_f32_16x16x32_bf16 v[68:71], a[232:235], v[36:39], v[68:71]
    buffer_load_dwordx4 v[188:191], v4, s[4:7], s50 offen offset:3072 sc1
    s_waitcnt lgkmcnt(2)
    v_mfma_f32_16x16x32_bf16 v[48:51], a[76:79], v[40:43], v[48:51]
    ds_read_b128 v[24:27], v218 offset:0
    v_mfma_f32_16x16x32_bf16 v[52:55], a[76:79], v[44:47], v[52:55]
    v_mfma_f32_16x16x32_bf16 v[56:59], a[156:159], v[40:43], v[56:59]
    ds_read_b128 v[28:31], v218 offset:10240
    v_mfma_f32_16x16x32_bf16 v[60:63], a[156:159], v[44:47], v[60:63]
    v_mfma_f32_16x16x32_bf16 v[64:67], a[236:239], v[40:43], v[64:67]
    v_mfma_f32_16x16x32_bf16 v[68:71], a[236:239], v[44:47], v[68:71]
    s_nop 1
    v_cvt_pk_bf16_f32 v224, v48, v49
    v_cvt_pk_bf16_f32 v225, v50, v51
    v_cvt_pk_bf16_f32 v228, v52, v53
    v_cvt_pk_bf16_f32 v229, v54, v55
    v_cvt_pk_bf16_f32 v226, v56, v57
    v_cvt_pk_bf16_f32 v227, v58, v59
    v_cvt_pk_bf16_f32 v230, v60, v61
    v_cvt_pk_bf16_f32 v231, v62, v63
    v_cvt_pk_bf16_f32 v232, v64, v65
    v_cvt_pk_bf16_f32 v233, v66, v67
    v_cvt_pk_bf16_f32 v234, v68, v69
    v_cvt_pk_bf16_f32 v235, v70, v71
    s_lshl_b32 s42, s36, 2
    s_add_u32 s42, s42, s16
    s_add_u32 s42, s42, 1
    s_cmp_ge_u32 s43, s42
    s_cbranch_scc1 L_82
    s_mov_b64 exec, 3
L_81:
    buffer_load_dword v13, v11, s[4:7], s45 offen sc1
    s_waitcnt vmcnt(0)
    v_readlane_b32 s43, v13, 0
    v_readlane_b32 s29, v13, 1
    s_nop 3
    s_min_u32 s43, s43, s29
    s_mov_b64 exec, -1
L_82:
    s_waitcnt lgkmcnt(2)
    v_mfma_f32_16x16x32_bf16 v[48:51], a[0:3], v[16:19], 0
    ds_read_b128 v[32:35], v2 offset:1024
    v_mfma_f32_16x16x32_bf16 v[52:55], a[0:3], v[20:23], 0
    v_mfma_f32_16x16x32_bf16 v[56:59], a[80:83], v[16:19], 0
    ds_read_b128 v[36:39], v2 offset:11264
    v_mfma_f32_16x16x32_bf16 v[60:63], a[80:83], v[20:23], 0
    v_mfma_f32_16x16x32_bf16 v[64:67], a[160:163], v[16:19], 0
    s_add_u32 m0, s35, 0
    s_nop 0
    buffer_load_dwordx4 v1, s[8:11], s34 offen offset:0 lds
    v_mfma_f32_16x16x32_bf16 v[68:71], a[160:163], v[20:23], 0
    ds_write_b128 v7, v[224:227] offset:24576
    ds_write_b64 v8, v[232:233] offset:24576
    s_waitcnt lgkmcnt(2)
    v_mfma_f32_16x16x32_bf16 v[48:51], a[4:7], v[24:27], v[48:51]
    ds_read_b128 v[40:43], v218 offset:1024
    v_mfma_f32_16x16x32_bf16 v[52:55], a[4:7], v[28:31], v[52:55]
    v_mfma_f32_16x16x32_bf16 v[56:59], a[84:87], v[24:27], v[56:59]
    ds_read_b128 v[44:47], v218 offset:11264
    v_mfma_f32_16x16x32_bf16 v[60:63], a[84:87], v[28:31], v[60:63]
    v_mfma_f32_16x16x32_bf16 v[64:67], a[164:167], v[24:27], v[64:67]
    s_add_u32 m0, s35, 896
    s_nop 0
    buffer_load_dwordx4 v1, s[8:11], s34 offen offset:128 lds
    v_mfma_f32_16x16x32_bf16 v[68:71], a[164:167], v[28:31], v[68:71]
    ds_write_b128 v7, v[228:231] offset:30720
    ds_write_b64 v8, v[234:235] offset:30720
    s_waitcnt lgkmcnt(2)
    v_mfma_f32_16x16x32_bf16 v[48:51], a[8:11], v[32:35], v[48:51]
    ds_read_b128 v[16:19], v2 offset:2048
    v_mfma_f32_16x16x32_bf16 v[52:55], a[8:11], v[36:39], v[52:55]
    v_mfma_f32_16x16x32_bf16 v[56:59], a[88:91], v[32:35], v[56:59]
    ds_read_b128 v[20:23], v2 offset:12288
    v_mfma_f32_16x16x32_bf16 v[60:63], a[88:91], v[36:39], v[60:63]
    v_mfma_f32_16x16x32_bf16 v[64:67], a[168:171], v[32:35], v[64:67]
    s_add_u32 m0, s35, 1792
    s_nop 0
    buffer_load_dwordx4 v1, s[8:11], s34 offen offset:256 lds
    v_mfma_f32_16x16x32_bf16 v[68:71], a[168:171], v[36:39], v[68:71]
    s_waitcnt lgkmcnt(2)
    v_mfma_f32_16x16x32_bf16 v[48:51], a[12:15], v[40:43], v[48:51]
    ds_read_b128 v[24:27], v218 offset:2048
    v_mfma_f32_16x16x32_bf16 v[52:55], a[12:15], v[44:47], v[52:55]
    v_mfma_f32_16x16x32_bf16 v[56:59], a[92:95], v[40:43], v[56:59]
    ds_read_b128 v[28:31], v218 offset:12288
    v_mfma_f32_16x16x32_bf16 v[60:63], a[92:95], v[44:47], v[60:63]
    v_mfma_f32_16x16x32_bf16 v[64:67], a[172:175], v[40:43], v[64:67]
    s_add_u32 m0, s35, 2688
    s_nop 0
    buffer_load_dwordx4 v1, s[8:11], s34 offen offset:384 lds
    v_mfma_f32_16x16x32_bf16 v[68:71], a[172:175], v[44:47], v[68:71]
    s_waitcnt lgkmcnt(2)
    v_mfma_f32_16x16x32_bf16 v[48:51], a[16:19], v[16:19], v[48:51]
    ds_read_b128 v[32:35], v2 offset:3072
    v_mfma_f32_16x16x32_bf16 v[52:55], a[16:19], v[20:23], v[52:55]
    v_mfma_f32_16x16x32_bf16 v[56:59], a[96:99], v[16:19], v[56:59]
    ds_read_b128 v[36:39], v2 offset:13312
    v_mfma_f32_16x16x32_bf16 v[60:63], a[96:99], v[20:23], v[60:63]
    v_mfma_f32_16x16x32_bf16 v[64:67], a[176:179], v[16:19], v[64:67]
    s_add_u32 m0, s35, 3584
    s_nop 0
    buffer_load_dwordx4 v1, s[8:11], s34 offen offset:512 lds
    s_add_u32 s34, s34, 40320
    s_add_u32 s35, s35, 20480
    s_add_u32 s29, s41, 102400
    s_cmp_ge_u32 s35, s29
    s_cselect_b32 s35, s41, s35
    v_mfma_f32_16x16x32_bf16 v[68:71], a[176:179], v[20:23], v[68:71]
    s_cmp_lt_u32 s43, s42
    s_cbranch_scc1 L_69
    buffer_load_dwordx4 v[72:75], v5, s[4:7], s38 offen offset:0 sc1
    L_69:
    s_waitcnt lgkmcnt(2)
    v_mfma_f32_16x16x32_bf16 v[48:51], a[20:23], v[24:27], v[48:51]
    ds_read_b128 v[40:43], v218 offset:3072
    v_mfma_f32_16x16x32_bf16 v[52:55], a[20:23], v[28:31], v[52:55]
    v_mfma_f32_16x16x32_bf16 v[56:59], a[100:103], v[24:27], v[56:59]
    ds_read_b128 v[44:47], v218 offset:13312
    v_mfma_f32_16x16x32_bf16 v[60:63], a[100:103], v[28:31], v[60:63]
    v_mfma_f32_16x16x32_bf16 v[64:67], a[180:183], v[24:27], v[64:67]
    v_mfma_f32_16x16x32_bf16 v[68:71], a[180:183], v[28:31], v[68:71]
    s_cmp_lt_u32 s43, s42
    s_cbranch_scc1 L_70
    buffer_load_dwordx4 v[76:79], v5, s[4:7], s38 offen offset:512 sc1
    L_70:
    s_waitcnt lgkmcnt(2)
    v_mfma_f32_16x16x32_bf16 v[48:51], a[24:27], v[32:35], v[48:51]
    ds_read_b128 v[16:19], v2 offset:4096
    v_mfma_f32_16x16x32_bf16 v[52:55], a[24:27], v[36:39], v[52:55]
    v_mfma_f32_16x16x32_bf16 v[56:59], a[104:107], v[32:35], v[56:59]
    ds_read_b128 v[20:23], v2 offset:14336
    v_mfma_f32_16x16x32_bf16 v[60:63], a[104:107], v[36:39], v[60:63]
    v_mfma_f32_16x16x32_bf16 v[64:67], a[184:187], v[32:35], v[64:67]
    v_mfma_f32_16x16x32_bf16 v[68:71], a[184:187], v[36:39], v[68:71]
    s_cmp_lt_u32 s43, s42
    s_cbranch_scc1 L_71
    buffer_load_dwordx4 v[80:83], v5, s[4:7], s38 offen offset:1024 sc1
    L_71:
    s_waitcnt lgkmcnt(2)
    v_mfma_f32_16x16x32_bf16 v[48:51], a[28:31], v[40:43], v[48:51]
    ds_read_b128 v[24:27], v218 offset:4096
    v_mfma_f32_16x16x32_bf16 v[52:55], a[28:31], v[44:47], v[52:55]
    v_mfma_f32_16x16x32_bf16 v[56:59], a[108:111], v[40:43], v[56:59]
    ds_read_b128 v[28:31], v218 offset:14336
    v_mfma_f32_16x16x32_bf16 v[60:63], a[108:111], v[44:47], v[60:63]
    v_mfma_f32_16x16x32_bf16 v[64:67], a[188:191], v[40:43], v[64:67]
    v_mfma_f32_16x16x32_bf16 v[68:71], a[188:191], v[44:47], v[68:71]
    s_cmp_lt_u32 s43, s42
    s_cbranch_scc1 L_72
    buffer_load_dwordx4 v[84:87], v5, s[4:7], s38 offen offset:1536 sc1
    L_72:
    s_waitcnt vmcnt(19)
    s_barrier
    v_add_u32 v2, 40960, v2
    v_subrev_u32 v12, 102400, v2
    v_min_u32 v2, v2, v12
    v_xor_b32 v218, 64, v2
    s_waitcnt lgkmcnt(2)
    v_mfma_f32_16x16x32_bf16 v[48:51], a[32:35], v[16:19], v[48:51]
    ds_read_b128 v[32:35], v3 offset:0
    v_mfma_f32_16x16x32_bf16 v[52:55], a[32:35], v[20:23], v[52:55]
    v_mfma_f32_16x16x32_bf16 v[56:59], a[112:115], v[16:19], v[56:59]
    ds_read_b128 v[36:39], v3 offset:10240
    v_mfma_f32_16x16x32_bf16 v[60:63], a[112:115], v[20:23], v[60:63]
    v_mfma_f32_16x16x32_bf16 v[64:67], a[192:195], v[16:19], v[64:67]
    v_mfma_f32_16x16x32_bf16 v[68:71], a[192:195], v[20:23], v[68:71]
    s_cmp_lt_u32 s43, s42
    s_cbranch_scc1 L_73
    buffer_load_dwordx4 v[88:91], v5, s[4:7], s38 offen offset:2048 sc1
    L_73:
    s_waitcnt lgkmcnt(2)
    v_mfma_f32_16x16x32_bf16 v[48:51], a[36:39], v[24:27], v[48:51]
    ds_read_b128 v[40:43], v219 offset:0
    v_mfma_f32_16x16x32_bf16 v[52:55], a[36:39], v[28:31], v[52:55]
    v_mfma_f32_16x16x32_bf16 v[56:59], a[116:119], v[24:27], v[56:59]
    ds_read_b128 v[44:47], v219 offset:10240
    v_mfma_f32_16x16x32_bf16 v[60:63], a[116:119], v[28:31], v[60:63]
    v_mfma_f32_16x16x32_bf16 v[64:67], a[196:199], v[24:27], v[64:67]
    v_mfma_f32_16x16x32_bf16 v[68:71], a[196:199], v[28:31], v[68:71]
    s_cmp_lt_u32 s43, s42
    s_cbranch_scc1 L_74
    buffer_load_dwordx4 v[92:95], v5, s[4:7], s38 offen offset:2560 sc1
    L_74:
    s_waitcnt lgkmcnt(2)
    v_mfma_f32_16x16x32_bf16 v[48:51], a[40:43], v[32:35], v[48:51]
    ds_read_b128 v[16:19], v3 offset:1024
    v_mfma_f32_16x16x32_bf16 v[52:55], a[40:43], v[36:39], v[52:55]
    v_mfma_f32_16x16x32_bf16 v[56:59], a[120:123], v[32:35], v[56:59]
    ds_read_b128 v[20:23], v3 offset:11264
    v_mfma_f32_16x16x32_bf16 v[60:63], a[120:123], v[36:39], v[60:63]
    v_mfma_f32_16x16x32_bf16 v[64:67], a[200:203], v[32:35], v[64:67]
    s_add_u32 m0, s35, 0
    s_nop 0
    buffer_load_dwordx4 v1, s[8:11], s34 offen offset:0 lds
    v_mfma_f32_16x16x32_bf16 v[68:71], a[200:203], v[36:39], v[68:71]
    s_waitcnt lgkmcnt(2)
    v_mfma_f32_16x16x32_bf16 v[48:51], a[44:47], v[40:43], v[48:51]
    ds_read_b128 v[24:27], v219 offset:1024
    v_mfma_f32_16x16x32_bf16 v[52:55], a[44:47], v[44:47], v[52:55]
    v_mfma_f32_16x16x32_bf16 v[56:59], a[124:127], v[40:43], v[56:59]
    ds_read_b128 v[28:31], v219 offset:11264
    v_mfma_f32_16x16x32_bf16 v[60:63], a[124:127], v[44:47], v[60:63]
    v_mfma_f32_16x16x32_bf16 v[64:67], a[204:207], v[40:43], v[64:67]
    s_add_u32 m0, s35, 896
    s_nop 0
    buffer_load_dwordx4 v1, s[8:11], s34 offen offset:128 lds
    v_mfma_f32_16x16x32_bf16 v[68:71], a[204:207], v[44:47], v[68:71]
    s_waitcnt lgkmcnt(2)
    v_mfma_f32_16x16x32_bf16 v[48:51], a[48:51], v[16:19], v[48:51]
    ds_read_b128 v[32:35], v3 offset:2048
    v_mfma_f32_16x16x32_bf16 v[52:55], a[48:51], v[20:23], v[52:55]
    v_mfma_f32_16x16x32_bf16 v[56:59], a[128:131], v[16:19], v[56:59]
    ds_read_b128 v[36:39], v3 offset:12288
    v_mfma_f32_16x16x32_bf16 v[60:63], a[128:131], v[20:23], v[60:63]
    v_mfma_f32_16x16x32_bf16 v[64:67], a[208:211], v[16:19], v[64:67]
    s_add_u32 m0, s35, 1792
    s_nop 0
    buffer_load_dwordx4 v1, s[8:11], s34 offen offset:256 lds
    v_mfma_f32_16x16x32_bf16 v[68:71], a[208:211], v[20:23], v[68:71]
    s_waitcnt lgkmcnt(2)
    v_mfma_f32_16x16x32_bf16 v[48:51], a[52:55], v[24:27], v[48:51]
    ds_read_b128 v[40:43], v219 offset:2048
    v_mfma_f32_16x16x32_bf16 v[52:55], a[52:55], v[28:31], v[52:55]
    v_mfma_f32_16x16x32_bf16 v[56:59], a[132:135], v[24:27], v[56:59]
    ds_read_b128 v[44:47], v219 offset:12288
    v_mfma_f32_16x16x32_bf16 v[60:63], a[132:135], v[28:31], v[60:63]
    v_mfma_f32_16x16x32_bf16 v[64:67], a[212:215], v[24:27], v[64:67]
    s_add_u32 m0, s35, 2688
    s_nop 0
    buffer_load_dwordx4 v1, s[8:11], s34 offen offset:384 lds
    v_mfma_f32_16x16x32_bf16 v[68:71], a[212:215], v[28:31], v[68:71]
    s_waitcnt lgkmcnt(2)
    v_mfma_f32_16x16x32_bf16 v[48:51], a[56:59], v[32:35], v[48:51]
    ds_read_b128 v[16:19], v3 offset:3072
    v_mfma_f32_16x16x32_bf16 v[52:55], a[56:59], v[36:39], v[52:55]
    v_mfma_f32_16x16x32_bf16 v[56:59], a[136:139], v[32:35], v[56:59]
    ds_read_b128 v[20:23], v3 offset:13312
    v_mfma_f32_16x16x32_bf16 v[60:63], a[136:139], v[36:39], v[60:63]
    v_mfma_f32_16x16x32_bf16 v[64:67], a[216:219], v[32:35], v[64:67]
    s_add_u32 m0, s35, 3584
    s_nop 0
    buffer_load_dwordx4 v1, s[8:11], s34 offen offset:512 lds
    s_add_u32 s34, s34, 640
    s_add_u32 s35, s35, 20480
    s_add_u32 s29, s41, 102400
    s_cmp_ge_u32 s35, s29
    s_cselect_b32 s35, s41, s35
    v_mfma_f32_16x16x32_bf16 v[68:71], a[216:219], v[36:39], v[68:71]
    s_cmp_lt_u32 s43, s42
    s_cbranch_scc1 L_75
    buffer_load_dwordx4 v[192:195], v6, s[4:7], s51 offen offset:0 sc1
    L_75:
    s_waitcnt lgkmcnt(2)
    v_mfma_f32_16x16x32_bf16 v[48:51], a[60:63], v[40:43], v[48:51]
    ds_read_b128 v[24:27], v219 offset:3072
    v_mfma_f32_16x16x32_bf16 v[52:55], a[60:63], v[44:47], v[52:55]
    v_mfma_f32_16x16x32_bf16 v[56:59], a[140:143], v[40:43], v[56:59]
    ds_read_b128 v[28:31], v219 offset:13312
    v_mfma_f32_16x16x32_bf16 v[60:63], a[140:143], v[44:47], v[60:63]
    v_mfma_f32_16x16x32_bf16 v[64:67], a[220:223], v[40:43], v[64:67]
    v_mfma_f32_16x16x32_bf16 v[68:71], a[220:223], v[44:47], v[68:71]
    s_cmp_lt_u32 s43, s42
    s_cbranch_scc1 L_76
    buffer_load_dwordx4 v[196:199], v6, s[4:7], s51 offen offset:512 sc1
    L_76:
    s_waitcnt lgkmcnt(2)
    v_mfma_f32_16x16x32_bf16 v[48:51], a[64:67], v[16:19], v[48:51]
    ds_read_b128 v[32:35], v3 offset:4096
    v_mfma_f32_16x16x32_bf16 v[52:55], a[64:67], v[20:23], v[52:55]
    v_mfma_f32_16x16x32_bf16 v[56:59], a[144:147], v[16:19], v[56:59]
    ds_read_b128 v[36:39], v3 offset:14336
    v_mfma_f32_16x16x32_bf16 v[60:63], a[144:147], v[20:23], v[60:63]
    v_mfma_f32_16x16x32_bf16 v[64:67], a[224:227], v[16:19], v[64:67]
    v_mfma_f32_16x16x32_bf16 v[68:71], a[224:227], v[20:23], v[68:71]
    s_cmp_lt_u32 s43, s42
    s_cbranch_scc1 L_77
    buffer_load_dwordx4 v[200:203], v6, s[4:7], s51 offen offset:1024 sc1
    L_77:
    s_waitcnt lgkmcnt(2)
    v_mfma_f32_16x16x32_bf16 v[48:51], a[68:71], v[24:27], v[48:51]
    ds_read_b128 v[40:43], v219 offset:4096
    v_mfma_f32_16x16x32_bf16 v[52:55], a[68:71], v[28:31], v[52:55]
    v_mfma_f32_16x16x32_bf16 v[56:59], a[148:151], v[24:27], v[56:59]
    ds_read_b128 v[44:47], v219 offset:14336
    v_mfma_f32_16x16x32_bf16 v[60:63], a[148:151], v[28:31], v[60:63]
    v_mfma_f32_16x16x32_bf16 v[64:67], a[228:231], v[24:27], v[64:67]
    v_mfma_f32_16x16x32_bf16 v[68:71], a[228:231], v[28:31], v[68:71]
    s_cmp_lt_u32 s43, s42
    s_cbranch_scc1 L_78
    buffer_load_dwordx4 v[204:207], v6, s[4:7], s51 offen offset:1536 sc1
    L_78:
    s_waitcnt vmcnt(14)
    s_barrier
    v_add_u32 v3, 40960, v3
    v_subrev_u32 v12, 102400, v3
    v_min_u32 v3, v3, v12
    v_xor_b32 v219, 64, v3
    s_waitcnt lgkmcnt(2)
    v_mfma_f32_16x16x32_bf16 v[48:51], a[72:75], v[32:35], v[48:51]
    ds_read_b128 v[16:19], v2 offset:0
    v_mfma_f32_16x16x32_bf16 v[52:55], a[72:75], v[36:39], v[52:55]
    v_mfma_f32_16x16x32_bf16 v[56:59], a[152:155], v[32:35], v[56:59]
    ds_read_b128 v[20:23], v2 offset:10240
    v_mfma_f32_16x16x32_bf16 v[60:63], a[152:155], v[36:39], v[60:63]
    v_mfma_f32_16x16x32_bf16 v[64:67], a[232:235], v[32:35], v[64:67]
    v_mfma_f32_16x16x32_bf16 v[68:71], a[232:235], v[36:39], v[68:71]
    s_cmp_lt_u32 s43, s42
    s_cbranch_scc1 L_79
    buffer_load_dwordx4 v[208:211], v6, s[4:7], s51 offen offset:2048 sc1
    L_79:
    s_waitcnt lgkmcnt(2)
    v_mfma_f32_16x16x32_bf16 v[48:51], a[76:79], v[40:43], v[48:51]
    ds_read_b128 v[24:27], v218 offset:0
    v_mfma_f32_16x16x32_bf16 v[52:55], a[76:79], v[44:47], v[52:55]
    v_mfma_f32_16x16x32_bf16 v[56:59], a[156:159], v[40:43], v[56:59]
    ds_read_b128 v[28:31], v218 offset:10240
    v_mfma_f32_16x16x32_bf16 v[60:63], a[156:159], v[44:47], v[60:63]
    v_mfma_f32_16x16x32_bf16 v[64:67], a[236:239], v[40:43], v[64:67]
    v_mfma_f32_16x16x32_bf16 v[68:71], a[236:239], v[44:47], v[68:71]
    s_cmp_lt_u32 s43, s42
    s_cbranch_scc1 L_80
    buffer_load_dwordx4 v[212:215], v6, s[4:7], s51 offen offset:2560 sc1
    L_80:
    s_nop 1
    v_cvt_pk_bf16_f32 v224, v48, v49
    v_cvt_pk_bf16_f32 v225, v50, v51
    v_cvt_pk_bf16_f32 v228, v52, v53
    v_cvt_pk_bf16_f32 v229, v54, v55
    v_cvt_pk_bf16_f32 v226, v56, v57
    v_cvt_pk_bf16_f32 v227, v58, v59
    v_cvt_pk_bf16_f32 v230, v60, v61
    v_cvt_pk_bf16_f32 v231, v62, v63
    v_cvt_pk_bf16_f32 v232, v64, v65
    v_cvt_pk_bf16_f32 v233, v66, v67
    v_cvt_pk_bf16_f32 v234, v68, v69
    v_cvt_pk_bf16_f32 v235, v70, v71
    ds_write_b128 v7, v[224:227] offset:36864
    ds_write_b64 v8, v[232:233] offset:36864
    ds_write_b128 v7, v[228:231] offset:43008
    ds_write_b64 v8, v[234:235] offset:43008
    s_cmp_ge_u32 s43, s42
    s_cbranch_scc1 L_83
    s_cmp_ge_u32 s43, s42
    s_cbranch_scc1 L_85
    s_mov_b64 exec, 3
L_84:
    buffer_load_dword v13, v11, s[4:7], s45 offen sc1
    s_waitcnt vmcnt(0)
    v_cmp_gt_u32 vcc, s42, v13
    s_cbranch_vccz L_86
    s_sleep 4
    s_branch L_spin_87
L_86:
    v_readlane_b32 s43, v13, 0
    v_readlane_b32 s29, v13, 1
    s_nop 3
    s_min_u32 s43, s43, s29
    s_mov_b64 exec, -1
L_85:
    buffer_load_dwordx4 v[72:75], v5, s[4:7], s38 offen offset:0 sc1
    buffer_load_dwordx4 v[76:79], v5, s[4:7], s38 offen offset:512 sc1
    buffer_load_dwordx4 v[80:83], v5, s[4:7], s38 offen offset:1024 sc1
    buffer_load_dwordx4 v[84:87], v5, s[4:7], s38 offen offset:1536 sc1
    buffer_load_dwordx4 v[88:91], v5, s[4:7], s38 offen offset:2048 sc1
    buffer_load_dwordx4 v[92:95], v5, s[4:7], s38 offen offset:2560 sc1
    buffer_load_dwordx4 v[192:195], v6, s[4:7], s51 offen offset:0 sc1
    buffer_load_dwordx4 v[196:199], v6, s[4:7], s51 offen offset:512 sc1
    buffer_load_dwordx4 v[200:203], v6, s[4:7], s51 offen offset:1024 sc1
    buffer_load_dwordx4 v[204:207], v6, s[4:7], s51 offen offset:1536 sc1
    buffer_load_dwordx4 v[208:211], v6, s[4:7], s51 offen offset:2048 sc1
    buffer_load_dwordx4 v[212:215], v6, s[4:7], s51 offen offset:2560 sc1
L_83:
    s_waitcnt lgkmcnt(0)
    s_barrier
    ds_read_b128 v[48:51], v9 offset:0
    ds_read_b128 v[52:55], v9 offset:1024
    ds_read_b128 v[56:59], v9 offset:2048
    ds_read_b128 v[60:63], v9 offset:3072
    ds_read_b128 v[64:67], v9 offset:4096
    ds_read_b128 v[68:71], v9 offset:5120
    s_waitcnt vmcnt(0)
    v_swap_b32 v106, v128
    v_swap_b32 v107, v129
    v_swap_b32 v118, v140
    v_swap_b32 v119, v141
    s_waitcnt lgkmcnt(5)
    v_mfma_f32_16x16x32_bf16 v[224:227], v[72:75], v[48:51], 0
    v_mfma_f32_16x16x32_bf16 v[228:231], v[96:99], v[48:51], 0
    s_waitcnt lgkmcnt(4)
    v_mfma_f32_16x16x32_bf16 v[224:227], v[76:79], v[52:55], v[224:227]
    v_mfma_f32_16x16x32_bf16 v[228:231], v[100:103], v[52:55], v[228:231]
    s_waitcnt lgkmcnt(3)
    v_mfma_f32_16x16x32_bf16 v[224:227], v[80:83], v[56:59], v[224:227]
    v_mfma_f32_16x16x32_bf16 v[228:231], v[104:107], v[56:59], v[228:231]
    s_waitcnt lgkmcnt(2)
    v_mfma_f32_16x16x32_bf16 v[224:227], v[84:87], v[60:63], v[224:227]
    v_mfma_f32_16x16x32_bf16 v[228:231], v[108:111], v[60:63], v[228:231]
    s_waitcnt lgkmcnt(1)
    v_mfma_f32_16x16x32_bf16 v[224:227], v[88:91], v[64:67], v[224:227]
    v_mfma_f32_16x16x32_bf16 v[228:231], v[112:115], v[64:67], v[228:231]
    s_waitcnt lgkmcnt(0)
    v_mfma_f32_16x16x32_bf16 v[224:227], v[92:95], v[68:71], v[224:227]
    v_mfma_f32_16x16x32_bf16 v[228:231], v[116:119], v[68:71], v[228:231]
    ds_read_b128 v[48:51], v9 offset:6144
    ds_read_b128 v[52:55], v9 offset:7168
    ds_read_b128 v[56:59], v9 offset:8192
    ds_read_b128 v[60:63], v9 offset:9216
    ds_read_b128 v[64:67], v9 offset:10240
    ds_read_b128 v[68:71], v9 offset:11264
    s_nop 7
    v_pk_add_f32 v[224:225], v[224:225], v[216:217] op_sel_hi:[1,0]
    v_pk_add_f32 v[226:227], v[226:227], v[216:217] op_sel_hi:[1,0]
    v_pk_add_f32 v[228:229], v[228:229], v[220:221]
    v_pk_add_f32 v[230:231], v[230:231], v[222:223]
    v_max3_f32 v13, v224, v225, v226
    v_max3_f32 v14, v227, v228, v229
    v_max3_f32 v13, v13, v230, v231
    s_waitcnt lgkmcnt(5)
    v_mfma_f32_16x16x32_bf16 v[232:235], v[72:75], v[48:51], 0
    v_max_f32 v15, v13, v14
    v_max_f32 v13, v13, v14
    v_mfma_f32_16x16x32_bf16 v[236:239], v[96:99], v[48:51], 0
    s_nop 1
    v_permlane32_swap_b32 v13, v15
    v_max_f32 v14, v13, v15
    v_mfma_f32_16x16x32_bf16 v[240:243], v[120:123], v[48:51], 0
    v_max_f32 v13, v13, v15
    s_nop 1
    s_waitcnt lgkmcnt(4)
    v_mfma_f32_16x16x32_bf16 v[232:235], v[76:79], v[52:55], v[232:235]
    v_permlane16_swap_b32 v13, v14
    v_max_f32 v13, v13, v14
    v_mul_f32 v13, s44, v13
    v_mfma_f32_16x16x32_bf16 v[236:239], v[100:103], v[52:55], v[236:239]
    v_fma_f32 v224, v224, s44, -v13
    v_fma_f32 v225, v225, s44, -v13
    v_mfma_f32_16x16x32_bf16 v[240:243], v[124:127], v[52:55], v[240:243]
    v_fma_f32 v226, v226, s44, -v13
    v_fma_f32 v227, v227, s44, -v13
    v_fma_f32 v228, v228, s44, -v13
    s_waitcnt lgkmcnt(3)
    v_mfma_f32_16x16x32_bf16 v[232:235], v[80:83], v[56:59], v[232:235]
    v_fma_f32 v229, v229, s44, -v13
    v_fma_f32 v230, v230, s44, -v13
    v_mfma_f32_16x16x32_bf16 v[236:239], v[104:107], v[56:59], v[236:239]
    v_fma_f32 v231, v231, s44, -v13
    v_exp_f32 v224, v224
    v_exp_f32 v225, v225
    v_mfma_f32_16x16x32_bf16 v[240:243], v[128:131], v[56:59], v[240:243]
    v_exp_f32 v226, v226
    v_exp_f32 v227, v227
    v_exp_f32 v228, v228
    s_waitcnt lgkmcnt(2)
    v_mfma_f32_16x16x32_bf16 v[232:235], v[84:87], v[60:63], v[232:235]
    v_exp_f32 v229, v229
    v_exp_f32 v230, v230
    v_mfma_f32_16x16x32_bf16 v[236:239], v[108:111], v[60:63], v[236:239]
    v_exp_f32 v231, v231
    v_cvt_pk_bf16_f32 v252, v224, v225
    v_cvt_pk_bf16_f32 v253, v226, v227
    v_mfma_f32_16x16x32_bf16 v[240:243], v[132:135], v[60:63], v[240:243]
    v_cvt_pk_bf16_f32 v244, v228, v229
    v_cvt_pk_bf16_f32 v245, v230, v231
    s_waitcnt lgkmcnt(1)
    v_mfma_f32_16x16x32_bf16 v[232:235], v[88:91], v[64:67], v[232:235]
    v_mov_b32 v246, 0
    v_mov_b32 v247, 0
    v_pk_add_f32 v[224:225], v[224:225], v[226:227]
    v_mfma_f32_16x16x32_bf16 v[236:239], v[112:115], v[64:67], v[236:239]
    v_pk_add_f32 v[228:229], v[228:229], v[230:231]
    v_pk_add_f32 v[224:225], v[224:225], v[228:229]
    v_mfma_f32_16x16x32_bf16 v[240:243], v[136:139], v[64:67], v[240:243]
    v_add_f32 v13, v224, v225
    v_add_f32 v14, v224, v225
    s_nop 1
    s_waitcnt lgkmcnt(0)
    v_mfma_f32_16x16x32_bf16 v[232:235], v[92:95], v[68:71], v[232:235]
    v_permlane32_swap_b32 v13, v14
    v_add_f32 v15, v13, v14
    v_mfma_f32_16x16x32_bf16 v[236:239], v[116:119], v[68:71], v[236:239]
    v_add_f32 v13, v13, v14
    s_nop 1
    v_permlane16_swap_b32 v13, v15
    v_mfma_f32_16x16x32_bf16 v[240:243], v[140:143], v[68:71], v[240:243]
    v_add_f32 v13, v13, v15
    v_rcp_f32 v224, v13
    s_nop 1
    s_add_u32 s30, s39, 4096
    s_add_u32 s40, s39, 196608
    s_add_u32 s42, s39, 200704
    v_mfma_f32_16x16x32_bf16 v[72:75], v[144:147], v[244:247], 0
    s_nop 7
    v_pk_add_f32 v[232:233], v[232:233], v[216:217] op_sel_hi:[1,0]
    v_mfma_f32_16x16x32_bf16 v[76:79], v[148:151], v[244:247], 0
    v_pk_add_f32 v[234:235], v[234:235], v[216:217] op_sel_hi:[1,0]
    v_pk_add_f32 v[240:241], v[240:241], v[220:221]
    v_pk_add_f32 v[242:243], v[242:243], v[222:223]
    v_mfma_f32_16x16x32_bf16 v[80:83], v[152:155], v[244:247], 0
    v_max3_f32 v13, v232, v233, v234
    v_max3_f32 v14, v235, v236, v237
    v_max3_f32 v13, v13, v238, v239
    v_mfma_f32_16x16x32_bf16 v[84:87], v[156:159], v[244:247], 0
    v_max3_f32 v14, v14, v240, v241
    v_max3_f32 v13, v13, v242, v243
    v_max_f32 v15, v13, v14
    v_mfma_f32_16x16x32_bf16 v[88:91], v[160:163], v[244:247], 0
    v_max_f32 v13, v13, v14
    s_nop 1
    v_mfma_f32_16x16x32_bf16 v[92:95], v[164:167], v[244:247], 0
    v_permlane32_swap_b32 v13, v15
    v_max_f32 v14, v13, v15
    v_max_f32 v13, v13, v15
    v_mfma_f32_16x16x32_bf16 v[96:99], v[168:171], v[244:247], 0
    s_nop 1
    v_permlane16_swap_b32 v13, v14
    v_max_f32 v13, v13, v14
    v_mfma_f32_16x16x32_bf16 v[100:103], v[172:175], v[244:247], 0
    v_mul_f32 v13, s44, v13
    v_fma_f32 v232, v232, s44, -v13
    v_fma_f32 v233, v233, s44, -v13
    v_mfma_f32_16x16x32_bf16 v[104:107], v[176:179], v[244:247], 0
    v_fma_f32 v234, v234, s44, -v13
    v_fma_f32 v235, v235, s44, -v13
    v_mfma_f32_16x16x32_bf16 v[108:111], v[180:183], v[244:247], 0
    v_fma_f32 v236, v236, s44, -v13
    v_fma_f32 v237, v237, s44, -v13
    v_fma_f32 v238, v238, s44, -v13
    v_mfma_f32_16x16x32_bf16 v[112:115], v[184:187], v[244:247], 0
    v_fma_f32 v239, v239, s44, -v13
    v_fma_f32 v240, v240, s44, -v13
    v_fma_f32 v241, v241, s44, -v13
    v_mfma_f32_16x16x32_bf16 v[116:119], v[188:191], v[244:247], 0
    v_fma_f32 v242, v242, s44, -v13
    v_fma_f32 v243, v243, s44, -v13
    v_exp_f32 v232, v232
    v_mfma_f32_16x16x16_bf16 v[72:75], v[192:193], v[252:253], v[72:75]
    v_exp_f32 v233, v233
    v_exp_f32 v234, v234
    v_mfma_f32_16x16x16_bf16 v[76:79], v[194:195], v[252:253], v[76:79]
    v_exp_f32 v235, v235
    v_exp_f32 v236, v236
    v_exp_f32 v237, v237
    v_mfma_f32_16x16x16_bf16 v[80:83], v[196:197], v[252:253], v[80:83]
    v_exp_f32 v238, v238
    v_exp_f32 v239, v239
    v_exp_f32 v240, v240
    v_mfma_f32_16x16x16_bf16 v[84:87], v[198:199], v[252:253], v[84:87]
    v_exp_f32 v241, v241
    v_exp_f32 v242, v242
    v_exp_f32 v243, v243
    v_mfma_f32_16x16x16_bf16 v[88:91], v[200:201], v[252:253], v[88:91]
    v_cvt_pk_bf16_f32 v254, v232, v233
    v_cvt_pk_bf16_f32 v255, v234, v235
    v_mfma_f32_16x16x16_bf16 v[92:95], v[202:203], v[252:253], v[92:95]
    v_cvt_pk_bf16_f32 v248, v236, v237
    v_cvt_pk_bf16_f32 v249, v238, v239
    v_cvt_pk_bf16_f32 v250, v240, v241
    v_mfma_f32_16x16x16_bf16 v[96:99], v[204:205], v[252:253], v[96:99]
    v_cvt_pk_bf16_f32 v251, v242, v243
    v_pk_add_f32 v[232:233], v[232:233], v[234:235]
    v_pk_add_f32 v[236:237], v[236:237], v[238:239]
    v_mfma_f32_16x16x16_bf16 v[100:103], v[206:207], v[252:253], v[100:103]
    v_pk_add_f32 v[240:241], v[240:241], v[242:243]
    v_pk_add_f32 v[232:233], v[232:233], v[240:241]
    v_pk_add_f32 v[232:233], v[232:233], v[236:237]
    v_mfma_f32_16x16x16_bf16 v[104:107], v[208:209], v[252:253], v[104:107]
    v_add_f32 v13, v232, v233
    v_add_f32 v14, v232, v233
    v_mfma_f32_16x16x16_bf16 v[108:111], v[210:211], v[252:253], v[108:111]
    s_nop 1
    v_permlane32_swap_b32 v13, v14
    v_add_f32 v15, v13, v14
    v_mfma_f32_16x16x16_bf16 v[112:115], v[212:213], v[252:253], v[112:115]
    v_add_f32 v13, v13, v14
    s_nop 1
    v_permlane16_swap_b32 v13, v15
    v_mfma_f32_16x16x16_bf16 v[116:119], v[214:215], v[252:253], v[116:119]
    v_add_f32 v13, v13, v15
    v_rcp_f32 v232, v13
    s_nop 1
    v_mfma_f32_16x16x32_bf16 v[120:123], v[144:147], v[248:251], 0
    s_nop 7
    v_pk_mul_f32 v[72:73], v[72:73], v[224:225] op_sel_hi:[1,0]
    v_mfma_f32_16x16x32_bf16 v[124:127], v[148:151], v[248:251], 0
    v_cvt_pk_bf16_f32 v72, v72, v73
    v_pk_mul_f32 v[74:75], v[74:75], v[224:225] op_sel_hi:[1,0]
    v_mfma_f32_16x16x32_bf16 v[128:131], v[152:155], v[248:251], 0
    v_cvt_pk_bf16_f32 v73, v74, v75
    v_pk_mul_f32 v[76:77], v[76:77], v[224:225] op_sel_hi:[1,0]
    v_mfma_f32_16x16x32_bf16 v[132:135], v[156:159], v[248:251], 0
    v_cvt_pk_bf16_f32 v74, v76, v77
    v_pk_mul_f32 v[78:79], v[78:79], v[224:225] op_sel_hi:[1,0]
    v_cvt_pk_bf16_f32 v75, v78, v79
    v_mfma_f32_16x16x32_bf16 v[136:139], v[160:163], v[248:251], 0
    buffer_store_dwordx4 v[72:75], v4, s[4:7], s39 offen offset:0 sc1
    v_pk_mul_f32 v[80:81], v[80:81], v[224:225] op_sel_hi:[1,0]
    v_mfma_f32_16x16x32_bf16 v[140:143], v[164:167], v[248:251], 0
    v_cvt_pk_bf16_f32 v80, v80, v81
    v_pk_mul_f32 v[82:83], v[82:83], v[224:225] op_sel_hi:[1,0]
    v_mfma_f32_16x16x32_bf16 v[48:51], v[168:171], v[248:251], 0
    v_cvt_pk_bf16_f32 v81, v82, v83
    v_pk_mul_f32 v[84:85], v[84:85], v[224:225] op_sel_hi:[1,0]
    v_cvt_pk_bf16_f32 v82, v84, v85
    v_mfma_f32_16x16x32_bf16 v[52:55], v[172:175], v[248:251], 0
    v_pk_mul_f32 v[86:87], v[86:87], v[224:225] op_sel_hi:[1,0]
    v_cvt_pk_bf16_f32 v83, v86, v87
    v_mfma_f32_16x16x32_bf16 v[56:59], v[176:179], v[248:251], 0
    buffer_store_dwordx4 v[80:83], v4, s[4:7], s39 offen offset:1024 sc1
    v_pk_mul_f32 v[88:89], v[88:89], v[224:225] op_sel_hi:[1,0]
    v_mfma_f32_16x16x32_bf16 v[60:63], v[180:183], v[248:251], 0
    v_cvt_pk_bf16_f32 v88, v88, v89
    v_pk_mul_f32 v[90:91], v[90:91], v[224:225] op_sel_hi:[1,0]
    v_mfma_f32_16x16x32_bf16 v[64:67], v[184:187], v[248:251], 0
    v_cvt_pk_bf16_f32 v89, v90, v91
    v_pk_mul_f32 v[92:93], v[92:93], v[224:225] op_sel_hi:[1,0]
    v_cvt_pk_bf16_f32 v90, v92, v93
    v_mfma_f32_16x16x32_bf16 v[68:71], v[188:191], v[248:251], 0
    v_pk_mul_f32 v[94:95], v[94:95], v[224:225] op_sel_hi:[1,0]
    v_cvt_pk_bf16_f32 v91, v94, v95
    v_mfma_f32_16x16x16_bf16 v[120:123], v[192:193], v[254:255], v[120:123]
    buffer_store_dwordx4 v[88:91], v4, s[4:7], s39 offen offset:2048 sc1
    v_pk_mul_f32 v[96:97], v[96:97], v[224:225] op_sel_hi:[1,0]
    v_mfma_f32_16x16x16_bf16 v[124:127], v[194:195], v[254:255], v[124:127]
    v_cvt_pk_bf16_f32 v96, v96, v97
    v_pk_mul_f32 v[98:99], v[98:99], v[224:225] op_sel_hi:[1,0]
    v_cvt_pk_bf16_f32 v97, v98, v99
    v_mfma_f32_16x16x16_bf16 v[128:131], v[196:197], v[254:255], v[128:131]
    v_pk_mul_f32 v[100:101], v[100:101], v[224:225] op_sel_hi:[1,0]
    v_cvt_pk_bf16_f32 v98, v100, v101
    v_mfma_f32_16x16x16_bf16 v[132:135], v[198:199], v[254:255], v[132:135]
    v_pk_mul_f32 v[102:103], v[102:103], v[224:225] op_sel_hi:[1,0]
    v_cvt_pk_bf16_f32 v99, v102, v103
    v_mfma_f32_16x16x16_bf16 v[136:139], v[200:201], v[254:255], v[136:139]
    buffer_store_dwordx4 v[96:99], v4, s[4:7], s39 offen offset:3072 sc1
    v_pk_mul_f32 v[104:105], v[104:105], v[224:225] op_sel_hi:[1,0]
    v_mfma_f32_16x16x16_bf16 v[140:143], v[202:203], v[254:255], v[140:143]
    v_cvt_pk_bf16_f32 v104, v104, v105
    v_pk_mul_f32 v[106:107], v[106:107], v[224:225] op_sel_hi:[1,0]
    v_cvt_pk_bf16_f32 v105, v106, v107
    v_mfma_f32_16x16x16_bf16 v[48:51], v[204:205], v[254:255], v[48:51]
    v_pk_mul_f32 v[108:109], v[108:109], v[224:225] op_sel_hi:[1,0]
    v_cvt_pk_bf16_f32 v106, v108, v109
    v_mfma_f32_16x16x16_bf16 v[52:55], v[206:207], v[254:255], v[52:55]
    v_pk_mul_f32 v[110:111], v[110:111], v[224:225] op_sel_hi:[1,0]
    v_cvt_pk_bf16_f32 v107, v110, v111
    v_mfma_f32_16x16x16_bf16 v[56:59], v[208:209], v[254:255], v[56:59]
    buffer_store_dwordx4 v[104:107], v4, s[4:7], s30 offen offset:0 sc1
    v_pk_mul_f32 v[112:113], v[112:113], v[224:225] op_sel_hi:[1,0]
    v_cvt_pk_bf16_f32 v112, v112, v113
    v_mfma_f32_16x16x16_bf16 v[60:63], v[210:211], v[254:255], v[60:63]
    v_pk_mul_f32 v[114:115], v[114:115], v[224:225] op_sel_hi:[1,0]
    v_cvt_pk_bf16_f32 v113, v114, v115
    v_mfma_f32_16x16x16_bf16 v[64:67], v[212:213], v[254:255], v[64:67]
    v_pk_mul_f32 v[116:117], v[116:117], v[224:225] op_sel_hi:[1,0]
    v_cvt_pk_bf16_f32 v114, v116, v117
    v_mfma_f32_16x16x16_bf16 v[68:71], v[214:215], v[254:255], v[68:71]
    v_pk_mul_f32 v[118:119], v[118:119], v[224:225] op_sel_hi:[1,0]
    v_cvt_pk_bf16_f32 v115, v118, v119
    buffer_store_dwordx4 v[112:115], v4, s[4:7], s30 offen offset:1024 sc1
    s_nop 7
    v_pk_mul_f32 v[120:121], v[120:121], v[232:233] op_sel_hi:[1,0]
    v_cvt_pk_bf16_f32 v120, v120, v121
    v_pk_mul_f32 v[122:123], v[122:123], v[232:233] op_sel_hi:[1,0]
    v_cvt_pk_bf16_f32 v121, v122, v123
    v_pk_mul_f32 v[124:125], v[124:125], v[232:233] op_sel_hi:[1,0]
    v_cvt_pk_bf16_f32 v122, v124, v125
    v_pk_mul_f32 v[126:127], v[126:127], v[232:233] op_sel_hi:[1,0]
    v_cvt_pk_bf16_f32 v123, v126, v127
    buffer_store_dwordx4 v[120:123], v4, s[4:7], s40 offen offset:0 sc1
    v_pk_mul_f32 v[128:129], v[128:129], v[232:233] op_sel_hi:[1,0]
    v_cvt_pk_bf16_f32 v128, v128, v129
    v_pk_mul_f32 v[130:131], v[130:131], v[232:233] op_sel_hi:[1,0]
    v_cvt_pk_bf16_f32 v129, v130, v131
    v_pk_mul_f32 v[132:133], v[132:133], v[232:233] op_sel_hi:[1,0]
    v_cvt_pk_bf16_f32 v130, v132, v133
    v_pk_mul_f32 v[134:135], v[134:135], v[232:233] op_sel_hi:[1,0]
    v_cvt_pk_bf16_f32 v131, v134, v135
    buffer_store_dwordx4 v[128:131], v4, s[4:7], s40 offen offset:1024 sc1
    v_pk_mul_f32 v[136:137], v[136:137], v[232:233] op_sel_hi:[1,0]
    v_cvt_pk_bf16_f32 v136, v136, v137
    v_pk_mul_f32 v[138:139], v[138:139], v[232:233] op_sel_hi:[1,0]
    v_cvt_pk_bf16_f32 v137, v138, v139
    v_pk_mul_f32 v[140:141], v[140:141], v[232:233] op_sel_hi:[1,0]
    v_cvt_pk_bf16_f32 v138, v140, v141
    v_pk_mul_f32 v[142:143], v[142:143], v[232:233] op_sel_hi:[1,0]
    v_cvt_pk_bf16_f32 v139, v142, v143
    buffer_store_dwordx4 v[136:139], v4, s[4:7], s40 offen offset:2048 sc1
    v_pk_mul_f32 v[48:49], v[48:49], v[232:233] op_sel_hi:[1,0]
    v_cvt_pk_bf16_f32 v48, v48, v49
    v_pk_mul_f32 v[50:51], v[50:51], v[232:233] op_sel_hi:[1,0]
    v_cvt_pk_bf16_f32 v49, v50, v51
    v_pk_mul_f32 v[52:53], v[52:53], v[232:233] op_sel_hi:[1,0]
    v_cvt_pk_bf16_f32 v50, v52, v53
    v_pk_mul_f32 v[54:55], v[54:55], v[232:233] op_sel_hi:[1,0]
    v_cvt_pk_bf16_f32 v51, v54, v55
    buffer_store_dwordx4 v[48:51], v4, s[4:7], s40 offen offset:3072 sc1
    v_pk_mul_f32 v[56:57], v[56:57], v[232:233] op_sel_hi:[1,0]
    v_cvt_pk_bf16_f32 v56, v56, v57
    v_pk_mul_f32 v[58:59], v[58:59], v[232:233] op_sel_hi:[1,0]
    v_cvt_pk_bf16_f32 v57, v58, v59
    v_pk_mul_f32 v[60:61], v[60:61], v[232:233] op_sel_hi:[1,0]
    v_cvt_pk_bf16_f32 v58, v60, v61
    v_pk_mul_f32 v[62:63], v[62:63], v[232:233] op_sel_hi:[1,0]
    v_cvt_pk_bf16_f32 v59, v62, v63
    buffer_store_dwordx4 v[56:59], v4, s[4:7], s42 offen offset:0 sc1
    v_pk_mul_f32 v[64:65], v[64:65], v[232:233] op_sel_hi:[1,0]
    v_cvt_pk_bf16_f32 v64, v64, v65
    v_pk_mul_f32 v[66:67], v[66:67], v[232:233] op_sel_hi:[1,0]
    v_cvt_pk_bf16_f32 v65, v66, v67
    v_pk_mul_f32 v[68:69], v[68:69], v[232:233] op_sel_hi:[1,0]
    v_cvt_pk_bf16_f32 v66, v68, v69
    v_pk_mul_f32 v[70:71], v[70:71], v[232:233] op_sel_hi:[1,0]
    v_cvt_pk_bf16_f32 v67, v70, v71
    buffer_store_dwordx4 v[64:67], v4, s[4:7], s42 offen offset:1024 sc1
    s_mul_i32 s29, s57, 49152
    s_add_u32 s37, s37, s29
    s_mul_i32 s29, s57, 12288
    s_add_u32 s38, s38, s29
    s_mul_i32 s29, s57, 1572864
    s_add_u32 s39, s39, s29
    s_mov_b32 s58, s36
    s_add_u32 s36, s36, s57
    s_cmp_eq_u32 s18, 0
    s_cselect_b32 s29, 16, 4
    s_cmp_lt_u32 s36, s29
    s_cbranch_scc1 L_qa_loop
    s_waitcnt vmcnt(0) lgkmcnt(0)
    s_barrier
    s_cmp_lg_u32 s16, 0
    s_cbranch_scc1 L_68b
    s_cmp_eq_u32 s58, -1
    s_cbranch_scc1 L_68b
    s_lshl_b32 s30, s17, 4
    s_add_u32 s29, s58, s30
    s_lshl_b32 s29, s29, 7
    s_add_u32 s29, s29, 184512512
    v_mov_b32 v13, 1
    s_mov_b64 exec, 1
    buffer_atomic_add v13, v10, s[4:7], s29 offen
    s_mov_b64 exec, -1
    L_68b:
    s_mov_b32 s38, s18
L_op:
    v_lshlrev_b32 v1, 4, v0
    v_mov_b32 v2, 0
    s_load_dwordx2 s[8:9], s[0:1], 112
    s_mov_b32 s10, 5242880
    s_mov_b32 s11, 0x20000
    v_and_b32 v6, 15, v0
    v_mul_u32_u24 v6, 2560, v6
    v_bfe_u32 v7, v0, 4, 1
    v_lshl_add_u32 v6, v7, 5, v6
    v_lshrrev_b32 v7, 5, v0
    v_lshl_add_u32 v5, v7, 4, v6
    s_cmp_lg_u32 s16, 0
    s_cbranch_scc1 L_89
L_88:
    buffer_load_dword v6, v2, s[12:15], 0 offen offset:48 sc1
    s_waitcnt vmcnt(0)
    v_cmp_gt_u32 vcc, 64, v6
    s_cbranch_vccz L_89
    s_sleep 8
    s_branch L_spin_90
L_89:
    s_barrier
    s_lshr_b32 s30, s16, 1
    s_and_b32 s31, s16, 1
    s_mul_i32 s40, s30, 40960
    s_mul_i32 s29, s31, 5120
    s_add_u32 s40, s40, s29
    s_add_u32 s40, s40, 192937984
    s_mul_i32 s41, s16, 5120
    s_cmp_eq_u32 s38, 0
    s_cbranch_scc1 L_op_next
    s_bfe_u32 s17, s100, 0x10001
    s_and_b32 s22, s100, 1
    s_lshr_b32 s31, s101, 3
    s_lshl_b32 s20, s31, 1
    s_bfe_u32 s21, s101, 0x20001
    s_mul_i32 s47, s17, 16
    s_mul_i32 s29, s31, 4
    s_add_u32 s47, s47, s29
    s_add_u32 s47, s47, s21
    s_mul_i32 s46, s47, 327680
    s_add_u32 s46, s46, 218103808
    s_mov_b32 s23, 2
    s_mov_b32 s24, 12
    s_branch L_op4_go
L_op_next:
    s_waitcnt vmcnt(0) lgkmcnt(0)
    s_barrier
    s_and_b32 s22, s100, 3
    s_lshl_b32 s29, s100, 2
    s_cmp_lg_u32 s16, 0
    s_cbranch_scc1 L_91
    v_mov_b32 v6, 1
    s_mov_b64 exec, 1
    buffer_atomic_add v6, v2, s[12:15], s29 offen offset:224 sc0
    v_mov_b32 v7, 122880
    s_waitcnt vmcnt(0)
    ds_write_b32 v7, v6
    s_waitcnt lgkmcnt(0)
    s_mov_b64 exec, -1
L_91:
    s_barrier
    v_mov_b32 v7, 122880
    ds_read_b32 v6, v7
    s_waitcnt lgkmcnt(0)
    v_readfirstlane_b32 s38, v6
    s_nop 3
    s_cmp_lt_u32 s100, 4
    s_cbranch_scc1 L_op_finc
    s_cmp_ge_u32 s38, 32
    s_cbranch_scc1 L_op_done
    s_cmp_ge_u32 s38, 16
    s_cbranch_scc1 L_op_fin
    s_and_b32 s21, s38, 3
    s_bfe_u32 s17, s38, 0x10002
    s_lshr_b32 s31, s38, 3
    s_mul_i32 s20, s31, 2
    s_add_u32 s20, s20, 8
    s_mov_b32 s47, s38
    s_add_u32 s47, s47, 32
    s_mul_i32 s46, s38, 655360
    s_add_u32 s46, s46, 228589568
    s_mov_b32 s23, 4
    s_mov_b32 s24, 6
    s_branch L_op4_go
L_op_fin:
    s_sub_u32 s31, s38, 16
    s_lshr_b32 s20, s31, 2
    s_and_b32 s21, s31, 3
    s_and_b32 s17, s100, 1
    s_lshr_b32 s22, s100, 1
    s_add_u32 s22, s22, 2
    s_branch L_op_fin2
L_op_finc:
    s_cmp_ge_u32 s38, 32
    s_cbranch_scc1 L_op_done
    s_lshr_b32 s20, s38, 3
    s_bfe_u32 s17, s38, 0x10002
    s_and_b32 s21, s38, 3
    s_mov_b32 s22, s100
L_op_fin2:
    s_mul_i32 s31, s20, 8
    s_mul_i32 s29, s17, 4
    s_add_u32 s31, s31, s29
    s_add_u32 s31, s31, s21
    s_add_u32 s20, s20, 12
    s_mov_b32 s47, s31
    s_add_u32 s47, s47, 48
    s_mul_i32 s46, s31, 491520
    s_add_u32 s46, s46, 239075328
    s_mov_b32 s23, 6
    s_mov_b32 s24, 4
    s_branch L_op2_go
L_op4_go:
    s_mul_i32 s31, s22, s24
    s_lshl_b32 s31, s31, 3
    s_mov_b32 s34, s40
    s_mul_i32 s29, s17, 7864320
    s_add_u32 s34, s34, s29
    s_mul_i32 s29, s31, 40960
    s_add_u32 s34, s34, s29
    s_mul_i32 s29, s21, 10240
    s_add_u32 s34, s34, s29
    s_mul_i32 s42, s17, 25165824
    s_mul_i32 s29, s20, 1572864
    s_add_u32 s42, s42, s29
    s_mul_i32 s29, s16, 786432
    s_add_u32 s42, s42, s29
    s_mul_i32 s29, s31, 1024
    s_add_u32 s42, s42, s29
    s_add_u32 s42, s42, 101220352
    s_cmp_eq_u32 s23, 2
    s_cselect_b32 s29, 1, 0
    s_lshl_b32 s50, s22, s29
    s_mov_b32 s30, s42
    s_add_u32 s29, s50, 0
    s_and_b32 s29, s29, 3
    s_mul_i32 s29, s29, 196608
    s_add_u32 s42, s30, s29
    s_add_u32 s29, s50, 1
    s_and_b32 s29, s29, 3
    s_mul_i32 s29, s29, 196608
    s_add_u32 s43, s30, s29
    s_add_u32 s29, s50, 2
    s_and_b32 s29, s29, 3
    s_mul_i32 s29, s29, 196608
    s_add_u32 s44, s30, s29
    s_add_u32 s29, s50, 3
    s_and_b32 s29, s29, 3
    s_mul_i32 s29, s29, 196608
    s_add_u32 s45, s30, s29
    s_mov_b32 s35, s41
    s_mul_i32 s48, s24, 327680
    s_add_u32 s48, s48, s34
    s_mul_i32 s49, s24, 8192
    s_add_u32 s49, s49, s42
    s_mov_b32 m0, s35
    s_nop 0
    buffer_load_dwordx4 v1, s[4:7], s34 offen offset:0 sc1 lds
    buffer_load_dwordx4 v1, s[4:7], s34 offen offset:1024 sc1 lds
    buffer_load_dwordx4 v1, s[4:7], s34 offen offset:2048 sc1 lds
    buffer_load_dwordx4 v1, s[4:7], s34 offen offset:3072 sc1 lds
    s_add_u32 m0, s35, 4096
    s_add_u32 s29, s34, 4096
    buffer_load_dwordx4 v1, s[4:7], s29 offen offset:0 sc1 lds
    s_add_u32 s34, s34, 81920
    s_add_u32 s35, s35, 20480
    s_add_u32 s29, s41, 122880
    s_cmp_ge_u32 s35, s29
    s_cselect_b32 s35, s41, s35
    s_cmp_ge_u32 s34, s48
    s_cselect_b32 s34, 0x7f000000, s34
    s_mov_b32 m0, s35
    s_nop 0
    buffer_load_dwordx4 v1, s[4:7], s34 offen offset:0 sc1 lds
    buffer_load_dwordx4 v1, s[4:7], s34 offen offset:1024 sc1 lds
    buffer_load_dwordx4 v1, s[4:7], s34 offen offset:2048 sc1 lds
    buffer_load_dwordx4 v1, s[4:7], s34 offen offset:3072 sc1 lds
    s_add_u32 m0, s35, 4096
    s_add_u32 s29, s34, 4096
    buffer_load_dwordx4 v1, s[4:7], s29 offen offset:0 sc1 lds
    s_add_u32 s34, s34, 81920
    s_add_u32 s35, s35, 20480
    s_add_u32 s29, s41, 122880
    s_cmp_ge_u32 s35, s29
    s_cselect_b32 s35, s41, s35
    s_cmp_ge_u32 s34, s48
    s_cselect_b32 s34, 0x7f000000, s34
    s_mov_b32 m0, s35
    s_nop 0
    buffer_load_dwordx4 v1, s[4:7], s34 offen offset:0 sc1 lds
    buffer_load_dwordx4 v1, s[4:7], s34 offen offset:1024 sc1 lds
    buffer_load_dwordx4 v1, s[4:7], s34 offen offset:2048 sc1 lds
    buffer_load_dwordx4 v1, s[4:7], s34 offen offset:3072 sc1 lds
    s_add_u32 m0, s35, 4096
    s_add_u32 s29, s34, 4096
    buffer_load_dwordx4 v1, s[4:7], s29 offen offset:0 sc1 lds
    s_add_u32 s34, s34, 81920
    s_add_u32 s35, s35, 20480
    s_add_u32 s29, s41, 122880
    s_cmp_ge_u32 s35, s29
    s_cselect_b32 s35, s41, s35
    s_cmp_ge_u32 s34, s48
    s_cselect_b32 s34, 0x7f000000, s34
    s_mov_b32 m0, s35
    s_nop 0
    buffer_load_dwordx4 v1, s[4:7], s34 offen offset:0 sc1 lds
    buffer_load_dwordx4 v1, s[4:7], s34 offen offset:1024 sc1 lds
    buffer_load_dwordx4 v1, s[4:7], s34 offen offset:2048 sc1 lds
    buffer_load_dwordx4 v1, s[4:7], s34 offen offset:3072 sc1 lds
    s_add_u32 m0, s35, 4096
    s_add_u32 s29, s34, 4096
    buffer_load_dwordx4 v1, s[4:7], s29 offen offset:0 sc1 lds
    s_add_u32 s34, s34, 81920
    s_add_u32 s35, s35, 20480
    s_add_u32 s29, s41, 122880
    s_cmp_ge_u32 s35, s29
    s_cselect_b32 s35, s41, s35
    s_cmp_ge_u32 s34, s48
    s_cselect_b32 s34, 0x7f000000, s34
    s_mul_i32 s30, s17, 2048
    s_mul_i32 s29, s20, 128
    s_add_u32 s30, s30, s29
    s_add_u32 s30, s30, 184512512
    s_cmp_lg_u32 s16, 0
    s_cbranch_scc1 L_93
L_92:
    buffer_load_dword v6, v2, s[4:7], s30 offen offset:0 sc1
    s_waitcnt vmcnt(0)
    v_cmp_gt_u32 vcc, 32, v6
    s_cbranch_vccz L_93
    s_sleep 8
    s_branch L_spin_94
L_93:
    s_barrier
    s_cmp_lg_u32 s16, 0
    s_cbranch_scc1 L_96
L_95:
    buffer_load_dword v6, v2, s[4:7], s30 offen offset:128 sc1
    s_waitcnt vmcnt(0)
    v_cmp_gt_u32 vcc, 32, v6
    s_cbranch_vccz L_96
    s_sleep 8
    s_branch L_spin_97
L_96:
    s_barrier
    buffer_load_dwordx4 v[96:99], v1, s[4:7], s42 offen offset:0 sc1
    buffer_load_dwordx4 v[112:115], v1, s[4:7], s42 offen offset:1024 sc1
    s_add_u32 s42, s42, 2048
    buffer_load_dwordx4 v[100:103], v1, s[4:7], s43 offen offset:0 sc1
    buffer_load_dwordx4 v[116:119], v1, s[4:7], s43 offen offset:1024 sc1
    s_add_u32 s43, s43, 2048
    buffer_load_dwordx4 v[104:107], v1, s[4:7], s44 offen offset:0 sc1
    buffer_load_dwordx4 v[120:123], v1, s[4:7], s44 offen offset:1024 sc1
    s_add_u32 s44, s44, 2048
    buffer_load_dwordx4 v[108:111], v1, s[4:7], s45 offen offset:0 sc1
    buffer_load_dwordx4 v[124:127], v1, s[4:7], s45 offen offset:1024 sc1
    s_add_u32 s45, s45, 2048
    s_cmp_ge_u32 s42, s49
    s_cselect_b32 s42, 0x7f000000, s42
    s_cselect_b32 s43, 0x7f000000, s43
    s_cselect_b32 s44, 0x7f000000, s44
    s_cselect_b32 s45, 0x7f000000, s45
    buffer_load_dwordx4 v[128:131], v1, s[4:7], s42 offen offset:0 sc1
    buffer_load_dwordx4 v[144:147], v1, s[4:7], s42 offen offset:1024 sc1
    s_add_u32 s42, s42, 2048
    buffer_load_dwordx4 v[132:135], v1, s[4:7], s43 offen offset:0 sc1
    buffer_load_dwordx4 v[148:151], v1, s[4:7], s43 offen offset:1024 sc1
    s_add_u32 s43, s43, 2048
    buffer_load_dwordx4 v[136:139], v1, s[4:7], s44 offen offset:0 sc1
    buffer_load_dwordx4 v[152:155], v1, s[4:7], s44 offen offset:1024 sc1
    s_add_u32 s44, s44, 2048
    buffer_load_dwordx4 v[140:143], v1, s[4:7], s45 offen offset:0 sc1
    buffer_load_dwordx4 v[156:159], v1, s[4:7], s45 offen offset:1024 sc1
    s_add_u32 s45, s45, 2048
    s_cmp_ge_u32 s42, s49
    s_cselect_b32 s42, 0x7f000000, s42
    s_cselect_b32 s43, 0x7f000000, s43
    s_cselect_b32 s44, 0x7f000000, s44
    s_cselect_b32 s45, 0x7f000000, s45
    buffer_load_dwordx4 v[160:163], v1, s[4:7], s42 offen offset:0 sc1
    buffer_load_dwordx4 v[176:179], v1, s[4:7], s42 offen offset:1024 sc1
    s_add_u32 s42, s42, 2048
    buffer_load_dwordx4 v[164:167], v1, s[4:7], s43 offen offset:0 sc1
    buffer_load_dwordx4 v[180:183], v1, s[4:7], s43 offen offset:1024 sc1
    s_add_u32 s43, s43, 2048
    buffer_load_dwordx4 v[168:171], v1, s[4:7], s44 offen offset:0 sc1
    buffer_load_dwordx4 v[184:187], v1, s[4:7], s44 offen offset:1024 sc1
    s_add_u32 s44, s44, 2048
    buffer_load_dwordx4 v[172:175], v1, s[4:7], s45 offen offset:0 sc1
    buffer_load_dwordx4 v[188:191], v1, s[4:7], s45 offen offset:1024 sc1
    s_add_u32 s45, s45, 2048
    s_cmp_ge_u32 s42, s49
    s_cselect_b32 s42, 0x7f000000, s42
    s_cselect_b32 s43, 0x7f000000, s43
    s_cselect_b32 s44, 0x7f000000, s44
    s_cselect_b32 s45, 0x7f000000, s45
    v_accvgpr_write_b32 a0, 0
    v_accvgpr_write_b32 a1, 0
    v_accvgpr_write_b32 a2, 0
    v_accvgpr_write_b32 a3, 0
    v_accvgpr_write_b32 a4, 0
    v_accvgpr_write_b32 a5, 0
    v_accvgpr_write_b32 a6, 0
    v_accvgpr_write_b32 a7, 0
    v_accvgpr_write_b32 a8, 0
    v_accvgpr_write_b32 a9, 0
    v_accvgpr_write_b32 a10, 0
    v_accvgpr_write_b32 a11, 0
    v_accvgpr_write_b32 a12, 0
    v_accvgpr_write_b32 a13, 0
    v_accvgpr_write_b32 a14, 0
    v_accvgpr_write_b32 a15, 0
    v_accvgpr_write_b32 a16, 0
    v_accvgpr_write_b32 a17, 0
    v_accvgpr_write_b32 a18, 0
    v_accvgpr_write_b32 a19, 0
    v_accvgpr_write_b32 a20, 0
    v_accvgpr_write_b32 a21, 0
    v_accvgpr_write_b32 a22, 0
    v_accvgpr_write_b32 a23, 0
    v_accvgpr_write_b32 a24, 0
    v_accvgpr_write_b32 a25, 0
    v_accvgpr_write_b32 a26, 0
    v_accvgpr_write_b32 a27, 0
    v_accvgpr_write_b32 a28, 0
    v_accvgpr_write_b32 a29, 0
    v_accvgpr_write_b32 a30, 0
    v_accvgpr_write_b32 a31, 0
    v_accvgpr_write_b32 a32, 0
    v_accvgpr_write_b32 a33, 0
    v_accvgpr_write_b32 a34, 0
    v_accvgpr_write_b32 a35, 0
    v_accvgpr_write_b32 a36, 0
    v_accvgpr_write_b32 a37, 0
    v_accvgpr_write_b32 a38, 0
    v_accvgpr_write_b32 a39, 0
    v_accvgpr_write_b32 a40, 0
    v_accvgpr_write_b32 a41, 0
    v_accvgpr_write_b32 a42, 0
    v_accvgpr_write_b32 a43, 0
    v_accvgpr_write_b32 a44, 0
    v_accvgpr_write_b32 a45, 0
    v_accvgpr_write_b32 a46, 0
    v_accvgpr_write_b32 a47, 0
    v_accvgpr_write_b32 a48, 0
    v_accvgpr_write_b32 a49, 0
    v_accvgpr_write_b32 a50, 0
    v_accvgpr_write_b32 a51, 0
    v_accvgpr_write_b32 a52, 0
    v_accvgpr_write_b32 a53, 0
    v_accvgpr_write_b32 a54, 0
    v_accvgpr_write_b32 a55, 0
    v_accvgpr_write_b32 a56, 0
    v_accvgpr_write_b32 a57, 0
    v_accvgpr_write_b32 a58, 0
    v_accvgpr_write_b32 a59, 0
    v_accvgpr_write_b32 a60, 0
    v_accvgpr_write_b32 a61, 0
    v_accvgpr_write_b32 a62, 0
    v_accvgpr_write_b32 a63, 0
    v_accvgpr_write_b32 a64, 0
    v_accvgpr_write_b32 a65, 0
    v_accvgpr_write_b32 a66, 0
    v_accvgpr_write_b32 a67, 0
    v_accvgpr_write_b32 a68, 0
    v_accvgpr_write_b32 a69, 0
    v_accvgpr_write_b32 a70, 0
    v_accvgpr_write_b32 a71, 0
    v_accvgpr_write_b32 a72, 0
    v_accvgpr_write_b32 a73, 0
    v_accvgpr_write_b32 a74, 0
    v_accvgpr_write_b32 a75, 0
    v_accvgpr_write_b32 a76, 0
    v_accvgpr_write_b32 a77, 0
    v_accvgpr_write_b32 a78, 0
    v_accvgpr_write_b32 a79, 0
    v_accvgpr_write_b32 a80, 0
    v_accvgpr_write_b32 a81, 0
    v_accvgpr_write_b32 a82, 0
    v_accvgpr_write_b32 a83, 0
    v_accvgpr_write_b32 a84, 0
    v_accvgpr_write_b32 a85, 0
    v_accvgpr_write_b32 a86, 0
    v_accvgpr_write_b32 a87, 0
    v_accvgpr_write_b32 a88, 0
    v_accvgpr_write_b32 a89, 0
    v_accvgpr_write_b32 a90, 0
    v_accvgpr_write_b32 a91, 0
    v_accvgpr_write_b32 a92, 0
    v_accvgpr_write_b32 a93, 0
    v_accvgpr_write_b32 a94, 0
    v_accvgpr_write_b32 a95, 0
    v_accvgpr_write_b32 a96, 0
    v_accvgpr_write_b32 a97, 0
    v_accvgpr_write_b32 a98, 0
    v_accvgpr_write_b32 a99, 0
    v_accvgpr_write_b32 a100, 0
    v_accvgpr_write_b32 a101, 0
    v_accvgpr_write_b32 a102, 0
    v_accvgpr_write_b32 a103, 0
    v_accvgpr_write_b32 a104, 0
    v_accvgpr_write_b32 a105, 0
    v_accvgpr_write_b32 a106, 0
    v_accvgpr_write_b32 a107, 0
    v_accvgpr_write_b32 a108, 0
    v_accvgpr_write_b32 a109, 0
    v_accvgpr_write_b32 a110, 0
    v_accvgpr_write_b32 a111, 0
    v_accvgpr_write_b32 a112, 0
    v_accvgpr_write_b32 a113, 0
    v_accvgpr_write_b32 a114, 0
    v_accvgpr_write_b32 a115, 0
    v_accvgpr_write_b32 a116, 0
    v_accvgpr_write_b32 a117, 0
    v_accvgpr_write_b32 a118, 0
    v_accvgpr_write_b32 a119, 0
    v_accvgpr_write_b32 a120, 0
    v_accvgpr_write_b32 a121, 0
    v_accvgpr_write_b32 a122, 0
    v_accvgpr_write_b32 a123, 0
    v_accvgpr_write_b32 a124, 0
    v_accvgpr_write_b32 a125, 0
    v_accvgpr_write_b32 a126, 0
    v_accvgpr_write_b32 a127, 0
    v_accvgpr_write_b32 a128, 0
    v_accvgpr_write_b32 a129, 0
    v_accvgpr_write_b32 a130, 0
    v_accvgpr_write_b32 a131, 0
    v_accvgpr_write_b32 a132, 0
    v_accvgpr_write_b32 a133, 0
    v_accvgpr_write_b32 a134, 0
    v_accvgpr_write_b32 a135, 0
    v_accvgpr_write_b32 a136, 0
    v_accvgpr_write_b32 a137, 0
    v_accvgpr_write_b32 a138, 0
    v_accvgpr_write_b32 a139, 0
    v_accvgpr_write_b32 a140, 0
    v_accvgpr_write_b32 a141, 0
    v_accvgpr_write_b32 a142, 0
    v_accvgpr_write_b32 a143, 0
    v_accvgpr_write_b32 a144, 0
    v_accvgpr_write_b32 a145, 0
    v_accvgpr_write_b32 a146, 0
    v_accvgpr_write_b32 a147, 0
    v_accvgpr_write_b32 a148, 0
    v_accvgpr_write_b32 a149, 0
    v_accvgpr_write_b32 a150, 0
    v_accvgpr_write_b32 a151, 0
    v_accvgpr_write_b32 a152, 0
    v_accvgpr_write_b32 a153, 0
    v_accvgpr_write_b32 a154, 0
    v_accvgpr_write_b32 a155, 0
    v_accvgpr_write_b32 a156, 0
    v_accvgpr_write_b32 a157, 0
    v_accvgpr_write_b32 a158, 0
    v_accvgpr_write_b32 a159, 0
    v_mov_b32 v3, v1
    v_add_u32 v4, 20480, v1
    s_waitcnt vmcnt(0)
    s_barrier
    ds_read_b128 v[16:19], v3 offset:0
    ds_read_b128 v[20:23], v3 offset:1024
    ds_read_b128 v[24:27], v3 offset:2048
    ds_read_b128 v[28:31], v3 offset:3072
    ds_read_b128 v[32:35], v3 offset:4096
    ds_read_b128 v[36:39], v3 offset:5120
    ds_read_b128 v[40:43], v3 offset:6144
    ds_read_b128 v[44:47], v3 offset:7168
    ds_read_b128 v[48:51], v3 offset:8192
    ds_read_b128 v[52:55], v3 offset:9216
.p2align 6
L_op4_loop:
    s_waitcnt vmcnt(26)
    s_waitcnt lgkmcnt(9)
    v_mfma_f32_16x16x32_bf16 a[0:3], v[16:19], v[96:99], a[0:3]
    ds_read_b128 v[56:59], v3 offset:10240
    v_mfma_f32_16x16x32_bf16 a[4:7], v[16:19], v[100:103], a[4:7]
    s_mov_b32 m0, s35
    s_nop 0
    buffer_load_dwordx4 v1, s[4:7], s34 offen offset:0 sc1 lds
    v_mfma_f32_16x16x32_bf16 a[8:11], v[16:19], v[104:107], a[8:11]
    v_mfma_f32_16x16x32_bf16 a[12:15], v[16:19], v[108:111], a[12:15]
    s_waitcnt lgkmcnt(9)
    v_mfma_f32_16x16x32_bf16 a[16:19], v[20:23], v[96:99], a[16:19]
    ds_read_b128 v[60:63], v3 offset:11264
    v_mfma_f32_16x16x32_bf16 a[20:23], v[20:23], v[100:103], a[20:23]
    buffer_load_dwordx4 v1, s[4:7], s34 offen offset:1024 sc1 lds
    v_mfma_f32_16x16x32_bf16 a[24:27], v[20:23], v[104:107], a[24:27]
    v_mfma_f32_16x16x32_bf16 a[28:31], v[20:23], v[108:111], a[28:31]
    s_waitcnt lgkmcnt(9)
    v_mfma_f32_16x16x32_bf16 a[32:35], v[24:27], v[96:99], a[32:35]
    ds_read_b128 v[64:67], v3 offset:12288
    v_mfma_f32_16x16x32_bf16 a[36:39], v[24:27], v[100:103], a[36:39]
    v_mfma_f32_16x16x32_bf16 a[40:43], v[24:27], v[104:107], a[40:43]
    v_mfma_f32_16x16x32_bf16 a[44:47], v[24:27], v[108:111], a[44:47]
    s_waitcnt lgkmcnt(9)
    v_mfma_f32_16x16x32_bf16 a[48:51], v[28:31], v[96:99], a[48:51]
    ds_read_b128 v[68:71], v3 offset:13312
    v_mfma_f32_16x16x32_bf16 a[52:55], v[28:31], v[100:103], a[52:55]
    buffer_load_dwordx4 v1, s[4:7], s34 offen offset:2048 sc1 lds
    v_mfma_f32_16x16x32_bf16 a[56:59], v[28:31], v[104:107], a[56:59]
    v_mfma_f32_16x16x32_bf16 a[60:63], v[28:31], v[108:111], a[60:63]
    s_waitcnt lgkmcnt(9)
    v_mfma_f32_16x16x32_bf16 a[64:67], v[32:35], v[96:99], a[64:67]
    ds_read_b128 v[72:75], v3 offset:14336
    v_mfma_f32_16x16x32_bf16 a[68:71], v[32:35], v[100:103], a[68:71]
    buffer_load_dwordx4 v1, s[4:7], s34 offen offset:3072 sc1 lds
    v_mfma_f32_16x16x32_bf16 a[72:75], v[32:35], v[104:107], a[72:75]
    v_mfma_f32_16x16x32_bf16 a[76:79], v[32:35], v[108:111], a[76:79]
    s_waitcnt lgkmcnt(9)
    v_mfma_f32_16x16x32_bf16 a[80:83], v[36:39], v[96:99], a[80:83]
    ds_read_b128 v[76:79], v3 offset:15360
    v_mfma_f32_16x16x32_bf16 a[84:87], v[36:39], v[100:103], a[84:87]
    v_mfma_f32_16x16x32_bf16 a[88:91], v[36:39], v[104:107], a[88:91]
    v_mfma_f32_16x16x32_bf16 a[92:95], v[36:39], v[108:111], a[92:95]
    s_waitcnt lgkmcnt(9)
    v_mfma_f32_16x16x32_bf16 a[96:99], v[40:43], v[96:99], a[96:99]
    ds_read_b128 v[80:83], v3 offset:16384
    v_mfma_f32_16x16x32_bf16 a[100:103], v[40:43], v[100:103], a[100:103]
    s_add_u32 m0, s35, 4096
    s_add_u32 s29, s34, 4096
    buffer_load_dwordx4 v1, s[4:7], s29 offen offset:0 sc1 lds
    s_add_u32 s34, s34, 81920
    s_add_u32 s35, s35, 20480
    s_add_u32 s29, s41, 122880
    s_cmp_ge_u32 s35, s29
    s_cselect_b32 s35, s41, s35
    s_cmp_ge_u32 s34, s48
    s_cselect_b32 s34, 0x7f000000, s34
    v_mfma_f32_16x16x32_bf16 a[104:107], v[40:43], v[104:107], a[104:107]
    v_mfma_f32_16x16x32_bf16 a[108:111], v[40:43], v[108:111], a[108:111]
    s_waitcnt lgkmcnt(9)
    v_mfma_f32_16x16x32_bf16 a[112:115], v[44:47], v[96:99], a[112:115]
    ds_read_b128 v[84:87], v3 offset:17408
    v_mfma_f32_16x16x32_bf16 a[116:119], v[44:47], v[100:103], a[116:119]
    buffer_load_dwordx4 v[192:195], v1, s[4:7], s42 offen offset:0 sc1
    v_mfma_f32_16x16x32_bf16 a[120:123], v[44:47], v[104:107], a[120:123]
    v_mfma_f32_16x16x32_bf16 a[124:127], v[44:47], v[108:111], a[124:127]
    s_waitcnt lgkmcnt(9)
    v_mfma_f32_16x16x32_bf16 a[128:131], v[48:51], v[96:99], a[128:131]
    ds_read_b128 v[88:91], v3 offset:18432
    v_mfma_f32_16x16x32_bf16 a[132:135], v[48:51], v[100:103], a[132:135]
    v_mfma_f32_16x16x32_bf16 a[136:139], v[48:51], v[104:107], a[136:139]
    v_mfma_f32_16x16x32_bf16 a[140:143], v[48:51], v[108:111], a[140:143]
    s_waitcnt lgkmcnt(9)
    v_mfma_f32_16x16x32_bf16 a[144:147], v[52:55], v[96:99], a[144:147]
    ds_read_b128 v[92:95], v3 offset:19456
    v_mfma_f32_16x16x32_bf16 a[148:151], v[52:55], v[100:103], a[148:151]
    buffer_load_dwordx4 v[208:211], v1, s[4:7], s42 offen offset:1024 sc1
    s_add_u32 s42, s42, 2048
    v_mfma_f32_16x16x32_bf16 a[152:155], v[52:55], v[104:107], a[152:155]
    v_mfma_f32_16x16x32_bf16 a[156:159], v[52:55], v[108:111], a[156:159]
    s_waitcnt vmcnt(41)
    s_barrier
    s_waitcnt lgkmcnt(9)
    v_mfma_f32_16x16x32_bf16 a[0:3], v[56:59], v[112:115], a[0:3]
    ds_read_b128 v[16:19], v4 offset:0
    v_mfma_f32_16x16x32_bf16 a[4:7], v[56:59], v[116:119], a[4:7]
    buffer_load_dwordx4 v[196:199], v1, s[4:7], s43 offen offset:0 sc1
    v_mfma_f32_16x16x32_bf16 a[8:11], v[56:59], v[120:123], a[8:11]
    v_mfma_f32_16x16x32_bf16 a[12:15], v[56:59], v[124:127], a[12:15]
    s_waitcnt lgkmcnt(9)
    v_mfma_f32_16x16x32_bf16 a[16:19], v[60:63], v[112:115], a[16:19]
    ds_read_b128 v[20:23], v4 offset:1024
    v_mfma_f32_16x16x32_bf16 a[20:23], v[60:63], v[116:119], a[20:23]
    v_mfma_f32_16x16x32_bf16 a[24:27], v[60:63], v[120:123], a[24:27]
    v_mfma_f32_16x16x32_bf16 a[28:31], v[60:63], v[124:127], a[28:31]
    s_waitcnt lgkmcnt(9)
    v_mfma_f32_16x16x32_bf16 a[32:35], v[64:67], v[112:115], a[32:35]
    ds_read_b128 v[24:27], v4 offset:2048
    v_mfma_f32_16x16x32_bf16 a[36:39], v[64:67], v[116:119], a[36:39]
    buffer_load_dwordx4 v[212:215], v1, s[4:7], s43 offen offset:1024 sc1
    s_add_u32 s43, s43, 2048
    v_mfma_f32_16x16x32_bf16 a[40:43], v[64:67], v[120:123], a[40:43]
    v_mfma_f32_16x16x32_bf16 a[44:47], v[64:67], v[124:127], a[44:47]
    s_waitcnt lgkmcnt(9)
    v_mfma_f32_16x16x32_bf16 a[48:51], v[68:71], v[112:115], a[48:51]
    ds_read_b128 v[28:31], v4 offset:3072
    v_mfma_f32_16x16x32_bf16 a[52:55], v[68:71], v[116:119], a[52:55]
    buffer_load_dwordx4 v[200:203], v1, s[4:7], s44 offen offset:0 sc1
    v_mfma_f32_16x16x32_bf16 a[56:59], v[68:71], v[120:123], a[56:59]
    v_mfma_f32_16x16x32_bf16 a[60:63], v[68:71], v[124:127], a[60:63]
    s_waitcnt lgkmcnt(9)
    v_mfma_f32_16x16x32_bf16 a[64:67], v[72:75], v[112:115], a[64:67]
    ds_read_b128 v[32:35], v4 offset:4096
    v_mfma_f32_16x16x32_bf16 a[68:71], v[72:75], v[116:119], a[68:71]
    v_mfma_f32_16x16x32_bf16 a[72:75], v[72:75], v[120:123], a[72:75]
    v_mfma_f32_16x16x32_bf16 a[76:79], v[72:75], v[124:127], a[76:79]
    s_waitcnt lgkmcnt(9)
    v_mfma_f32_16x16x32_bf16 a[80:83], v[76:79], v[112:115], a[80:83]
    ds_read_b128 v[36:39], v4 offset:5120
    v_mfma_f32_16x16x32_bf16 a[84:87], v[76:79], v[116:119], a[84:87]
    buffer_load_dwordx4 v[216:219], v1, s[4:7], s44 offen offset:1024 sc1
    s_add_u32 s44, s44, 2048
    v_mfma_f32_16x16x32_bf16 a[88:91], v[76:79], v[120:123], a[88:91]
    v_mfma_f32_16x16x32_bf16 a[92:95], v[76:79], v[124:127], a[92:95]
    s_waitcnt lgkmcnt(9)
    v_mfma_f32_16x16x32_bf16 a[96:99], v[80:83], v[112:115], a[96:99]
    ds_read_b128 v[40:43], v4 offset:6144
    v_mfma_f32_16x16x32_bf16 a[100:103], v[80:83], v[116:119], a[100:103]
    buffer_load_dwordx4 v[204:207], v1, s[4:7], s45 offen offset:0 sc1
    v_mfma_f32_16x16x32_bf16 a[104:107], v[80:83], v[120:123], a[104:107]
    v_mfma_f32_16x16x32_bf16 a[108:111], v[80:83], v[124:127], a[108:111]
    s_waitcnt lgkmcnt(9)
    v_mfma_f32_16x16x32_bf16 a[112:115], v[84:87], v[112:115], a[112:115]
    ds_read_b128 v[44:47], v4 offset:7168
    v_mfma_f32_16x16x32_bf16 a[116:119], v[84:87], v[116:119], a[116:119]
    v_mfma_f32_16x16x32_bf16 a[120:123], v[84:87], v[120:123], a[120:123]
    v_mfma_f32_16x16x32_bf16 a[124:127], v[84:87], v[124:127], a[124:127]
    s_waitcnt lgkmcnt(9)
    v_mfma_f32_16x16x32_bf16 a[128:131], v[88:91], v[112:115], a[128:131]
    ds_read_b128 v[48:51], v4 offset:8192
    v_mfma_f32_16x16x32_bf16 a[132:135], v[88:91], v[116:119], a[132:135]
    buffer_load_dwordx4 v[220:223], v1, s[4:7], s45 offen offset:1024 sc1
    s_add_u32 s45, s45, 2048
    s_cmp_ge_u32 s42, s49
    s_cselect_b32 s42, 0x7f000000, s42
    s_cselect_b32 s43, 0x7f000000, s43
    s_cselect_b32 s44, 0x7f000000, s44
    s_cselect_b32 s45, 0x7f000000, s45
    v_mfma_f32_16x16x32_bf16 a[136:139], v[88:91], v[120:123], a[136:139]
    v_mfma_f32_16x16x32_bf16 a[140:143], v[88:91], v[124:127], a[140:143]
    s_waitcnt lgkmcnt(9)
    v_mfma_f32_16x16x32_bf16 a[144:147], v[92:95], v[112:115], a[144:147]
    ds_read_b128 v[52:55], v4 offset:9216
    v_mfma_f32_16x16x32_bf16 a[148:151], v[92:95], v[116:119], a[148:151]
    v_mfma_f32_16x16x32_bf16 a[152:155], v[92:95], v[120:123], a[152:155]
    v_mfma_f32_16x16x32_bf16 a[156:159], v[92:95], v[124:127], a[156:159]
    v_mov_b32 v3, v4
    v_add_u32 v4, 20480, v4
    v_subrev_u32 v6, 122880, v4
    v_min_u32 v4, v4, v6
    s_waitcnt vmcnt(26)
    s_waitcnt lgkmcnt(9)
    v_mfma_f32_16x16x32_bf16 a[0:3], v[16:19], v[128:131], a[0:3]
    ds_read_b128 v[56:59], v3 offset:10240
    v_mfma_f32_16x16x32_bf16 a[4:7], v[16:19], v[132:135], a[4:7]
    s_mov_b32 m0, s35
    s_nop 0
    buffer_load_dwordx4 v1, s[4:7], s34 offen offset:0 sc1 lds
    v_mfma_f32_16x16x32_bf16 a[8:11], v[16:19], v[136:139], a[8:11]
    v_mfma_f32_16x16x32_bf16 a[12:15], v[16:19], v[140:143], a[12:15]
    s_waitcnt lgkmcnt(9)
    v_mfma_f32_16x16x32_bf16 a[16:19], v[20:23], v[128:131], a[16:19]
    ds_read_b128 v[60:63], v3 offset:11264
    v_mfma_f32_16x16x32_bf16 a[20:23], v[20:23], v[132:135], a[20:23]
    buffer_load_dwordx4 v1, s[4:7], s34 offen offset:1024 sc1 lds
    v_mfma_f32_16x16x32_bf16 a[24:27], v[20:23], v[136:139], a[24:27]
    v_mfma_f32_16x16x32_bf16 a[28:31], v[20:23], v[140:143], a[28:31]
    s_waitcnt lgkmcnt(9)
    v_mfma_f32_16x16x32_bf16 a[32:35], v[24:27], v[128:131], a[32:35]
    ds_read_b128 v[64:67], v3 offset:12288
    v_mfma_f32_16x16x32_bf16 a[36:39], v[24:27], v[132:135], a[36:39]
    v_mfma_f32_16x16x32_bf16 a[40:43], v[24:27], v[136:139], a[40:43]
    v_mfma_f32_16x16x32_bf16 a[44:47], v[24:27], v[140:143], a[44:47]
    s_waitcnt lgkmcnt(9)
    v_mfma_f32_16x16x32_bf16 a[48:51], v[28:31], v[128:131], a[48:51]
    ds_read_b128 v[68:71], v3 offset:13312
    v_mfma_f32_16x16x32_bf16 a[52:55], v[28:31], v[132:135], a[52:55]
    buffer_load_dwordx4 v1, s[4:7], s34 offen offset:2048 sc1 lds
    v_mfma_f32_16x16x32_bf16 a[56:59], v[28:31], v[136:139], a[56:59]
    v_mfma_f32_16x16x32_bf16 a[60:63], v[28:31], v[140:143], a[60:63]
    s_waitcnt lgkmcnt(9)
    v_mfma_f32_16x16x32_bf16 a[64:67], v[32:35], v[128:131], a[64:67]
    ds_read_b128 v[72:75], v3 offset:14336
    v_mfma_f32_16x16x32_bf16 a[68:71], v[32:35], v[132:135], a[68:71]
    buffer_load_dwordx4 v1, s[4:7], s34 offen offset:3072 sc1 lds
    v_mfma_f32_16x16x32_bf16 a[72:75], v[32:35], v[136:139], a[72:75]
    v_mfma_f32_16x16x32_bf16 a[76:79], v[32:35], v[140:143], a[76:79]
    s_waitcnt lgkmcnt(9)
    v_mfma_f32_16x16x32_bf16 a[80:83], v[36:39], v[128:131], a[80:83]
    ds_read_b128 v[76:79], v3 offset:15360
    v_mfma_f32_16x16x32_bf16 a[84:87], v[36:39], v[132:135], a[84:87]
    v_mfma_f32_16x16x32_bf16 a[88:91], v[36:39], v[136:139], a[88:91]
    v_mfma_f32_16x16x32_bf16 a[92:95], v[36:39], v[140:143], a[92:95]
    s_waitcnt lgkmcnt(9)
    v_mfma_f32_16x16x32_bf16 a[96:99], v[40:43], v[128:131], a[96:99]
    ds_read_b128 v[80:83], v3 offset:16384
    v_mfma_f32_16x16x32_bf16 a[100:103], v[40:43], v[132:135], a[100:103]
    s_add_u32 m0, s35, 4096
    s_add_u32 s29, s34, 4096
    buffer_load_dwordx4 v1, s[4:7], s29 offen offset:0 sc1 lds
    s_add_u32 s34, s34, 81920
    s_add_u32 s35, s35, 20480
    s_add_u32 s29, s41, 122880
    s_cmp_ge_u32 s35, s29
    s_cselect_b32 s35, s41, s35
    s_cmp_ge_u32 s34, s48
    s_cselect_b32 s34, 0x7f000000, s34
    v_mfma_f32_16x16x32_bf16 a[104:107], v[40:43], v[136:139], a[104:107]
    v_mfma_f32_16x16x32_bf16 a[108:111], v[40:43], v[140:143], a[108:111]
    s_waitcnt lgkmcnt(9)
    v_mfma_f32_16x16x32_bf16 a[112:115], v[44:47], v[128:131], a[112:115]
    ds_read_b128 v[84:87], v3 offset:17408
    v_mfma_f32_16x16x32_bf16 a[116:119], v[44:47], v[132:135], a[116:119]
    buffer_load_dwordx4 v[96:99], v1, s[4:7], s42 offen offset:0 sc1
    v_mfma_f32_16x16x32_bf16 a[120:123], v[44:47], v[136:139], a[120:123]
    v_mfma_f32_16x16x32_bf16 a[124:127], v[44:47], v[140:143], a[124:127]
    s_waitcnt lgkmcnt(9)
    v_mfma_f32_16x16x32_bf16 a[128:131], v[48:51], v[128:131], a[128:131]
    ds_read_b128 v[88:91], v3 offset:18432
    v_mfma_f32_16x16x32_bf16 a[132:135], v[48:51], v[132:135], a[132:135]
    v_mfma_f32_16x16x32_bf16 a[136:139], v[48:51], v[136:139], a[136:139]
    v_mfma_f32_16x16x32_bf16 a[140:143], v[48:51], v[140:143], a[140:143]
    s_waitcnt lgkmcnt(9)
    v_mfma_f32_16x16x32_bf16 a[144:147], v[52:55], v[128:131], a[144:147]
    ds_read_b128 v[92:95], v3 offset:19456
    v_mfma_f32_16x16x32_bf16 a[148:151], v[52:55], v[132:135], a[148:151]
    buffer_load_dwordx4 v[112:115], v1, s[4:7], s42 offen offset:1024 sc1
    s_add_u32 s42, s42, 2048
    v_mfma_f32_16x16x32_bf16 a[152:155], v[52:55], v[136:139], a[152:155]
    v_mfma_f32_16x16x32_bf16 a[156:159], v[52:55], v[140:143], a[156:159]
    s_waitcnt vmcnt(41)
    s_barrier
    s_waitcnt lgkmcnt(9)
    v_mfma_f32_16x16x32_bf16 a[0:3], v[56:59], v[144:147], a[0:3]
    ds_read_b128 v[16:19], v4 offset:0
    v_mfma_f32_16x16x32_bf16 a[4:7], v[56:59], v[148:151], a[4:7]
    buffer_load_dwordx4 v[100:103], v1, s[4:7], s43 offen offset:0 sc1
    v_mfma_f32_16x16x32_bf16 a[8:11], v[56:59], v[152:155], a[8:11]
    v_mfma_f32_16x16x32_bf16 a[12:15], v[56:59], v[156:159], a[12:15]
    s_waitcnt lgkmcnt(9)
    v_mfma_f32_16x16x32_bf16 a[16:19], v[60:63], v[144:147], a[16:19]
    ds_read_b128 v[20:23], v4 offset:1024
    v_mfma_f32_16x16x32_bf16 a[20:23], v[60:63], v[148:151], a[20:23]
    v_mfma_f32_16x16x32_bf16 a[24:27], v[60:63], v[152:155], a[24:27]
    v_mfma_f32_16x16x32_bf16 a[28:31], v[60:63], v[156:159], a[28:31]
    s_waitcnt lgkmcnt(9)
    v_mfma_f32_16x16x32_bf16 a[32:35], v[64:67], v[144:147], a[32:35]
    ds_read_b128 v[24:27], v4 offset:2048
    v_mfma_f32_16x16x32_bf16 a[36:39], v[64:67], v[148:151], a[36:39]
    buffer_load_dwordx4 v[116:119], v1, s[4:7], s43 offen offset:1024 sc1
    s_add_u32 s43, s43, 2048
    v_mfma_f32_16x16x32_bf16 a[40:43], v[64:67], v[152:155], a[40:43]
    v_mfma_f32_16x16x32_bf16 a[44:47], v[64:67], v[156:159], a[44:47]
    s_waitcnt lgkmcnt(9)
    v_mfma_f32_16x16x32_bf16 a[48:51], v[68:71], v[144:147], a[48:51]
    ds_read_b128 v[28:31], v4 offset:3072
    v_mfma_f32_16x16x32_bf16 a[52:55], v[68:71], v[148:151], a[52:55]
    buffer_load_dwordx4 v[104:107], v1, s[4:7], s44 offen offset:0 sc1
    v_mfma_f32_16x16x32_bf16 a[56:59], v[68:71], v[152:155], a[56:59]
    v_mfma_f32_16x16x32_bf16 a[60:63], v[68:71], v[156:159], a[60:63]
    s_waitcnt lgkmcnt(9)
    v_mfma_f32_16x16x32_bf16 a[64:67], v[72:75], v[144:147], a[64:67]
    ds_read_b128 v[32:35], v4 offset:4096
    v_mfma_f32_16x16x32_bf16 a[68:71], v[72:75], v[148:151], a[68:71]
    v_mfma_f32_16x16x32_bf16 a[72:75], v[72:75], v[152:155], a[72:75]
    v_mfma_f32_16x16x32_bf16 a[76:79], v[72:75], v[156:159], a[76:79]
    s_waitcnt lgkmcnt(9)
    v_mfma_f32_16x16x32_bf16 a[80:83], v[76:79], v[144:147], a[80:83]
    ds_read_b128 v[36:39], v4 offset:5120
    v_mfma_f32_16x16x32_bf16 a[84:87], v[76:79], v[148:151], a[84:87]
    buffer_load_dwordx4 v[120:123], v1, s[4:7], s44 offen offset:1024 sc1
    s_add_u32 s44, s44, 2048
    v_mfma_f32_16x16x32_bf16 a[88:91], v[76:79], v[152:155], a[88:91]
    v_mfma_f32_16x16x32_bf16 a[92:95], v[76:79], v[156:159], a[92:95]
    s_waitcnt lgkmcnt(9)
    v_mfma_f32_16x16x32_bf16 a[96:99], v[80:83], v[144:147], a[96:99]
    ds_read_b128 v[40:43], v4 offset:6144
    v_mfma_f32_16x16x32_bf16 a[100:103], v[80:83], v[148:151], a[100:103]
    buffer_load_dwordx4 v[108:111], v1, s[4:7], s45 offen offset:0 sc1
    v_mfma_f32_16x16x32_bf16 a[104:107], v[80:83], v[152:155], a[104:107]
    v_mfma_f32_16x16x32_bf16 a[108:111], v[80:83], v[156:159], a[108:111]
    s_waitcnt lgkmcnt(9)
    v_mfma_f32_16x16x32_bf16 a[112:115], v[84:87], v[144:147], a[112:115]
    ds_read_b128 v[44:47], v4 offset:7168
    v_mfma_f32_16x16x32_bf16 a[116:119], v[84:87], v[148:151], a[116:119]
    v_mfma_f32_16x16x32_bf16 a[120:123], v[84:87], v[152:155], a[120:123]
    v_mfma_f32_16x16x32_bf16 a[124:127], v[84:87], v[156:159], a[124:127]
    s_waitcnt lgkmcnt(9)
    v_mfma_f32_16x16x32_bf16 a[128:131], v[88:91], v[144:147], a[128:131]
    ds_read_b128 v[48:51], v4 offset:8192
    v_mfma_f32_16x16x32_bf16 a[132:135], v[88:91], v[148:151], a[132:135]
    buffer_load_dwordx4 v[124:127], v1, s[4:7], s45 offen offset:1024 sc1
    s_add_u32 s45, s45, 2048
    s_cmp_ge_u32 s42, s49
    s_cselect_b32 s42, 0x7f000000, s42
    s_cselect_b32 s43, 0x7f000000, s43
    s_cselect_b32 s44, 0x7f000000, s44
    s_cselect_b32 s45, 0x7f000000, s45
    v_mfma_f32_16x16x32_bf16 a[136:139], v[88:91], v[152:155], a[136:139]
    v_mfma_f32_16x16x32_bf16 a[140:143], v[88:91], v[156:159], a[140:143]
    s_waitcnt lgkmcnt(9)
    v_mfma_f32_16x16x32_bf16 a[144:147], v[92:95], v[144:147], a[144:147]
    ds_read_b128 v[52:55], v4 offset:9216
    v_mfma_f32_16x16x32_bf16 a[148:151], v[92:95], v[148:151], a[148:151]
    v_mfma_f32_16x16x32_bf16 a[152:155], v[92:95], v[152:155], a[152:155]
    v_mfma_f32_16x16x32_bf16 a[156:159], v[92:95], v[156:159], a[156:159]
    v_mov_b32 v3, v4
    v_add_u32 v4, 20480, v4
    v_subrev_u32 v6, 122880, v4
    v_min_u32 v4, v4, v6
    s_waitcnt vmcnt(26)
    s_waitcnt lgkmcnt(9)
    v_mfma_f32_16x16x32_bf16 a[0:3], v[16:19], v[160:163], a[0:3]
    ds_read_b128 v[56:59], v3 offset:10240
    v_mfma_f32_16x16x32_bf16 a[4:7], v[16:19], v[164:167], a[4:7]
    s_mov_b32 m0, s35
    s_nop 0
    buffer_load_dwordx4 v1, s[4:7], s34 offen offset:0 sc1 lds
    v_mfma_f32_16x16x32_bf16 a[8:11], v[16:19], v[168:171], a[8:11]
    v_mfma_f32_16x16x32_bf16 a[12:15], v[16:19], v[172:175], a[12:15]
    s_waitcnt lgkmcnt(9)
    v_mfma_f32_16x16x32_bf16 a[16:19], v[20:23], v[160:163], a[16:19]
    ds_read_b128 v[60:63], v3 offset:11264
    v_mfma_f32_16x16x32_bf16 a[20:23], v[20:23], v[164:167], a[20:23]
    buffer_load_dwordx4 v1, s[4:7], s34 offen offset:1024 sc1 lds
    v_mfma_f32_16x16x32_bf16 a[24:27], v[20:23], v[168:171], a[24:27]
    v_mfma_f32_16x16x32_bf16 a[28:31], v[20:23], v[172:175], a[28:31]
    s_waitcnt lgkmcnt(9)
    v_mfma_f32_16x16x32_bf16 a[32:35], v[24:27], v[160:163], a[32:35]
    ds_read_b128 v[64:67], v3 offset:12288
    v_mfma_f32_16x16x32_bf16 a[36:39], v[24:27], v[164:167], a[36:39]
    v_mfma_f32_16x16x32_bf16 a[40:43], v[24:27], v[168:171], a[40:43]
    v_mfma_f32_16x16x32_bf16 a[44:47], v[24:27], v[172:175], a[44:47]
    s_waitcnt lgkmcnt(9)
    v_mfma_f32_16x16x32_bf16 a[48:51], v[28:31], v[160:163], a[48:51]
    ds_read_b128 v[68:71], v3 offset:13312
    v_mfma_f32_16x16x32_bf16 a[52:55], v[28:31], v[164:167], a[52:55]
    buffer_load_dwordx4 v1, s[4:7], s34 offen offset:2048 sc1 lds
    v_mfma_f32_16x16x32_bf16 a[56:59], v[28:31], v[168:171], a[56:59]
    v_mfma_f32_16x16x32_bf16 a[60:63], v[28:31], v[172:175], a[60:63]
    s_waitcnt lgkmcnt(9)
    v_mfma_f32_16x16x32_bf16 a[64:67], v[32:35], v[160:163], a[64:67]
    ds_read_b128 v[72:75], v3 offset:14336
    v_mfma_f32_16x16x32_bf16 a[68:71], v[32:35], v[164:167], a[68:71]
    buffer_load_dwordx4 v1, s[4:7], s34 offen offset:3072 sc1 lds
    v_mfma_f32_16x16x32_bf16 a[72:75], v[32:35], v[168:171], a[72:75]
    v_mfma_f32_16x16x32_bf16 a[76:79], v[32:35], v[172:175], a[76:79]
    s_waitcnt lgkmcnt(9)
    v_mfma_f32_16x16x32_bf16 a[80:83], v[36:39], v[160:163], a[80:83]
    ds_read_b128 v[76:79], v3 offset:15360
    v_mfma_f32_16x16x32_bf16 a[84:87], v[36:39], v[164:167], a[84:87]
    v_mfma_f32_16x16x32_bf16 a[88:91], v[36:39], v[168:171], a[88:91]
    v_mfma_f32_16x16x32_bf16 a[92:95], v[36:39], v[172:175], a[92:95]
    s_waitcnt lgkmcnt(9)
    v_mfma_f32_16x16x32_bf16 a[96:99], v[40:43], v[160:163], a[96:99]
    ds_read_b128 v[80:83], v3 offset:16384
    v_mfma_f32_16x16x32_bf16 a[100:103], v[40:43], v[164:167], a[100:103]
    s_add_u32 m0, s35, 4096
    s_add_u32 s29, s34, 4096
    buffer_load_dwordx4 v1, s[4:7], s29 offen offset:0 sc1 lds
    s_add_u32 s34, s34, 81920
    s_add_u32 s35, s35, 20480
    s_add_u32 s29, s41, 122880
    s_cmp_ge_u32 s35, s29
    s_cselect_b32 s35, s41, s35
    s_cmp_ge_u32 s34, s48
    s_cselect_b32 s34, 0x7f000000, s34
    v_mfma_f32_16x16x32_bf16 a[104:107], v[40:43], v[168:171], a[104:107]
    v_mfma_f32_16x16x32_bf16 a[108:111], v[40:43], v[172:175], a[108:111]
    s_waitcnt lgkmcnt(9)
    v_mfma_f32_16x16x32_bf16 a[112:115], v[44:47], v[160:163], a[112:115]
    ds_read_b128 v[84:87], v3 offset:17408
    v_mfma_f32_16x16x32_bf16 a[116:119], v[44:47], v[164:167], a[116:119]
    buffer_load_dwordx4 v[128:131], v1, s[4:7], s42 offen offset:0 sc1
    v_mfma_f32_16x16x32_bf16 a[120:123], v[44:47], v[168:171], a[120:123]
    v_mfma_f32_16x16x32_bf16 a[124:127], v[44:47], v[172:175], a[124:127]
    s_waitcnt lgkmcnt(9)
    v_mfma_f32_16x16x32_bf16 a[128:131], v[48:51], v[160:163], a[128:131]
    ds_read_b128 v[88:91], v3 offset:18432
    v_mfma_f32_16x16x32_bf16 a[132:135], v[48:51], v[164:167], a[132:135]
    v_mfma_f32_16x16x32_bf16 a[136:139], v[48:51], v[168:171], a[136:139]
    v_mfma_f32_16x16x32_bf16 a[140:143], v[48:51], v[172:175], a[140:143]
    s_waitcnt lgkmcnt(9)
    v_mfma_f32_16x16x32_bf16 a[144:147], v[52:55], v[160:163], a[144:147]
    ds_read_b128 v[92:95], v3 offset:19456
    v_mfma_f32_16x16x32_bf16 a[148:151], v[52:55], v[164:167], a[148:151]
    buffer_load_dwordx4 v[144:147], v1, s[4:7], s42 offen offset:1024 sc1
    s_add_u32 s42, s42, 2048
    v_mfma_f32_16x16x32_bf16 a[152:155], v[52:55], v[168:171], a[152:155]
    v_mfma_f32_16x16x32_bf16 a[156:159], v[52:55], v[172:175], a[156:159]
    s_waitcnt vmcnt(41)
    s_barrier
    s_waitcnt lgkmcnt(9)
    v_mfma_f32_16x16x32_bf16 a[0:3], v[56:59], v[176:179], a[0:3]
    ds_read_b128 v[16:19], v4 offset:0
    v_mfma_f32_16x16x32_bf16 a[4:7], v[56:59], v[180:183], a[4:7]
    buffer_load_dwordx4 v[132:135], v1, s[4:7], s43 offen offset:0 sc1
    v_mfma_f32_16x16x32_bf16 a[8:11], v[56:59], v[184:187], a[8:11]
    v_mfma_f32_16x16x32_bf16 a[12:15], v[56:59], v[188:191], a[12:15]
    s_waitcnt lgkmcnt(9)
    v_mfma_f32_16x16x32_bf16 a[16:19], v[60:63], v[176:179], a[16:19]
    ds_read_b128 v[20:23], v4 offset:1024
    v_mfma_f32_16x16x32_bf16 a[20:23], v[60:63], v[180:183], a[20:23]
    v_mfma_f32_16x16x32_bf16 a[24:27], v[60:63], v[184:187], a[24:27]
    v_mfma_f32_16x16x32_bf16 a[28:31], v[60:63], v[188:191], a[28:31]
    s_waitcnt lgkmcnt(9)
    v_mfma_f32_16x16x32_bf16 a[32:35], v[64:67], v[176:179], a[32:35]
    ds_read_b128 v[24:27], v4 offset:2048
    v_mfma_f32_16x16x32_bf16 a[36:39], v[64:67], v[180:183], a[36:39]
    buffer_load_dwordx4 v[148:151], v1, s[4:7], s43 offen offset:1024 sc1
    s_add_u32 s43, s43, 2048
    v_mfma_f32_16x16x32_bf16 a[40:43], v[64:67], v[184:187], a[40:43]
    v_mfma_f32_16x16x32_bf16 a[44:47], v[64:67], v[188:191], a[44:47]
    s_waitcnt lgkmcnt(9)
    v_mfma_f32_16x16x32_bf16 a[48:51], v[68:71], v[176:179], a[48:51]
    ds_read_b128 v[28:31], v4 offset:3072
    v_mfma_f32_16x16x32_bf16 a[52:55], v[68:71], v[180:183], a[52:55]
    buffer_load_dwordx4 v[136:139], v1, s[4:7], s44 offen offset:0 sc1
    v_mfma_f32_16x16x32_bf16 a[56:59], v[68:71], v[184:187], a[56:59]
    v_mfma_f32_16x16x32_bf16 a[60:63], v[68:71], v[188:191], a[60:63]
    s_waitcnt lgkmcnt(9)
    v_mfma_f32_16x16x32_bf16 a[64:67], v[72:75], v[176:179], a[64:67]
    ds_read_b128 v[32:35], v4 offset:4096
    v_mfma_f32_16x16x32_bf16 a[68:71], v[72:75], v[180:183], a[68:71]
    v_mfma_f32_16x16x32_bf16 a[72:75], v[72:75], v[184:187], a[72:75]
    v_mfma_f32_16x16x32_bf16 a[76:79], v[72:75], v[188:191], a[76:79]
    s_waitcnt lgkmcnt(9)
    v_mfma_f32_16x16x32_bf16 a[80:83], v[76:79], v[176:179], a[80:83]
    ds_read_b128 v[36:39], v4 offset:5120
    v_mfma_f32_16x16x32_bf16 a[84:87], v[76:79], v[180:183], a[84:87]
    buffer_load_dwordx4 v[152:155], v1, s[4:7], s44 offen offset:1024 sc1
    s_add_u32 s44, s44, 2048
    v_mfma_f32_16x16x32_bf16 a[88:91], v[76:79], v[184:187], a[88:91]
    v_mfma_f32_16x16x32_bf16 a[92:95], v[76:79], v[188:191], a[92:95]
    s_waitcnt lgkmcnt(9)
    v_mfma_f32_16x16x32_bf16 a[96:99], v[80:83], v[176:179], a[96:99]
    ds_read_b128 v[40:43], v4 offset:6144
    v_mfma_f32_16x16x32_bf16 a[100:103], v[80:83], v[180:183], a[100:103]
    buffer_load_dwordx4 v[140:143], v1, s[4:7], s45 offen offset:0 sc1
    v_mfma_f32_16x16x32_bf16 a[104:107], v[80:83], v[184:187], a[104:107]
    v_mfma_f32_16x16x32_bf16 a[108:111], v[80:83], v[188:191], a[108:111]
    s_waitcnt lgkmcnt(9)
    v_mfma_f32_16x16x32_bf16 a[112:115], v[84:87], v[176:179], a[112:115]
    ds_read_b128 v[44:47], v4 offset:7168
    v_mfma_f32_16x16x32_bf16 a[116:119], v[84:87], v[180:183], a[116:119]
    v_mfma_f32_16x16x32_bf16 a[120:123], v[84:87], v[184:187], a[120:123]
    v_mfma_f32_16x16x32_bf16 a[124:127], v[84:87], v[188:191], a[124:127]
    s_waitcnt lgkmcnt(9)
    v_mfma_f32_16x16x32_bf16 a[128:131], v[88:91], v[176:179], a[128:131]
    ds_read_b128 v[48:51], v4 offset:8192
    v_mfma_f32_16x16x32_bf16 a[132:135], v[88:91], v[180:183], a[132:135]
    buffer_load_dwordx4 v[156:159], v1, s[4:7], s45 offen offset:1024 sc1
    s_add_u32 s45, s45, 2048
    s_cmp_ge_u32 s42, s49
    s_cselect_b32 s42, 0x7f000000, s42
    s_cselect_b32 s43, 0x7f000000, s43
    s_cselect_b32 s44, 0x7f000000, s44
    s_cselect_b32 s45, 0x7f000000, s45
    v_mfma_f32_16x16x32_bf16 a[136:139], v[88:91], v[184:187], a[136:139]
    v_mfma_f32_16x16x32_bf16 a[140:143], v[88:91], v[188:191], a[140:143]
    s_waitcnt lgkmcnt(9)
    v_mfma_f32_16x16x32_bf16 a[144:147], v[92:95], v[176:179], a[144:147]
    ds_read_b128 v[52:55], v4 offset:9216
    v_mfma_f32_16x16x32_bf16 a[148:151], v[92:95], v[180:183], a[148:151]
    v_mfma_f32_16x16x32_bf16 a[152:155], v[92:95], v[184:187], a[152:155]
    v_mfma_f32_16x16x32_bf16 a[156:159], v[92:95], v[188:191], a[156:159]
    v_mov_b32 v3, v4
    v_add_u32 v4, 20480, v4
    v_subrev_u32 v6, 122880, v4
    v_min_u32 v4, v4, v6
    s_waitcnt vmcnt(26)
    s_waitcnt lgkmcnt(9)
    v_mfma_f32_16x16x32_bf16 a[0:3], v[16:19], v[192:195], a[0:3]
    ds_read_b128 v[56:59], v3 offset:10240
    v_mfma_f32_16x16x32_bf16 a[4:7], v[16:19], v[196:199], a[4:7]
    s_mov_b32 m0, s35
    s_nop 0
    buffer_load_dwordx4 v1, s[4:7], s34 offen offset:0 sc1 lds
    v_mfma_f32_16x16x32_bf16 a[8:11], v[16:19], v[200:203], a[8:11]
    v_mfma_f32_16x16x32_bf16 a[12:15], v[16:19], v[204:207], a[12:15]
    s_waitcnt lgkmcnt(9)
    v_mfma_f32_16x16x32_bf16 a[16:19], v[20:23], v[192:195], a[16:19]
    ds_read_b128 v[60:63], v3 offset:11264
    v_mfma_f32_16x16x32_bf16 a[20:23], v[20:23], v[196:199], a[20:23]
    buffer_load_dwordx4 v1, s[4:7], s34 offen offset:1024 sc1 lds
    v_mfma_f32_16x16x32_bf16 a[24:27], v[20:23], v[200:203], a[24:27]
    v_mfma_f32_16x16x32_bf16 a[28:31], v[20:23], v[204:207], a[28:31]
    s_waitcnt lgkmcnt(9)
    v_mfma_f32_16x16x32_bf16 a[32:35], v[24:27], v[192:195], a[32:35]
    ds_read_b128 v[64:67], v3 offset:12288
    v_mfma_f32_16x16x32_bf16 a[36:39], v[24:27], v[196:199], a[36:39]
    v_mfma_f32_16x16x32_bf16 a[40:43], v[24:27], v[200:203], a[40:43]
    v_mfma_f32_16x16x32_bf16 a[44:47], v[24:27], v[204:207], a[44:47]
    s_waitcnt lgkmcnt(9)
    v_mfma_f32_16x16x32_bf16 a[48:51], v[28:31], v[192:195], a[48:51]
    ds_read_b128 v[68:71], v3 offset:13312
    v_mfma_f32_16x16x32_bf16 a[52:55], v[28:31], v[196:199], a[52:55]
    buffer_load_dwordx4 v1, s[4:7], s34 offen offset:2048 sc1 lds
    v_mfma_f32_16x16x32_bf16 a[56:59], v[28:31], v[200:203], a[56:59]
    v_mfma_f32_16x16x32_bf16 a[60:63], v[28:31], v[204:207], a[60:63]
    s_waitcnt lgkmcnt(9)
    v_mfma_f32_16x16x32_bf16 a[64:67], v[32:35], v[192:195], a[64:67]
    ds_read_b128 v[72:75], v3 offset:14336
    v_mfma_f32_16x16x32_bf16 a[68:71], v[32:35], v[196:199], a[68:71]
    buffer_load_dwordx4 v1, s[4:7], s34 offen offset:3072 sc1 lds
    v_mfma_f32_16x16x32_bf16 a[72:75], v[32:35], v[200:203], a[72:75]
    v_mfma_f32_16x16x32_bf16 a[76:79], v[32:35], v[204:207], a[76:79]
    s_waitcnt lgkmcnt(9)
    v_mfma_f32_16x16x32_bf16 a[80:83], v[36:39], v[192:195], a[80:83]
    ds_read_b128 v[76:79], v3 offset:15360
    v_mfma_f32_16x16x32_bf16 a[84:87], v[36:39], v[196:199], a[84:87]
    v_mfma_f32_16x16x32_bf16 a[88:91], v[36:39], v[200:203], a[88:91]
    v_mfma_f32_16x16x32_bf16 a[92:95], v[36:39], v[204:207], a[92:95]
    s_waitcnt lgkmcnt(9)
    v_mfma_f32_16x16x32_bf16 a[96:99], v[40:43], v[192:195], a[96:99]
    ds_read_b128 v[80:83], v3 offset:16384
    v_mfma_f32_16x16x32_bf16 a[100:103], v[40:43], v[196:199], a[100:103]
    s_add_u32 m0, s35, 4096
    s_add_u32 s29, s34, 4096
    buffer_load_dwordx4 v1, s[4:7], s29 offen offset:0 sc1 lds
    s_add_u32 s34, s34, 81920
    s_add_u32 s35, s35, 20480
    s_add_u32 s29, s41, 122880
    s_cmp_ge_u32 s35, s29
    s_cselect_b32 s35, s41, s35
    s_cmp_ge_u32 s34, s48
    s_cselect_b32 s34, 0x7f000000, s34
    v_mfma_f32_16x16x32_bf16 a[104:107], v[40:43], v[200:203], a[104:107]
    v_mfma_f32_16x16x32_bf16 a[108:111], v[40:43], v[204:207], a[108:111]
    s_waitcnt lgkmcnt(9)
    v_mfma_f32_16x16x32_bf16 a[112:115], v[44:47], v[192:195], a[112:115]
    ds_read_b128 v[84:87], v3 offset:17408
    v_mfma_f32_16x16x32_bf16 a[116:119], v[44:47], v[196:199], a[116:119]
    buffer_load_dwordx4 v[160:163], v1, s[4:7], s42 offen offset:0 sc1
    v_mfma_f32_16x16x32_bf16 a[120:123], v[44:47], v[200:203], a[120:123]
    v_mfma_f32_16x16x32_bf16 a[124:127], v[44:47], v[204:207], a[124:127]
    s_waitcnt lgkmcnt(9)
    v_mfma_f32_16x16x32_bf16 a[128:131], v[48:51], v[192:195], a[128:131]
    ds_read_b128 v[88:91], v3 offset:18432
    v_mfma_f32_16x16x32_bf16 a[132:135], v[48:51], v[196:199], a[132:135]
    v_mfma_f32_16x16x32_bf16 a[136:139], v[48:51], v[200:203], a[136:139]
    v_mfma_f32_16x16x32_bf16 a[140:143], v[48:51], v[204:207], a[140:143]
    s_waitcnt lgkmcnt(9)
    v_mfma_f32_16x16x32_bf16 a[144:147], v[52:55], v[192:195], a[144:147]
    ds_read_b128 v[92:95], v3 offset:19456
    v_mfma_f32_16x16x32_bf16 a[148:151], v[52:55], v[196:199], a[148:151]
    buffer_load_dwordx4 v[176:179], v1, s[4:7], s42 offen offset:1024 sc1
    s_add_u32 s42, s42, 2048
    v_mfma_f32_16x16x32_bf16 a[152:155], v[52:55], v[200:203], a[152:155]
    v_mfma_f32_16x16x32_bf16 a[156:159], v[52:55], v[204:207], a[156:159]
    s_waitcnt vmcnt(41)
    s_barrier
    s_waitcnt lgkmcnt(9)
    v_mfma_f32_16x16x32_bf16 a[0:3], v[56:59], v[208:211], a[0:3]
    ds_read_b128 v[16:19], v4 offset:0
    v_mfma_f32_16x16x32_bf16 a[4:7], v[56:59], v[212:215], a[4:7]
    buffer_load_dwordx4 v[164:167], v1, s[4:7], s43 offen offset:0 sc1
    v_mfma_f32_16x16x32_bf16 a[8:11], v[56:59], v[216:219], a[8:11]
    v_mfma_f32_16x16x32_bf16 a[12:15], v[56:59], v[220:223], a[12:15]
    s_waitcnt lgkmcnt(9)
    v_mfma_f32_16x16x32_bf16 a[16:19], v[60:63], v[208:211], a[16:19]
    ds_read_b128 v[20:23], v4 offset:1024
    v_mfma_f32_16x16x32_bf16 a[20:23], v[60:63], v[212:215], a[20:23]
    v_mfma_f32_16x16x32_bf16 a[24:27], v[60:63], v[216:219], a[24:27]
    v_mfma_f32_16x16x32_bf16 a[28:31], v[60:63], v[220:223], a[28:31]
    s_waitcnt lgkmcnt(9)
    v_mfma_f32_16x16x32_bf16 a[32:35], v[64:67], v[208:211], a[32:35]
    ds_read_b128 v[24:27], v4 offset:2048
    v_mfma_f32_16x16x32_bf16 a[36:39], v[64:67], v[212:215], a[36:39]
    buffer_load_dwordx4 v[180:183], v1, s[4:7], s43 offen offset:1024 sc1
    s_add_u32 s43, s43, 2048
    v_mfma_f32_16x16x32_bf16 a[40:43], v[64:67], v[216:219], a[40:43]
    v_mfma_f32_16x16x32_bf16 a[44:47], v[64:67], v[220:223], a[44:47]
    s_waitcnt lgkmcnt(9)
    v_mfma_f32_16x16x32_bf16 a[48:51], v[68:71], v[208:211], a[48:51]
    ds_read_b128 v[28:31], v4 offset:3072
    v_mfma_f32_16x16x32_bf16 a[52:55], v[68:71], v[212:215], a[52:55]
    buffer_load_dwordx4 v[168:171], v1, s[4:7], s44 offen offset:0 sc1
    v_mfma_f32_16x16x32_bf16 a[56:59], v[68:71], v[216:219], a[56:59]
    v_mfma_f32_16x16x32_bf16 a[60:63], v[68:71], v[220:223], a[60:63]
    s_waitcnt lgkmcnt(9)
    v_mfma_f32_16x16x32_bf16 a[64:67], v[72:75], v[208:211], a[64:67]
    ds_read_b128 v[32:35], v4 offset:4096
    v_mfma_f32_16x16x32_bf16 a[68:71], v[72:75], v[212:215], a[68:71]
    v_mfma_f32_16x16x32_bf16 a[72:75], v[72:75], v[216:219], a[72:75]
    v_mfma_f32_16x16x32_bf16 a[76:79], v[72:75], v[220:223], a[76:79]
    s_waitcnt lgkmcnt(9)
    v_mfma_f32_16x16x32_bf16 a[80:83], v[76:79], v[208:211], a[80:83]
    ds_read_b128 v[36:39], v4 offset:5120
    v_mfma_f32_16x16x32_bf16 a[84:87], v[76:79], v[212:215], a[84:87]
    buffer_load_dwordx4 v[184:187], v1, s[4:7], s44 offen offset:1024 sc1
    s_add_u32 s44, s44, 2048
    v_mfma_f32_16x16x32_bf16 a[88:91], v[76:79], v[216:219], a[88:91]
    v_mfma_f32_16x16x32_bf16 a[92:95], v[76:79], v[220:223], a[92:95]
    s_waitcnt lgkmcnt(9)
    v_mfma_f32_16x16x32_bf16 a[96:99], v[80:83], v[208:211], a[96:99]
    ds_read_b128 v[40:43], v4 offset:6144
    v_mfma_f32_16x16x32_bf16 a[100:103], v[80:83], v[212:215], a[100:103]
    buffer_load_dwordx4 v[172:175], v1, s[4:7], s45 offen offset:0 sc1
    v_mfma_f32_16x16x32_bf16 a[104:107], v[80:83], v[216:219], a[104:107]
    v_mfma_f32_16x16x32_bf16 a[108:111], v[80:83], v[220:223], a[108:111]
    s_waitcnt lgkmcnt(9)
    v_mfma_f32_16x16x32_bf16 a[112:115], v[84:87], v[208:211], a[112:115]
    ds_read_b128 v[44:47], v4 offset:7168
    v_mfma_f32_16x16x32_bf16 a[116:119], v[84:87], v[212:215], a[116:119]
    v_mfma_f32_16x16x32_bf16 a[120:123], v[84:87], v[216:219], a[120:123]
    v_mfma_f32_16x16x32_bf16 a[124:127], v[84:87], v[220:223], a[124:127]
    s_waitcnt lgkmcnt(9)
    v_mfma_f32_16x16x32_bf16 a[128:131], v[88:91], v[208:211], a[128:131]
    ds_read_b128 v[48:51], v4 offset:8192
    v_mfma_f32_16x16x32_bf16 a[132:135], v[88:91], v[212:215], a[132:135]
    buffer_load_dwordx4 v[188:191], v1, s[4:7], s45 offen offset:1024 sc1
    s_add_u32 s45, s45, 2048
    s_cmp_ge_u32 s42, s49
    s_cselect_b32 s42, 0x7f000000, s42
    s_cselect_b32 s43, 0x7f000000, s43
    s_cselect_b32 s44, 0x7f000000, s44
    s_cselect_b32 s45, 0x7f000000, s45
    v_mfma_f32_16x16x32_bf16 a[136:139], v[88:91], v[216:219], a[136:139]
    v_mfma_f32_16x16x32_bf16 a[140:143], v[88:91], v[220:223], a[140:143]
    s_waitcnt lgkmcnt(9)
    v_mfma_f32_16x16x32_bf16 a[144:147], v[92:95], v[208:211], a[144:147]
    ds_read_b128 v[52:55], v4 offset:9216
    v_mfma_f32_16x16x32_bf16 a[148:151], v[92:95], v[212:215], a[148:151]
    v_mfma_f32_16x16x32_bf16 a[152:155], v[92:95], v[216:219], a[152:155]
    v_mfma_f32_16x16x32_bf16 a[156:159], v[92:95], v[220:223], a[156:159]
    v_mov_b32 v3, v4
    v_add_u32 v4, 20480, v4
    v_subrev_u32 v6, 122880, v4
    v_min_u32 v4, v4, v6
    s_sub_u32 s24, s24, 1
    s_cmp_lg_u32 s24, 0
    s_cbranch_scc1 L_op4_loop
    s_nop 7
    s_mov_b32 s30, s46
    s_mul_i32 s29, s22, 163840
    s_add_u32 s30, s30, s29
    s_mul_i32 s29, s16, 40960
    s_add_u32 s30, s30, s29
    s_add_u32 s31, s50, 3
    s_and_b32 s31, s31, 3
    s_mul_i32 s31, s31, 10240
    s_add_u32 s31, s31, s30
    s_add_u32 s29, s31, 0
    buffer_store_dwordx4 a[12:15], v1, s[4:7], s29 offen offset:0 sc1
    buffer_store_dwordx4 a[28:31], v1, s[4:7], s29 offen offset:1024 sc1
    buffer_store_dwordx4 a[44:47], v1, s[4:7], s29 offen offset:2048 sc1
    buffer_store_dwordx4 a[60:63], v1, s[4:7], s29 offen offset:3072 sc1
    s_add_u32 s29, s31, 4096
    buffer_store_dwordx4 a[76:79], v1, s[4:7], s29 offen offset:0 sc1
    buffer_store_dwordx4 a[92:95], v1, s[4:7], s29 offen offset:1024 sc1
    buffer_store_dwordx4 a[108:111], v1, s[4:7], s29 offen offset:2048 sc1
    buffer_store_dwordx4 a[124:127], v1, s[4:7], s29 offen offset:3072 sc1
    s_add_u32 s29, s31, 8192
    buffer_store_dwordx4 a[140:143], v1, s[4:7], s29 offen offset:0 sc1
    buffer_store_dwordx4 a[156:159], v1, s[4:7], s29 offen offset:1024 sc1
    s_add_u32 s31, s50, 2
    s_and_b32 s31, s31, 3
    s_mul_i32 s31, s31, 10240
    s_add_u32 s31, s31, s30
    s_add_u32 s29, s31, 0
    buffer_store_dwordx4 a[8:11], v1, s[4:7], s29 offen offset:0 sc1
    buffer_store_dwordx4 a[24:27], v1, s[4:7], s29 offen offset:1024 sc1
    buffer_store_dwordx4 a[40:43], v1, s[4:7], s29 offen offset:2048 sc1
    buffer_store_dwordx4 a[56:59], v1, s[4:7], s29 offen offset:3072 sc1
    s_add_u32 s29, s31, 4096
    buffer_store_dwordx4 a[72:75], v1, s[4:7], s29 offen offset:0 sc1
    buffer_store_dwordx4 a[88:91], v1, s[4:7], s29 offen offset:1024 sc1
    buffer_store_dwordx4 a[104:107], v1, s[4:7], s29 offen offset:2048 sc1
    buffer_store_dwordx4 a[120:123], v1, s[4:7], s29 offen offset:3072 sc1
    s_add_u32 s29, s31, 8192
    buffer_store_dwordx4 a[136:139], v1, s[4:7], s29 offen offset:0 sc1
    buffer_store_dwordx4 a[152:155], v1, s[4:7], s29 offen offset:1024 sc1
    s_cmp_eq_u32 s23, 2
    s_cbranch_scc1 L_op4_pub
    s_add_u32 s31, s50, 1
    s_and_b32 s31, s31, 3
    s_mul_i32 s31, s31, 10240
    s_add_u32 s31, s31, s30
    s_add_u32 s29, s31, 0
    buffer_store_dwordx4 a[4:7], v1, s[4:7], s29 offen offset:0 sc1
    buffer_store_dwordx4 a[20:23], v1, s[4:7], s29 offen offset:1024 sc1
    buffer_store_dwordx4 a[36:39], v1, s[4:7], s29 offen offset:2048 sc1
    buffer_store_dwordx4 a[52:55], v1, s[4:7], s29 offen offset:3072 sc1
    s_add_u32 s29, s31, 4096
    buffer_store_dwordx4 a[68:71], v1, s[4:7], s29 offen offset:0 sc1
    buffer_store_dwordx4 a[84:87], v1, s[4:7], s29 offen offset:1024 sc1
    buffer_store_dwordx4 a[100:103], v1, s[4:7], s29 offen offset:2048 sc1
    buffer_store_dwordx4 a[116:119], v1, s[4:7], s29 offen offset:3072 sc1
    s_add_u32 s29, s31, 8192
    buffer_store_dwordx4 a[132:135], v1, s[4:7], s29 offen offset:0 sc1
    buffer_store_dwordx4 a[148:151], v1, s[4:7], s29 offen offset:1024 sc1
L_op4_pub:
    s_waitcnt vmcnt(0)
    s_barrier
    s_mul_i32 s31, s47, 128
    s_add_u32 s31, s31, 184500224
    s_cmp_lg_u32 s16, 0
    s_cbranch_scc1 L_98
    v_mov_b32 v6, 1
    s_mov_b64 exec, 1
    buffer_atomic_add v6, v2, s[4:7], s31 offen
    s_mov_b64 exec, -1
L_98:
    v_accvgpr_read_b32 v96, a0
    v_accvgpr_read_b32 v97, a1
    v_accvgpr_read_b32 v98, a2
    v_accvgpr_read_b32 v99, a3
    v_accvgpr_read_b32 v100, a16
    v_accvgpr_read_b32 v101, a17
    v_accvgpr_read_b32 v102, a18
    v_accvgpr_read_b32 v103, a19
    v_accvgpr_read_b32 v104, a32
    v_accvgpr_read_b32 v105, a33
    v_accvgpr_read_b32 v106, a34
    v_accvgpr_read_b32 v107, a35
    v_accvgpr_read_b32 v108, a48
    v_accvgpr_read_b32 v109, a49
    v_accvgpr_read_b32 v110, a50
    v_accvgpr_read_b32 v111, a51
    v_accvgpr_read_b32 v112, a64
    v_accvgpr_read_b32 v113, a65
    v_accvgpr_read_b32 v114, a66
    v_accvgpr_read_b32 v115, a67
    v_accvgpr_read_b32 v116, a80
    v_accvgpr_read_b32 v117, a81
    v_accvgpr_read_b32 v118, a82
    v_accvgpr_read_b32 v119, a83
    v_accvgpr_read_b32 v120, a96
    v_accvgpr_read_b32 v121, a97
    v_accvgpr_read_b32 v122, a98
    v_accvgpr_read_b32 v123, a99
    v_accvgpr_read_b32 v124, a112
    v_accvgpr_read_b32 v125, a113
    v_accvgpr_read_b32 v126, a114
    v_accvgpr_read_b32 v127, a115
    v_accvgpr_read_b32 v128, a128
    v_accvgpr_read_b32 v129, a129
    v_accvgpr_read_b32 v130, a130
    v_accvgpr_read_b32 v131, a131
    v_accvgpr_read_b32 v132, a144
    v_accvgpr_read_b32 v133, a145
    v_accvgpr_read_b32 v134, a146
    v_accvgpr_read_b32 v135, a147
    v_accvgpr_read_b32 v136, a4
    v_accvgpr_read_b32 v137, a5
    v_accvgpr_read_b32 v138, a6
    v_accvgpr_read_b32 v139, a7
    v_accvgpr_read_b32 v140, a20
    v_accvgpr_read_b32 v141, a21
    v_accvgpr_read_b32 v142, a22
    v_accvgpr_read_b32 v143, a23
    v_accvgpr_read_b32 v144, a36
    v_accvgpr_read_b32 v145, a37
    v_accvgpr_read_b32 v146, a38
    v_accvgpr_read_b32 v147, a39
    v_accvgpr_read_b32 v148, a52
    v_accvgpr_read_b32 v149, a53
    v_accvgpr_read_b32 v150, a54
    v_accvgpr_read_b32 v151, a55
    v_accvgpr_read_b32 v152, a68
    v_accvgpr_read_b32 v153, a69
    v_accvgpr_read_b32 v154, a70
    v_accvgpr_read_b32 v155, a71
    v_accvgpr_read_b32 v156, a84
    v_accvgpr_read_b32 v157, a85
    v_accvgpr_read_b32 v158, a86
    v_accvgpr_read_b32 v159, a87
    v_accvgpr_read_b32 v160, a100
    v_accvgpr_read_b32 v161, a101
    v_accvgpr_read_b32 v162, a102
    v_accvgpr_read_b32 v163, a103
    v_accvgpr_read_b32 v164, a116
    v_accvgpr_read_b32 v165, a117
    v_accvgpr_read_b32 v166, a118
    v_accvgpr_read_b32 v167, a119
    v_accvgpr_read_b32 v168, a132
    v_accvgpr_read_b32 v169, a133
    v_accvgpr_read_b32 v170, a134
    v_accvgpr_read_b32 v171, a135
    v_accvgpr_read_b32 v172, a148
    v_accvgpr_read_b32 v173, a149
    v_accvgpr_read_b32 v174, a150
    v_accvgpr_read_b32 v175, a151
    s_cmp_lg_u32 s16, 0
    s_cbranch_scc1 L_100
L_99:
    buffer_load_dword v6, v2, s[4:7], s31 offen offset:0 sc1
    s_waitcnt vmcnt(0)
    v_cmp_gt_u32 vcc, s23, v6
    s_cbranch_vccz L_100
    s_sleep 4
    s_branch L_spin_101
L_100:
    s_barrier
    s_cmp_eq_u32 s23, 2
    s_cbranch_scc1 L_op4_s2
    s_add_u32 s30, s22, 1
    s_sub_u32 s29, s23, 1
    s_and_b32 s30, s30, s29
    s_add_u32 s31, s50, 0
    s_and_b32 s31, s31, 3
    s_mul_i32 s30, s30, 163840
    s_add_u32 s30, s30, s46
    s_mul_i32 s29, s16, 40960
    s_add_u32 s30, s30, s29
    s_mul_i32 s29, s31, 10240
    s_add_u32 s30, s30, s29
    s_add_u32 s29, s30, 0
    buffer_load_dwordx4 v[16:19], v1, s[4:7], s29 offen offset:0 sc1
    buffer_load_dwordx4 v[20:23], v1, s[4:7], s29 offen offset:1024 sc1
    buffer_load_dwordx4 v[24:27], v1, s[4:7], s29 offen offset:2048 sc1
    buffer_load_dwordx4 v[28:31], v1, s[4:7], s29 offen offset:3072 sc1
    s_add_u32 s29, s30, 4096
    buffer_load_dwordx4 v[32:35], v1, s[4:7], s29 offen offset:0 sc1
    buffer_load_dwordx4 v[36:39], v1, s[4:7], s29 offen offset:1024 sc1
    buffer_load_dwordx4 v[40:43], v1, s[4:7], s29 offen offset:2048 sc1
    buffer_load_dwordx4 v[44:47], v1, s[4:7], s29 offen offset:3072 sc1
    s_add_u32 s29, s30, 8192
    buffer_load_dwordx4 v[48:51], v1, s[4:7], s29 offen offset:0 sc1
    buffer_load_dwordx4 v[52:55], v1, s[4:7], s29 offen offset:1024 sc1
    s_add_u32 s30, s22, 2
    s_sub_u32 s29, s23, 1
    s_and_b32 s30, s30, s29
    s_add_u32 s31, s50, 0
    s_and_b32 s31, s31, 3
    s_mul_i32 s30, s30, 163840
    s_add_u32 s30, s30, s46
    s_mul_i32 s29, s16, 40960
    s_add_u32 s30, s30, s29
    s_mul_i32 s29, s31, 10240
    s_add_u32 s30, s30, s29
    s_add_u32 s29, s30, 0
    buffer_load_dwordx4 v[56:59], v1, s[4:7], s29 offen offset:0 sc1
    buffer_load_dwordx4 v[60:63], v1, s[4:7], s29 offen offset:1024 sc1
    buffer_load_dwordx4 v[64:67], v1, s[4:7], s29 offen offset:2048 sc1
    buffer_load_dwordx4 v[68:71], v1, s[4:7], s29 offen offset:3072 sc1
    s_add_u32 s29, s30, 4096
    buffer_load_dwordx4 v[72:75], v1, s[4:7], s29 offen offset:0 sc1
    buffer_load_dwordx4 v[76:79], v1, s[4:7], s29 offen offset:1024 sc1
    buffer_load_dwordx4 v[80:83], v1, s[4:7], s29 offen offset:2048 sc1
    buffer_load_dwordx4 v[84:87], v1, s[4:7], s29 offen offset:3072 sc1
    s_add_u32 s29, s30, 8192
    buffer_load_dwordx4 v[88:91], v1, s[4:7], s29 offen offset:0 sc1
    buffer_load_dwordx4 v[92:95], v1, s[4:7], s29 offen offset:1024 sc1
    s_add_u32 s30, s22, 3
    s_sub_u32 s29, s23, 1
    s_and_b32 s30, s30, s29
    s_add_u32 s31, s50, 0
    s_and_b32 s31, s31, 3
    s_mul_i32 s30, s30, 163840
    s_add_u32 s30, s30, s46
    s_mul_i32 s29, s16, 40960
    s_add_u32 s30, s30, s29
    s_mul_i32 s29, s31, 10240
    s_add_u32 s30, s30, s29
    s_add_u32 s29, s30, 0
    buffer_load_dwordx4 v[176:179], v1, s[4:7], s29 offen offset:0 sc1
    buffer_load_dwordx4 v[180:183], v1, s[4:7], s29 offen offset:1024 sc1
    buffer_load_dwordx4 v[184:187], v1, s[4:7], s29 offen offset:2048 sc1
    buffer_load_dwordx4 v[188:191], v1, s[4:7], s29 offen offset:3072 sc1
    s_add_u32 s29, s30, 4096
    buffer_load_dwordx4 v[192:195], v1, s[4:7], s29 offen offset:0 sc1
    buffer_load_dwordx4 v[196:199], v1, s[4:7], s29 offen offset:1024 sc1
    buffer_load_dwordx4 v[200:203], v1, s[4:7], s29 offen offset:2048 sc1
    buffer_load_dwordx4 v[204:207], v1, s[4:7], s29 offen offset:3072 sc1
    s_add_u32 s29, s30, 8192
    buffer_load_dwordx4 v[208:211], v1, s[4:7], s29 offen offset:0 sc1
    buffer_load_dwordx4 v[212:215], v1, s[4:7], s29 offen offset:1024 sc1
    s_waitcnt vmcnt(29)
    v_pk_add_f32 v[96:97], v[96:97], v[16:17]
    v_pk_add_f32 v[98:99], v[98:99], v[18:19]
    s_waitcnt vmcnt(28)
    v_pk_add_f32 v[100:101], v[100:101], v[20:21]
    v_pk_add_f32 v[102:103], v[102:103], v[22:23]
    s_waitcnt vmcnt(27)
    v_pk_add_f32 v[104:105], v[104:105], v[24:25]
    v_pk_add_f32 v[106:107], v[106:107], v[26:27]
    s_waitcnt vmcnt(26)
    v_pk_add_f32 v[108:109], v[108:109], v[28:29]
    v_pk_add_f32 v[110:111], v[110:111], v[30:31]
    s_waitcnt vmcnt(25)
    v_pk_add_f32 v[112:113], v[112:113], v[32:33]
    v_pk_add_f32 v[114:115], v[114:115], v[34:35]
    s_waitcnt vmcnt(24)
    v_pk_add_f32 v[116:117], v[116:117], v[36:37]
    v_pk_add_f32 v[118:119], v[118:119], v[38:39]
    s_waitcnt vmcnt(23)
    v_pk_add_f32 v[120:121], v[120:121], v[40:41]
    v_pk_add_f32 v[122:123], v[122:123], v[42:43]
    s_waitcnt vmcnt(22)
    v_pk_add_f32 v[124:125], v[124:125], v[44:45]
    v_pk_add_f32 v[126:127], v[126:127], v[46:47]
    s_waitcnt vmcnt(21)
    v_pk_add_f32 v[128:129], v[128:129], v[48:49]
    v_pk_add_f32 v[130:131], v[130:131], v[50:51]
    s_waitcnt vmcnt(20)
    v_pk_add_f32 v[132:133], v[132:133], v[52:53]
    v_pk_add_f32 v[134:135], v[134:135], v[54:55]
    s_waitcnt vmcnt(19)
    v_pk_add_f32 v[96:97], v[96:97], v[56:57]
    v_pk_add_f32 v[98:99], v[98:99], v[58:59]
    s_waitcnt vmcnt(18)
    v_pk_add_f32 v[100:101], v[100:101], v[60:61]
    v_pk_add_f32 v[102:103], v[102:103], v[62:63]
    s_waitcnt vmcnt(17)
    v_pk_add_f32 v[104:105], v[104:105], v[64:65]
    v_pk_add_f32 v[106:107], v[106:107], v[66:67]
    s_waitcnt vmcnt(16)
    v_pk_add_f32 v[108:109], v[108:109], v[68:69]
    v_pk_add_f32 v[110:111], v[110:111], v[70:71]
    s_waitcnt vmcnt(15)
    v_pk_add_f32 v[112:113], v[112:113], v[72:73]
    v_pk_add_f32 v[114:115], v[114:115], v[74:75]
    s_waitcnt vmcnt(14)
    v_pk_add_f32 v[116:117], v[116:117], v[76:77]
    v_pk_add_f32 v[118:119], v[118:119], v[78:79]
    s_waitcnt vmcnt(13)
    v_pk_add_f32 v[120:121], v[120:121], v[80:81]
    v_pk_add_f32 v[122:123], v[122:123], v[82:83]
    s_waitcnt vmcnt(12)
    v_pk_add_f32 v[124:125], v[124:125], v[84:85]
    v_pk_add_f32 v[126:127], v[126:127], v[86:87]
    s_waitcnt vmcnt(11)
    v_pk_add_f32 v[128:129], v[128:129], v[88:89]
    v_pk_add_f32 v[130:131], v[130:131], v[90:91]
    s_waitcnt vmcnt(10)
    v_pk_add_f32 v[132:133], v[132:133], v[92:93]
    v_pk_add_f32 v[134:135], v[134:135], v[94:95]
    s_waitcnt vmcnt(9)
    v_pk_add_f32 v[96:97], v[96:97], v[176:177]
    v_pk_add_f32 v[98:99], v[98:99], v[178:179]
    s_waitcnt vmcnt(8)
    v_pk_add_f32 v[100:101], v[100:101], v[180:181]
    v_pk_add_f32 v[102:103], v[102:103], v[182:183]
    s_waitcnt vmcnt(7)
    v_pk_add_f32 v[104:105], v[104:105], v[184:185]
    v_pk_add_f32 v[106:107], v[106:107], v[186:187]
    s_waitcnt vmcnt(6)
    v_pk_add_f32 v[108:109], v[108:109], v[188:189]
    v_pk_add_f32 v[110:111], v[110:111], v[190:191]
    s_waitcnt vmcnt(5)
    v_pk_add_f32 v[112:113], v[112:113], v[192:193]
    v_pk_add_f32 v[114:115], v[114:115], v[194:195]
    s_waitcnt vmcnt(4)
    v_pk_add_f32 v[116:117], v[116:117], v[196:197]
    v_pk_add_f32 v[118:119], v[118:119], v[198:199]
    s_waitcnt vmcnt(3)
    v_pk_add_f32 v[120:121], v[120:121], v[200:201]
    v_pk_add_f32 v[122:123], v[122:123], v[202:203]
    s_waitcnt vmcnt(2)
    v_pk_add_f32 v[124:125], v[124:125], v[204:205]
    v_pk_add_f32 v[126:127], v[126:127], v[206:207]
    s_waitcnt vmcnt(1)
    v_pk_add_f32 v[128:129], v[128:129], v[208:209]
    v_pk_add_f32 v[130:131], v[130:131], v[210:211]
    s_waitcnt vmcnt(0)
    v_pk_add_f32 v[132:133], v[132:133], v[212:213]
    v_pk_add_f32 v[134:135], v[134:135], v[214:215]
    s_add_u32 s31, s50, 0
    s_and_b32 s31, s31, 3
    s_mul_i32 s30, s20, 327680
    s_mul_i32 s29, s16, 163840
    s_add_u32 s30, s30, s29
    s_mul_i32 s29, s31, 40960
    s_add_u32 s30, s30, s29
    s_mul_i32 s29, s17, 1280
    s_add_u32 s30, s30, s29
    s_mul_i32 s29, s21, 320
    s_add_u32 s30, s30, s29
    v_cvt_pk_bf16_f32 v8, v96, v97
    v_cvt_pk_bf16_f32 v9, v98, v99
    v_cvt_pk_bf16_f32 v10, v100, v101
    v_cvt_pk_bf16_f32 v11, v102, v103
    s_nop 1
    v_permlane16_swap_b32 v8, v10
    v_permlane16_swap_b32 v9, v11
    buffer_store_dwordx4 v[8:11], v5, s[8:11], s30 offen offset:0
    v_cvt_pk_bf16_f32 v12, v104, v105
    v_cvt_pk_bf16_f32 v13, v106, v107
    v_cvt_pk_bf16_f32 v14, v108, v109
    v_cvt_pk_bf16_f32 v15, v110, v111
    s_nop 1
    v_permlane16_swap_b32 v12, v14
    v_permlane16_swap_b32 v13, v15
    buffer_store_dwordx4 v[12:15], v5, s[8:11], s30 offen offset:64
    v_cvt_pk_bf16_f32 v8, v112, v113
    v_cvt_pk_bf16_f32 v9, v114, v115
    v_cvt_pk_bf16_f32 v10, v116, v117
    v_cvt_pk_bf16_f32 v11, v118, v119
    s_nop 1
    v_permlane16_swap_b32 v8, v10
    v_permlane16_swap_b32 v9, v11
    buffer_store_dwordx4 v[8:11], v5, s[8:11], s30 offen offset:128
    v_cvt_pk_bf16_f32 v12, v120, v121
    v_cvt_pk_bf16_f32 v13, v122, v123
    v_cvt_pk_bf16_f32 v14, v124, v125
    v_cvt_pk_bf16_f32 v15, v126, v127
    s_nop 1
    v_permlane16_swap_b32 v12, v14
    v_permlane16_swap_b32 v13, v15
    buffer_store_dwordx4 v[12:15], v5, s[8:11], s30 offen offset:192
    v_cvt_pk_bf16_f32 v8, v128, v129
    v_cvt_pk_bf16_f32 v9, v130, v131
    v_cvt_pk_bf16_f32 v10, v132, v133
    v_cvt_pk_bf16_f32 v11, v134, v135
    s_nop 1
    v_permlane16_swap_b32 v8, v10
    v_permlane16_swap_b32 v9, v11
    buffer_store_dwordx4 v[8:11], v5, s[8:11], s30 offen offset:256
    s_branch L_op_next
L_op4_s2:
    s_add_u32 s30, s22, 1
    s_sub_u32 s29, s23, 1
    s_and_b32 s30, s30, s29
    s_add_u32 s31, s50, 0
    s_and_b32 s31, s31, 3
    s_mul_i32 s30, s30, 163840
    s_add_u32 s30, s30, s46
    s_mul_i32 s29, s16, 40960
    s_add_u32 s30, s30, s29
    s_mul_i32 s29, s31, 10240
    s_add_u32 s30, s30, s29
    s_add_u32 s29, s30, 0
    buffer_load_dwordx4 v[16:19], v1, s[4:7], s29 offen offset:0 sc1
    buffer_load_dwordx4 v[20:23], v1, s[4:7], s29 offen offset:1024 sc1
    buffer_load_dwordx4 v[24:27], v1, s[4:7], s29 offen offset:2048 sc1
    buffer_load_dwordx4 v[28:31], v1, s[4:7], s29 offen offset:3072 sc1
    s_add_u32 s29, s30, 4096
    buffer_load_dwordx4 v[32:35], v1, s[4:7], s29 offen offset:0 sc1
    buffer_load_dwordx4 v[36:39], v1, s[4:7], s29 offen offset:1024 sc1
    buffer_load_dwordx4 v[40:43], v1, s[4:7], s29 offen offset:2048 sc1
    buffer_load_dwordx4 v[44:47], v1, s[4:7], s29 offen offset:3072 sc1
    s_add_u32 s29, s30, 8192
    buffer_load_dwordx4 v[48:51], v1, s[4:7], s29 offen offset:0 sc1
    buffer_load_dwordx4 v[52:55], v1, s[4:7], s29 offen offset:1024 sc1
    s_add_u32 s30, s22, 1
    s_sub_u32 s29, s23, 1
    s_and_b32 s30, s30, s29
    s_add_u32 s31, s50, 1
    s_and_b32 s31, s31, 3
    s_mul_i32 s30, s30, 163840
    s_add_u32 s30, s30, s46
    s_mul_i32 s29, s16, 40960
    s_add_u32 s30, s30, s29
    s_mul_i32 s29, s31, 10240
    s_add_u32 s30, s30, s29
    s_add_u32 s29, s30, 0
    buffer_load_dwordx4 v[56:59], v1, s[4:7], s29 offen offset:0 sc1
    buffer_load_dwordx4 v[60:63], v1, s[4:7], s29 offen offset:1024 sc1
    buffer_load_dwordx4 v[64:67], v1, s[4:7], s29 offen offset:2048 sc1
    buffer_load_dwordx4 v[68:71], v1, s[4:7], s29 offen offset:3072 sc1
    s_add_u32 s29, s30, 4096
    buffer_load_dwordx4 v[72:75], v1, s[4:7], s29 offen offset:0 sc1
    buffer_load_dwordx4 v[76:79], v1, s[4:7], s29 offen offset:1024 sc1
    buffer_load_dwordx4 v[80:83], v1, s[4:7], s29 offen offset:2048 sc1
    buffer_load_dwordx4 v[84:87], v1, s[4:7], s29 offen offset:3072 sc1
    s_add_u32 s29, s30, 8192
    buffer_load_dwordx4 v[88:91], v1, s[4:7], s29 offen offset:0 sc1
    buffer_load_dwordx4 v[92:95], v1, s[4:7], s29 offen offset:1024 sc1
    s_waitcnt vmcnt(19)
    v_pk_add_f32 v[96:97], v[96:97], v[16:17]
    v_pk_add_f32 v[98:99], v[98:99], v[18:19]
    s_waitcnt vmcnt(18)
    v_pk_add_f32 v[100:101], v[100:101], v[20:21]
    v_pk_add_f32 v[102:103], v[102:103], v[22:23]
    s_waitcnt vmcnt(17)
    v_pk_add_f32 v[104:105], v[104:105], v[24:25]
    v_pk_add_f32 v[106:107], v[106:107], v[26:27]
    s_waitcnt vmcnt(16)
    v_pk_add_f32 v[108:109], v[108:109], v[28:29]
    v_pk_add_f32 v[110:111], v[110:111], v[30:31]
    s_waitcnt vmcnt(15)
    v_pk_add_f32 v[112:113], v[112:113], v[32:33]
    v_pk_add_f32 v[114:115], v[114:115], v[34:35]
    s_waitcnt vmcnt(14)
    v_pk_add_f32 v[116:117], v[116:117], v[36:37]
    v_pk_add_f32 v[118:119], v[118:119], v[38:39]
    s_waitcnt vmcnt(13)
    v_pk_add_f32 v[120:121], v[120:121], v[40:41]
    v_pk_add_f32 v[122:123], v[122:123], v[42:43]
    s_waitcnt vmcnt(12)
    v_pk_add_f32 v[124:125], v[124:125], v[44:45]
    v_pk_add_f32 v[126:127], v[126:127], v[46:47]
    s_waitcnt vmcnt(11)
    v_pk_add_f32 v[128:129], v[128:129], v[48:49]
    v_pk_add_f32 v[130:131], v[130:131], v[50:51]
    s_waitcnt vmcnt(10)
    v_pk_add_f32 v[132:133], v[132:133], v[52:53]
    v_pk_add_f32 v[134:135], v[134:135], v[54:55]
    s_waitcnt vmcnt(9)
    v_pk_add_f32 v[136:137], v[136:137], v[56:57]
    v_pk_add_f32 v[138:139], v[138:139], v[58:59]
    s_waitcnt vmcnt(8)
    v_pk_add_f32 v[140:141], v[140:141], v[60:61]
    v_pk_add_f32 v[142:143], v[142:143], v[62:63]
    s_waitcnt vmcnt(7)
    v_pk_add_f32 v[144:145], v[144:145], v[64:65]
    v_pk_add_f32 v[146:147], v[146:147], v[66:67]
    s_waitcnt vmcnt(6)
    v_pk_add_f32 v[148:149], v[148:149], v[68:69]
    v_pk_add_f32 v[150:151], v[150:151], v[70:71]
    s_waitcnt vmcnt(5)
    v_pk_add_f32 v[152:153], v[152:153], v[72:73]
    v_pk_add_f32 v[154:155], v[154:155], v[74:75]
    s_waitcnt vmcnt(4)
    v_pk_add_f32 v[156:157], v[156:157], v[76:77]
    v_pk_add_f32 v[158:159], v[158:159], v[78:79]
    s_waitcnt vmcnt(3)
    v_pk_add_f32 v[160:161], v[160:161], v[80:81]
    v_pk_add_f32 v[162:163], v[162:163], v[82:83]
    s_waitcnt vmcnt(2)
    v_pk_add_f32 v[164:165], v[164:165], v[84:85]
    v_pk_add_f32 v[166:167], v[166:167], v[86:87]
    s_waitcnt vmcnt(1)
    v_pk_add_f32 v[168:169], v[168:169], v[88:89]
    v_pk_add_f32 v[170:171], v[170:171], v[90:91]
    s_waitcnt vmcnt(0)
    v_pk_add_f32 v[172:173], v[172:173], v[92:93]
    v_pk_add_f32 v[174:175], v[174:175], v[94:95]
    s_add_u32 s31, s50, 0
    s_and_b32 s31, s31, 3
    s_mul_i32 s30, s20, 327680
    s_mul_i32 s29, s16, 163840
    s_add_u32 s30, s30, s29
    s_mul_i32 s29, s31, 40960
    s_add_u32 s30, s30, s29
    s_mul_i32 s29, s17, 1280
    s_add_u32 s30, s30, s29
    s_mul_i32 s29, s21, 320
    s_add_u32 s30, s30, s29
    v_cvt_pk_bf16_f32 v8, v96, v97
    v_cvt_pk_bf16_f32 v9, v98, v99
    v_cvt_pk_bf16_f32 v10, v100, v101
    v_cvt_pk_bf16_f32 v11, v102, v103
    s_nop 1
    v_permlane16_swap_b32 v8, v10
    v_permlane16_swap_b32 v9, v11
    buffer_store_dwordx4 v[8:11], v5, s[8:11], s30 offen offset:0
    v_cvt_pk_bf16_f32 v12, v104, v105
    v_cvt_pk_bf16_f32 v13, v106, v107
    v_cvt_pk_bf16_f32 v14, v108, v109
    v_cvt_pk_bf16_f32 v15, v110, v111
    s_nop 1
    v_permlane16_swap_b32 v12, v14
    v_permlane16_swap_b32 v13, v15
    buffer_store_dwordx4 v[12:15], v5, s[8:11], s30 offen offset:64
    v_cvt_pk_bf16_f32 v8, v112, v113
    v_cvt_pk_bf16_f32 v9, v114, v115
    v_cvt_pk_bf16_f32 v10, v116, v117
    v_cvt_pk_bf16_f32 v11, v118, v119
    s_nop 1
    v_permlane16_swap_b32 v8, v10
    v_permlane16_swap_b32 v9, v11
    buffer_store_dwordx4 v[8:11], v5, s[8:11], s30 offen offset:128
    v_cvt_pk_bf16_f32 v12, v120, v121
    v_cvt_pk_bf16_f32 v13, v122, v123
    v_cvt_pk_bf16_f32 v14, v124, v125
    v_cvt_pk_bf16_f32 v15, v126, v127
    s_nop 1
    v_permlane16_swap_b32 v12, v14
    v_permlane16_swap_b32 v13, v15
    buffer_store_dwordx4 v[12:15], v5, s[8:11], s30 offen offset:192
    v_cvt_pk_bf16_f32 v8, v128, v129
    v_cvt_pk_bf16_f32 v9, v130, v131
    v_cvt_pk_bf16_f32 v10, v132, v133
    v_cvt_pk_bf16_f32 v11, v134, v135
    s_nop 1
    v_permlane16_swap_b32 v8, v10
    v_permlane16_swap_b32 v9, v11
    buffer_store_dwordx4 v[8:11], v5, s[8:11], s30 offen offset:256
    s_add_u32 s31, s50, 1
    s_and_b32 s31, s31, 3
    s_mul_i32 s30, s20, 327680
    s_mul_i32 s29, s16, 163840
    s_add_u32 s30, s30, s29
    s_mul_i32 s29, s31, 40960
    s_add_u32 s30, s30, s29
    s_mul_i32 s29, s17, 1280
    s_add_u32 s30, s30, s29
    s_mul_i32 s29, s21, 320
    s_add_u32 s30, s30, s29
    v_cvt_pk_bf16_f32 v8, v136, v137
    v_cvt_pk_bf16_f32 v9, v138, v139
    v_cvt_pk_bf16_f32 v10, v140, v141
    v_cvt_pk_bf16_f32 v11, v142, v143
    s_nop 1
    v_permlane16_swap_b32 v8, v10
    v_permlane16_swap_b32 v9, v11
    buffer_store_dwordx4 v[8:11], v5, s[8:11], s30 offen offset:0
    v_cvt_pk_bf16_f32 v12, v144, v145
    v_cvt_pk_bf16_f32 v13, v146, v147
    v_cvt_pk_bf16_f32 v14, v148, v149
    v_cvt_pk_bf16_f32 v15, v150, v151
    s_nop 1
    v_permlane16_swap_b32 v12, v14
    v_permlane16_swap_b32 v13, v15
    buffer_store_dwordx4 v[12:15], v5, s[8:11], s30 offen offset:64
    v_cvt_pk_bf16_f32 v8, v152, v153
    v_cvt_pk_bf16_f32 v9, v154, v155
    v_cvt_pk_bf16_f32 v10, v156, v157
    v_cvt_pk_bf16_f32 v11, v158, v159
    s_nop 1
    v_permlane16_swap_b32 v8, v10
    v_permlane16_swap_b32 v9, v11
    buffer_store_dwordx4 v[8:11], v5, s[8:11], s30 offen offset:128
    v_cvt_pk_bf16_f32 v12, v160, v161
    v_cvt_pk_bf16_f32 v13, v162, v163
    v_cvt_pk_bf16_f32 v14, v164, v165
    v_cvt_pk_bf16_f32 v15, v166, v167
    s_nop 1
    v_permlane16_swap_b32 v12, v14
    v_permlane16_swap_b32 v13, v15
    buffer_store_dwordx4 v[12:15], v5, s[8:11], s30 offen offset:192
    v_cvt_pk_bf16_f32 v8, v168, v169
    v_cvt_pk_bf16_f32 v9, v170, v171
    v_cvt_pk_bf16_f32 v10, v172, v173
    v_cvt_pk_bf16_f32 v11, v174, v175
    s_nop 1
    v_permlane16_swap_b32 v8, v10
    v_permlane16_swap_b32 v9, v11
    buffer_store_dwordx4 v[8:11], v5, s[8:11], s30 offen offset:256
    s_branch L_op_next
L_op2_go:
    s_mul_i32 s31, s22, s24
    s_lshl_b32 s31, s31, 3
    s_mov_b32 s34, s40
    s_mul_i32 s29, s17, 7864320
    s_add_u32 s34, s34, s29
    s_mul_i32 s29, s31, 40960
    s_add_u32 s34, s34, s29
    s_mul_i32 s29, s21, 10240
    s_add_u32 s34, s34, s29
    s_mul_i32 s42, s17, 25165824
    s_mul_i32 s29, s20, 1572864
    s_add_u32 s42, s42, s29
    s_mul_i32 s29, s16, 393216
    s_add_u32 s42, s42, s29
    s_mul_i32 s29, s31, 1024
    s_add_u32 s42, s42, s29
    s_add_u32 s42, s42, 101220352
    s_add_u32 s43, s42, 196608
    s_mov_b32 s35, s41
    s_mul_i32 s48, s24, 327680
    s_add_u32 s48, s48, s34
    s_mul_i32 s49, s24, 8192
    s_add_u32 s49, s49, s42
    s_mov_b32 m0, s35
    s_nop 0
    buffer_load_dwordx4 v1, s[4:7], s34 offen offset:0 sc1 lds
    buffer_load_dwordx4 v1, s[4:7], s34 offen offset:1024 sc1 lds
    buffer_load_dwordx4 v1, s[4:7], s34 offen offset:2048 sc1 lds
    buffer_load_dwordx4 v1, s[4:7], s34 offen offset:3072 sc1 lds
    s_add_u32 m0, s35, 4096
    s_add_u32 s29, s34, 4096
    buffer_load_dwordx4 v1, s[4:7], s29 offen offset:0 sc1 lds
    s_add_u32 s34, s34, 81920
    s_add_u32 s35, s35, 20480
    s_add_u32 s29, s41, 122880
    s_cmp_ge_u32 s35, s29
    s_cselect_b32 s35, s41, s35
    s_cmp_ge_u32 s34, s48
    s_cselect_b32 s34, 0x7f000000, s34
    s_mov_b32 m0, s35
    s_nop 0
    buffer_load_dwordx4 v1, s[4:7], s34 offen offset:0 sc1 lds
    buffer_load_dwordx4 v1, s[4:7], s34 offen offset:1024 sc1 lds
    buffer_load_dwordx4 v1, s[4:7], s34 offen offset:2048 sc1 lds
    buffer_load_dwordx4 v1, s[4:7], s34 offen offset:3072 sc1 lds
    s_add_u32 m0, s35, 4096
    s_add_u32 s29, s34, 4096
    buffer_load_dwordx4 v1, s[4:7], s29 offen offset:0 sc1 lds
    s_add_u32 s34, s34, 81920
    s_add_u32 s35, s35, 20480
    s_add_u32 s29, s41, 122880
    s_cmp_ge_u32 s35, s29
    s_cselect_b32 s35, s41, s35
    s_cmp_ge_u32 s34, s48
    s_cselect_b32 s34, 0x7f000000, s34
    s_mov_b32 m0, s35
    s_nop 0
    buffer_load_dwordx4 v1, s[4:7], s34 offen offset:0 sc1 lds
    buffer_load_dwordx4 v1, s[4:7], s34 offen offset:1024 sc1 lds
    buffer_load_dwordx4 v1, s[4:7], s34 offen offset:2048 sc1 lds
    buffer_load_dwordx4 v1, s[4:7], s34 offen offset:3072 sc1 lds
    s_add_u32 m0, s35, 4096
    s_add_u32 s29, s34, 4096
    buffer_load_dwordx4 v1, s[4:7], s29 offen offset:0 sc1 lds
    s_add_u32 s34, s34, 81920
    s_add_u32 s35, s35, 20480
    s_add_u32 s29, s41, 122880
    s_cmp_ge_u32 s35, s29
    s_cselect_b32 s35, s41, s35
    s_cmp_ge_u32 s34, s48
    s_cselect_b32 s34, 0x7f000000, s34
    s_mov_b32 m0, s35
    s_nop 0
    buffer_load_dwordx4 v1, s[4:7], s34 offen offset:0 sc1 lds
    buffer_load_dwordx4 v1, s[4:7], s34 offen offset:1024 sc1 lds
    buffer_load_dwordx4 v1, s[4:7], s34 offen offset:2048 sc1 lds
    buffer_load_dwordx4 v1, s[4:7], s34 offen offset:3072 sc1 lds
    s_add_u32 m0, s35, 4096
    s_add_u32 s29, s34, 4096
    buffer_load_dwordx4 v1, s[4:7], s29 offen offset:0 sc1 lds
    s_add_u32 s34, s34, 81920
    s_add_u32 s35, s35, 20480
    s_add_u32 s29, s41, 122880
    s_cmp_ge_u32 s35, s29
    s_cselect_b32 s35, s41, s35
    s_cmp_ge_u32 s34, s48
    s_cselect_b32 s34, 0x7f000000, s34
    s_mul_i32 s30, s17, 2048
    s_mul_i32 s29, s20, 128
    s_add_u32 s30, s30, s29
    s_add_u32 s30, s30, 184512512
    s_cmp_lg_u32 s16, 0
    s_cbranch_scc1 L_103
L_102:
    buffer_load_dword v6, v2, s[4:7], s30 offen offset:0 sc1
    s_waitcnt vmcnt(0)
    v_cmp_gt_u32 vcc, 32, v6
    s_cbranch_vccz L_103
    s_sleep 8
    s_branch L_spin_104
L_103:
    s_barrier
    buffer_load_dwordx4 v[96:99], v1, s[4:7], s42 offen offset:0 sc1
    buffer_load_dwordx4 v[104:107], v1, s[4:7], s42 offen offset:1024 sc1
    s_add_u32 s42, s42, 2048
    buffer_load_dwordx4 v[100:103], v1, s[4:7], s43 offen offset:0 sc1
    buffer_load_dwordx4 v[108:111], v1, s[4:7], s43 offen offset:1024 sc1
    s_add_u32 s43, s43, 2048
    s_cmp_ge_u32 s42, s49
    s_cselect_b32 s42, 0x7f000000, s42
    s_cselect_b32 s43, 0x7f000000, s43
    buffer_load_dwordx4 v[112:115], v1, s[4:7], s42 offen offset:0 sc1
    buffer_load_dwordx4 v[120:123], v1, s[4:7], s42 offen offset:1024 sc1
    s_add_u32 s42, s42, 2048
    buffer_load_dwordx4 v[116:119], v1, s[4:7], s43 offen offset:0 sc1
    buffer_load_dwordx4 v[124:127], v1, s[4:7], s43 offen offset:1024 sc1
    s_add_u32 s43, s43, 2048
    s_cmp_ge_u32 s42, s49
    s_cselect_b32 s42, 0x7f000000, s42
    s_cselect_b32 s43, 0x7f000000, s43
    buffer_load_dwordx4 v[128:131], v1, s[4:7], s42 offen offset:0 sc1
    buffer_load_dwordx4 v[136:139], v1, s[4:7], s42 offen offset:1024 sc1
    s_add_u32 s42, s42, 2048
    buffer_load_dwordx4 v[132:135], v1, s[4:7], s43 offen offset:0 sc1
    buffer_load_dwordx4 v[140:143], v1, s[4:7], s43 offen offset:1024 sc1
    s_add_u32 s43, s43, 2048
    s_cmp_ge_u32 s42, s49
    s_cselect_b32 s42, 0x7f000000, s42
    s_cselect_b32 s43, 0x7f000000, s43
    v_accvgpr_write_b32 a0, 0
    v_accvgpr_write_b32 a1, 0
    v_accvgpr_write_b32 a2, 0
    v_accvgpr_write_b32 a3, 0
    v_accvgpr_write_b32 a4, 0
    v_accvgpr_write_b32 a5, 0
    v_accvgpr_write_b32 a6, 0
    v_accvgpr_write_b32 a7, 0
    v_accvgpr_write_b32 a8, 0
    v_accvgpr_write_b32 a9, 0
    v_accvgpr_write_b32 a10, 0
    v_accvgpr_write_b32 a11, 0
    v_accvgpr_write_b32 a12, 0
    v_accvgpr_write_b32 a13, 0
    v_accvgpr_write_b32 a14, 0
    v_accvgpr_write_b32 a15, 0
    v_accvgpr_write_b32 a16, 0
    v_accvgpr_write_b32 a17, 0
    v_accvgpr_write_b32 a18, 0
    v_accvgpr_write_b32 a19, 0
    v_accvgpr_write_b32 a20, 0
    v_accvgpr_write_b32 a21, 0
    v_accvgpr_write_b32 a22, 0
    v_accvgpr_write_b32 a23, 0
    v_accvgpr_write_b32 a24, 0
    v_accvgpr_write_b32 a25, 0
    v_accvgpr_write_b32 a26, 0
    v_accvgpr_write_b32 a27, 0
    v_accvgpr_write_b32 a28, 0
    v_accvgpr_write_b32 a29, 0
    v_accvgpr_write_b32 a30, 0
    v_accvgpr_write_b32 a31, 0
    v_accvgpr_write_b32 a32, 0
    v_accvgpr_write_b32 a33, 0
    v_accvgpr_write_b32 a34, 0
    v_accvgpr_write_b32 a35, 0
    v_accvgpr_write_b32 a36, 0
    v_accvgpr_write_b32 a37, 0
    v_accvgpr_write_b32 a38, 0
    v_accvgpr_write_b32 a39, 0
    v_accvgpr_write_b32 a40, 0
    v_accvgpr_write_b32 a41, 0
    v_accvgpr_write_b32 a42, 0
    v_accvgpr_write_b32 a43, 0
    v_accvgpr_write_b32 a44, 0
    v_accvgpr_write_b32 a45, 0
    v_accvgpr_write_b32 a46, 0
    v_accvgpr_write_b32 a47, 0
    v_accvgpr_write_b32 a48, 0
    v_accvgpr_write_b32 a49, 0
    v_accvgpr_write_b32 a50, 0
    v_accvgpr_write_b32 a51, 0
    v_accvgpr_write_b32 a52, 0
    v_accvgpr_write_b32 a53, 0
    v_accvgpr_write_b32 a54, 0
    v_accvgpr_write_b32 a55, 0
    v_accvgpr_write_b32 a56, 0
    v_accvgpr_write_b32 a57, 0
    v_accvgpr_write_b32 a58, 0
    v_accvgpr_write_b32 a59, 0
    v_accvgpr_write_b32 a60, 0
    v_accvgpr_write_b32 a61, 0
    v_accvgpr_write_b32 a62, 0
    v_accvgpr_write_b32 a63, 0
    v_accvgpr_write_b32 a64, 0
    v_accvgpr_write_b32 a65, 0
    v_accvgpr_write_b32 a66, 0
    v_accvgpr_write_b32 a67, 0
    v_accvgpr_write_b32 a68, 0
    v_accvgpr_write_b32 a69, 0
    v_accvgpr_write_b32 a70, 0
    v_accvgpr_write_b32 a71, 0
    v_accvgpr_write_b32 a72, 0
    v_accvgpr_write_b32 a73, 0
    v_accvgpr_write_b32 a74, 0
    v_accvgpr_write_b32 a75, 0
    v_accvgpr_write_b32 a76, 0
    v_accvgpr_write_b32 a77, 0
    v_accvgpr_write_b32 a78, 0
    v_accvgpr_write_b32 a79, 0
    v_mov_b32 v3, v1
    v_add_u32 v4, 20480, v1
    s_waitcnt vmcnt(0)
    s_barrier
    ds_read_b128 v[16:19], v3 offset:0
    ds_read_b128 v[20:23], v3 offset:1024
    ds_read_b128 v[24:27], v3 offset:2048
    ds_read_b128 v[28:31], v3 offset:3072
    ds_read_b128 v[32:35], v3 offset:4096
    ds_read_b128 v[36:39], v3 offset:5120
    ds_read_b128 v[40:43], v3 offset:6144
    ds_read_b128 v[44:47], v3 offset:7168
    ds_read_b128 v[48:51], v3 offset:8192
    ds_read_b128 v[52:55], v3 offset:9216
.p2align 6
L_op2_loop:
    s_waitcnt vmcnt(18)
    s_waitcnt lgkmcnt(9)
    v_mfma_f32_16x16x32_bf16 a[0:3], v[16:19], v[96:99], a[0:3]
    ds_read_b128 v[56:59], v3 offset:10240
    v_mfma_f32_16x16x32_bf16 a[4:7], v[16:19], v[100:103], a[4:7]
    s_mov_b32 m0, s35
    s_nop 0
    buffer_load_dwordx4 v1, s[4:7], s34 offen offset:0 sc1 lds
    s_waitcnt lgkmcnt(9)
    v_mfma_f32_16x16x32_bf16 a[8:11], v[20:23], v[96:99], a[8:11]
    ds_read_b128 v[60:63], v3 offset:11264
    v_mfma_f32_16x16x32_bf16 a[12:15], v[20:23], v[100:103], a[12:15]
    s_waitcnt lgkmcnt(9)
    v_mfma_f32_16x16x32_bf16 a[16:19], v[24:27], v[96:99], a[16:19]
    ds_read_b128 v[64:67], v3 offset:12288
    v_mfma_f32_16x16x32_bf16 a[20:23], v[24:27], v[100:103], a[20:23]
    buffer_load_dwordx4 v1, s[4:7], s34 offen offset:1024 sc1 lds
    s_waitcnt lgkmcnt(9)
    v_mfma_f32_16x16x32_bf16 a[24:27], v[28:31], v[96:99], a[24:27]
    ds_read_b128 v[68:71], v3 offset:13312
    v_mfma_f32_16x16x32_bf16 a[28:31], v[28:31], v[100:103], a[28:31]
    s_waitcnt lgkmcnt(9)
    v_mfma_f32_16x16x32_bf16 a[32:35], v[32:35], v[96:99], a[32:35]
    ds_read_b128 v[72:75], v3 offset:14336
    v_mfma_f32_16x16x32_bf16 a[36:39], v[32:35], v[100:103], a[36:39]
    buffer_load_dwordx4 v1, s[4:7], s34 offen offset:2048 sc1 lds
    s_waitcnt lgkmcnt(9)
    v_mfma_f32_16x16x32_bf16 a[40:43], v[36:39], v[96:99], a[40:43]
    ds_read_b128 v[76:79], v3 offset:15360
    v_mfma_f32_16x16x32_bf16 a[44:47], v[36:39], v[100:103], a[44:47]
    s_waitcnt lgkmcnt(9)
    v_mfma_f32_16x16x32_bf16 a[48:51], v[40:43], v[96:99], a[48:51]
    ds_read_b128 v[80:83], v3 offset:16384
    v_mfma_f32_16x16x32_bf16 a[52:55], v[40:43], v[100:103], a[52:55]
    buffer_load_dwordx4 v1, s[4:7], s34 offen offset:3072 sc1 lds
    s_waitcnt lgkmcnt(9)
    v_mfma_f32_16x16x32_bf16 a[56:59], v[44:47], v[96:99], a[56:59]
    ds_read_b128 v[84:87], v3 offset:17408
    v_mfma_f32_16x16x32_bf16 a[60:63], v[44:47], v[100:103], a[60:63]
    s_waitcnt lgkmcnt(9)
    v_mfma_f32_16x16x32_bf16 a[64:67], v[48:51], v[96:99], a[64:67]
    ds_read_b128 v[88:91], v3 offset:18432
    v_mfma_f32_16x16x32_bf16 a[68:71], v[48:51], v[100:103], a[68:71]
    s_add_u32 m0, s35, 4096
    s_add_u32 s29, s34, 4096
    buffer_load_dwordx4 v1, s[4:7], s29 offen offset:0 sc1 lds
    s_add_u32 s34, s34, 81920
    s_add_u32 s35, s35, 20480
    s_add_u32 s29, s41, 122880
    s_cmp_ge_u32 s35, s29
    s_cselect_b32 s35, s41, s35
    s_cmp_ge_u32 s34, s48
    s_cselect_b32 s34, 0x7f000000, s34
    s_waitcnt lgkmcnt(9)
    v_mfma_f32_16x16x32_bf16 a[72:75], v[52:55], v[96:99], a[72:75]
    ds_read_b128 v[92:95], v3 offset:19456
    v_mfma_f32_16x16x32_bf16 a[76:79], v[52:55], v[100:103], a[76:79]
    s_waitcnt vmcnt(27)
    s_barrier
    s_waitcnt lgkmcnt(9)
    v_mfma_f32_16x16x32_bf16 a[0:3], v[56:59], v[104:107], a[0:3]
    ds_read_b128 v[16:19], v4 offset:0
    v_mfma_f32_16x16x32_bf16 a[4:7], v[56:59], v[108:111], a[4:7]
    s_waitcnt lgkmcnt(9)
    v_mfma_f32_16x16x32_bf16 a[8:11], v[60:63], v[104:107], a[8:11]
    ds_read_b128 v[20:23], v4 offset:1024
    v_mfma_f32_16x16x32_bf16 a[12:15], v[60:63], v[108:111], a[12:15]
    buffer_load_dwordx4 v[144:147], v1, s[4:7], s42 offen offset:0 sc1
    s_waitcnt lgkmcnt(9)
    v_mfma_f32_16x16x32_bf16 a[16:19], v[64:67], v[104:107], a[16:19]
    ds_read_b128 v[24:27], v4 offset:2048
    v_mfma_f32_16x16x32_bf16 a[20:23], v[64:67], v[108:111], a[20:23]
    s_waitcnt lgkmcnt(9)
    v_mfma_f32_16x16x32_bf16 a[24:27], v[68:71], v[104:107], a[24:27]
    ds_read_b128 v[28:31], v4 offset:3072
    v_mfma_f32_16x16x32_bf16 a[28:31], v[68:71], v[108:111], a[28:31]
    buffer_load_dwordx4 v[152:155], v1, s[4:7], s42 offen offset:1024 sc1
    s_add_u32 s42, s42, 2048
    s_waitcnt lgkmcnt(9)
    v_mfma_f32_16x16x32_bf16 a[32:35], v[72:75], v[104:107], a[32:35]
    ds_read_b128 v[32:35], v4 offset:4096
    v_mfma_f32_16x16x32_bf16 a[36:39], v[72:75], v[108:111], a[36:39]
    s_waitcnt lgkmcnt(9)
    v_mfma_f32_16x16x32_bf16 a[40:43], v[76:79], v[104:107], a[40:43]
    ds_read_b128 v[36:39], v4 offset:5120
    v_mfma_f32_16x16x32_bf16 a[44:47], v[76:79], v[108:111], a[44:47]
    buffer_load_dwordx4 v[148:151], v1, s[4:7], s43 offen offset:0 sc1
    s_waitcnt lgkmcnt(9)
    v_mfma_f32_16x16x32_bf16 a[48:51], v[80:83], v[104:107], a[48:51]
    ds_read_b128 v[40:43], v4 offset:6144
    v_mfma_f32_16x16x32_bf16 a[52:55], v[80:83], v[108:111], a[52:55]
    s_waitcnt lgkmcnt(9)
    v_mfma_f32_16x16x32_bf16 a[56:59], v[84:87], v[104:107], a[56:59]
    ds_read_b128 v[44:47], v4 offset:7168
    v_mfma_f32_16x16x32_bf16 a[60:63], v[84:87], v[108:111], a[60:63]
    buffer_load_dwordx4 v[156:159], v1, s[4:7], s43 offen offset:1024 sc1
    s_add_u32 s43, s43, 2048
    s_cmp_ge_u32 s42, s49
    s_cselect_b32 s42, 0x7f000000, s42
    s_cselect_b32 s43, 0x7f000000, s43
    s_waitcnt lgkmcnt(9)
    v_mfma_f32_16x16x32_bf16 a[64:67], v[88:91], v[104:107], a[64:67]
    ds_read_b128 v[48:51], v4 offset:8192
    v_mfma_f32_16x16x32_bf16 a[68:71], v[88:91], v[108:111], a[68:71]
    s_waitcnt lgkmcnt(9)
    v_mfma_f32_16x16x32_bf16 a[72:75], v[92:95], v[104:107], a[72:75]
    ds_read_b128 v[52:55], v4 offset:9216
    v_mfma_f32_16x16x32_bf16 a[76:79], v[92:95], v[108:111], a[76:79]
    v_mov_b32 v3, v4
    v_add_u32 v4, 20480, v4
    v_subrev_u32 v6, 122880, v4
    v_min_u32 v4, v4, v6
    s_waitcnt vmcnt(18)
    s_waitcnt lgkmcnt(9)
    v_mfma_f32_16x16x32_bf16 a[0:3], v[16:19], v[112:115], a[0:3]
    ds_read_b128 v[56:59], v3 offset:10240
    v_mfma_f32_16x16x32_bf16 a[4:7], v[16:19], v[116:119], a[4:7]
    s_mov_b32 m0, s35
    s_nop 0
    buffer_load_dwordx4 v1, s[4:7], s34 offen offset:0 sc1 lds
    s_waitcnt lgkmcnt(9)
    v_mfma_f32_16x16x32_bf16 a[8:11], v[20:23], v[112:115], a[8:11]
    ds_read_b128 v[60:63], v3 offset:11264
    v_mfma_f32_16x16x32_bf16 a[12:15], v[20:23], v[116:119], a[12:15]
    s_waitcnt lgkmcnt(9)
    v_mfma_f32_16x16x32_bf16 a[16:19], v[24:27], v[112:115], a[16:19]
    ds_read_b128 v[64:67], v3 offset:12288
    v_mfma_f32_16x16x32_bf16 a[20:23], v[24:27], v[116:119], a[20:23]
    buffer_load_dwordx4 v1, s[4:7], s34 offen offset:1024 sc1 lds
    s_waitcnt lgkmcnt(9)
    v_mfma_f32_16x16x32_bf16 a[24:27], v[28:31], v[112:115], a[24:27]
    ds_read_b128 v[68:71], v3 offset:13312
    v_mfma_f32_16x16x32_bf16 a[28:31], v[28:31], v[116:119], a[28:31]
    s_waitcnt lgkmcnt(9)
    v_mfma_f32_16x16x32_bf16 a[32:35], v[32:35], v[112:115], a[32:35]
    ds_read_b128 v[72:75], v3 offset:14336
    v_mfma_f32_16x16x32_bf16 a[36:39], v[32:35], v[116:119], a[36:39]
    buffer_load_dwordx4 v1, s[4:7], s34 offen offset:2048 sc1 lds
    s_waitcnt lgkmcnt(9)
    v_mfma_f32_16x16x32_bf16 a[40:43], v[36:39], v[112:115], a[40:43]
    ds_read_b128 v[76:79], v3 offset:15360
    v_mfma_f32_16x16x32_bf16 a[44:47], v[36:39], v[116:119], a[44:47]
    s_waitcnt lgkmcnt(9)
    v_mfma_f32_16x16x32_bf16 a[48:51], v[40:43], v[112:115], a[48:51]
    ds_read_b128 v[80:83], v3 offset:16384
    v_mfma_f32_16x16x32_bf16 a[52:55], v[40:43], v[116:119], a[52:55]
    buffer_load_dwordx4 v1, s[4:7], s34 offen offset:3072 sc1 lds
    s_waitcnt lgkmcnt(9)
    v_mfma_f32_16x16x32_bf16 a[56:59], v[44:47], v[112:115], a[56:59]
    ds_read_b128 v[84:87], v3 offset:17408
    v_mfma_f32_16x16x32_bf16 a[60:63], v[44:47], v[116:119], a[60:63]
    s_waitcnt lgkmcnt(9)
    v_mfma_f32_16x16x32_bf16 a[64:67], v[48:51], v[112:115], a[64:67]
    ds_read_b128 v[88:91], v3 offset:18432
    v_mfma_f32_16x16x32_bf16 a[68:71], v[48:51], v[116:119], a[68:71]
    s_add_u32 m0, s35, 4096
    s_add_u32 s29, s34, 4096
    buffer_load_dwordx4 v1, s[4:7], s29 offen offset:0 sc1 lds
    s_add_u32 s34, s34, 81920
    s_add_u32 s35, s35, 20480
    s_add_u32 s29, s41, 122880
    s_cmp_ge_u32 s35, s29
    s_cselect_b32 s35, s41, s35
    s_cmp_ge_u32 s34, s48
    s_cselect_b32 s34, 0x7f000000, s34
    s_waitcnt lgkmcnt(9)
    v_mfma_f32_16x16x32_bf16 a[72:75], v[52:55], v[112:115], a[72:75]
    ds_read_b128 v[92:95], v3 offset:19456
    v_mfma_f32_16x16x32_bf16 a[76:79], v[52:55], v[116:119], a[76:79]
    s_waitcnt vmcnt(27)
    s_barrier
    s_waitcnt lgkmcnt(9)
    v_mfma_f32_16x16x32_bf16 a[0:3], v[56:59], v[120:123], a[0:3]
    ds_read_b128 v[16:19], v4 offset:0
    v_mfma_f32_16x16x32_bf16 a[4:7], v[56:59], v[124:127], a[4:7]
    s_waitcnt lgkmcnt(9)
    v_mfma_f32_16x16x32_bf16 a[8:11], v[60:63], v[120:123], a[8:11]
    ds_read_b128 v[20:23], v4 offset:1024
    v_mfma_f32_16x16x32_bf16 a[12:15], v[60:63], v[124:127], a[12:15]
    buffer_load_dwordx4 v[96:99], v1, s[4:7], s42 offen offset:0 sc1
    s_waitcnt lgkmcnt(9)
    v_mfma_f32_16x16x32_bf16 a[16:19], v[64:67], v[120:123], a[16:19]
    ds_read_b128 v[24:27], v4 offset:2048
    v_mfma_f32_16x16x32_bf16 a[20:23], v[64:67], v[124:127], a[20:23]
    s_waitcnt lgkmcnt(9)
    v_mfma_f32_16x16x32_bf16 a[24:27], v[68:71], v[120:123], a[24:27]
    ds_read_b128 v[28:31], v4 offset:3072
    v_mfma_f32_16x16x32_bf16 a[28:31], v[68:71], v[124:127], a[28:31]
    buffer_load_dwordx4 v[104:107], v1, s[4:7], s42 offen offset:1024 sc1
    s_add_u32 s42, s42, 2048
    s_waitcnt lgkmcnt(9)
    v_mfma_f32_16x16x32_bf16 a[32:35], v[72:75], v[120:123], a[32:35]
    ds_read_b128 v[32:35], v4 offset:4096
    v_mfma_f32_16x16x32_bf16 a[36:39], v[72:75], v[124:127], a[36:39]
    s_waitcnt lgkmcnt(9)
    v_mfma_f32_16x16x32_bf16 a[40:43], v[76:79], v[120:123], a[40:43]
    ds_read_b128 v[36:39], v4 offset:5120
    v_mfma_f32_16x16x32_bf16 a[44:47], v[76:79], v[124:127], a[44:47]
    buffer_load_dwordx4 v[100:103], v1, s[4:7], s43 offen offset:0 sc1
    s_waitcnt lgkmcnt(9)
    v_mfma_f32_16x16x32_bf16 a[48:51], v[80:83], v[120:123], a[48:51]
    ds_read_b128 v[40:43], v4 offset:6144
    v_mfma_f32_16x16x32_bf16 a[52:55], v[80:83], v[124:127], a[52:55]
    s_waitcnt lgkmcnt(9)
    v_mfma_f32_16x16x32_bf16 a[56:59], v[84:87], v[120:123], a[56:59]
    ds_read_b128 v[44:47], v4 offset:7168
    v_mfma_f32_16x16x32_bf16 a[60:63], v[84:87], v[124:127], a[60:63]
    buffer_load_dwordx4 v[108:111], v1, s[4:7], s43 offen offset:1024 sc1
    s_add_u32 s43, s43, 2048
    s_cmp_ge_u32 s42, s49
    s_cselect_b32 s42, 0x7f000000, s42
    s_cselect_b32 s43, 0x7f000000, s43
    s_waitcnt lgkmcnt(9)
    v_mfma_f32_16x16x32_bf16 a[64:67], v[88:91], v[120:123], a[64:67]
    ds_read_b128 v[48:51], v4 offset:8192
    v_mfma_f32_16x16x32_bf16 a[68:71], v[88:91], v[124:127], a[68:71]
    s_waitcnt lgkmcnt(9)
    v_mfma_f32_16x16x32_bf16 a[72:75], v[92:95], v[120:123], a[72:75]
    ds_read_b128 v[52:55], v4 offset:9216
    v_mfma_f32_16x16x32_bf16 a[76:79], v[92:95], v[124:127], a[76:79]
    v_mov_b32 v3, v4
    v_add_u32 v4, 20480, v4
    v_subrev_u32 v6, 122880, v4
    v_min_u32 v4, v4, v6
    s_waitcnt vmcnt(18)
    s_waitcnt lgkmcnt(9)
    v_mfma_f32_16x16x32_bf16 a[0:3], v[16:19], v[128:131], a[0:3]
    ds_read_b128 v[56:59], v3 offset:10240
    v_mfma_f32_16x16x32_bf16 a[4:7], v[16:19], v[132:135], a[4:7]
    s_mov_b32 m0, s35
    s_nop 0
    buffer_load_dwordx4 v1, s[4:7], s34 offen offset:0 sc1 lds
    s_waitcnt lgkmcnt(9)
    v_mfma_f32_16x16x32_bf16 a[8:11], v[20:23], v[128:131], a[8:11]
    ds_read_b128 v[60:63], v3 offset:11264
    v_mfma_f32_16x16x32_bf16 a[12:15], v[20:23], v[132:135], a[12:15]
    s_waitcnt lgkmcnt(9)
    v_mfma_f32_16x16x32_bf16 a[16:19], v[24:27], v[128:131], a[16:19]
    ds_read_b128 v[64:67], v3 offset:12288
    v_mfma_f32_16x16x32_bf16 a[20:23], v[24:27], v[132:135], a[20:23]
    buffer_load_dwordx4 v1, s[4:7], s34 offen offset:1024 sc1 lds
    s_waitcnt lgkmcnt(9)
    v_mfma_f32_16x16x32_bf16 a[24:27], v[28:31], v[128:131], a[24:27]
    ds_read_b128 v[68:71], v3 offset:13312
    v_mfma_f32_16x16x32_bf16 a[28:31], v[28:31], v[132:135], a[28:31]
    s_waitcnt lgkmcnt(9)
    v_mfma_f32_16x16x32_bf16 a[32:35], v[32:35], v[128:131], a[32:35]
    ds_read_b128 v[72:75], v3 offset:14336
    v_mfma_f32_16x16x32_bf16 a[36:39], v[32:35], v[132:135], a[36:39]
    buffer_load_dwordx4 v1, s[4:7], s34 offen offset:2048 sc1 lds
    s_waitcnt lgkmcnt(9)
    v_mfma_f32_16x16x32_bf16 a[40:43], v[36:39], v[128:131], a[40:43]
    ds_read_b128 v[76:79], v3 offset:15360
    v_mfma_f32_16x16x32_bf16 a[44:47], v[36:39], v[132:135], a[44:47]
    s_waitcnt lgkmcnt(9)
    v_mfma_f32_16x16x32_bf16 a[48:51], v[40:43], v[128:131], a[48:51]
    ds_read_b128 v[80:83], v3 offset:16384
    v_mfma_f32_16x16x32_bf16 a[52:55], v[40:43], v[132:135], a[52:55]
    buffer_load_dwordx4 v1, s[4:7], s34 offen offset:3072 sc1 lds
    s_waitcnt lgkmcnt(9)
    v_mfma_f32_16x16x32_bf16 a[56:59], v[44:47], v[128:131], a[56:59]
    ds_read_b128 v[84:87], v3 offset:17408
    v_mfma_f32_16x16x32_bf16 a[60:63], v[44:47], v[132:135], a[60:63]
    s_waitcnt lgkmcnt(9)
    v_mfma_f32_16x16x32_bf16 a[64:67], v[48:51], v[128:131], a[64:67]
    ds_read_b128 v[88:91], v3 offset:18432
    v_mfma_f32_16x16x32_bf16 a[68:71], v[48:51], v[132:135], a[68:71]
    s_add_u32 m0, s35, 4096
    s_add_u32 s29, s34, 4096
    buffer_load_dwordx4 v1, s[4:7], s29 offen offset:0 sc1 lds
    s_add_u32 s34, s34, 81920
    s_add_u32 s35, s35, 20480
    s_add_u32 s29, s41, 122880
    s_cmp_ge_u32 s35, s29
    s_cselect_b32 s35, s41, s35
    s_cmp_ge_u32 s34, s48
    s_cselect_b32 s34, 0x7f000000, s34
    s_waitcnt lgkmcnt(9)
    v_mfma_f32_16x16x32_bf16 a[72:75], v[52:55], v[128:131], a[72:75]
    ds_read_b128 v[92:95], v3 offset:19456
    v_mfma_f32_16x16x32_bf16 a[76:79], v[52:55], v[132:135], a[76:79]
    s_waitcnt vmcnt(27)
    s_barrier
    s_waitcnt lgkmcnt(9)
    v_mfma_f32_16x16x32_bf16 a[0:3], v[56:59], v[136:139], a[0:3]
    ds_read_b128 v[16:19], v4 offset:0
    v_mfma_f32_16x16x32_bf16 a[4:7], v[56:59], v[140:143], a[4:7]
    s_waitcnt lgkmcnt(9)
    v_mfma_f32_16x16x32_bf16 a[8:11], v[60:63], v[136:139], a[8:11]
    ds_read_b128 v[20:23], v4 offset:1024
    v_mfma_f32_16x16x32_bf16 a[12:15], v[60:63], v[140:143], a[12:15]
    buffer_load_dwordx4 v[112:115], v1, s[4:7], s42 offen offset:0 sc1
    s_waitcnt lgkmcnt(9)
    v_mfma_f32_16x16x32_bf16 a[16:19], v[64:67], v[136:139], a[16:19]
    ds_read_b128 v[24:27], v4 offset:2048
    v_mfma_f32_16x16x32_bf16 a[20:23], v[64:67], v[140:143], a[20:23]
    s_waitcnt lgkmcnt(9)
    v_mfma_f32_16x16x32_bf16 a[24:27], v[68:71], v[136:139], a[24:27]
    ds_read_b128 v[28:31], v4 offset:3072
    v_mfma_f32_16x16x32_bf16 a[28:31], v[68:71], v[140:143], a[28:31]
    buffer_load_dwordx4 v[120:123], v1, s[4:7], s42 offen offset:1024 sc1
    s_add_u32 s42, s42, 2048
    s_waitcnt lgkmcnt(9)
    v_mfma_f32_16x16x32_bf16 a[32:35], v[72:75], v[136:139], a[32:35]
    ds_read_b128 v[32:35], v4 offset:4096
    v_mfma_f32_16x16x32_bf16 a[36:39], v[72:75], v[140:143], a[36:39]
    s_waitcnt lgkmcnt(9)
    v_mfma_f32_16x16x32_bf16 a[40:43], v[76:79], v[136:139], a[40:43]
    ds_read_b128 v[36:39], v4 offset:5120
    v_mfma_f32_16x16x32_bf16 a[44:47], v[76:79], v[140:143], a[44:47]
    buffer_load_dwordx4 v[116:119], v1, s[4:7], s43 offen offset:0 sc1
    s_waitcnt lgkmcnt(9)
    v_mfma_f32_16x16x32_bf16 a[48:51], v[80:83], v[136:139], a[48:51]
    ds_read_b128 v[40:43], v4 offset:6144
    v_mfma_f32_16x16x32_bf16 a[52:55], v[80:83], v[140:143], a[52:55]
    s_waitcnt lgkmcnt(9)
    v_mfma_f32_16x16x32_bf16 a[56:59], v[84:87], v[136:139], a[56:59]
    ds_read_b128 v[44:47], v4 offset:7168
    v_mfma_f32_16x16x32_bf16 a[60:63], v[84:87], v[140:143], a[60:63]
    buffer_load_dwordx4 v[124:127], v1, s[4:7], s43 offen offset:1024 sc1
    s_add_u32 s43, s43, 2048
    s_cmp_ge_u32 s42, s49
    s_cselect_b32 s42, 0x7f000000, s42
    s_cselect_b32 s43, 0x7f000000, s43
    s_waitcnt lgkmcnt(9)
    v_mfma_f32_16x16x32_bf16 a[64:67], v[88:91], v[136:139], a[64:67]
    ds_read_b128 v[48:51], v4 offset:8192
    v_mfma_f32_16x16x32_bf16 a[68:71], v[88:91], v[140:143], a[68:71]
    s_waitcnt lgkmcnt(9)
    v_mfma_f32_16x16x32_bf16 a[72:75], v[92:95], v[136:139], a[72:75]
    ds_read_b128 v[52:55], v4 offset:9216
    v_mfma_f32_16x16x32_bf16 a[76:79], v[92:95], v[140:143], a[76:79]
    v_mov_b32 v3, v4
    v_add_u32 v4, 20480, v4
    v_subrev_u32 v6, 122880, v4
    v_min_u32 v4, v4, v6
    s_waitcnt vmcnt(18)
    s_waitcnt lgkmcnt(9)
    v_mfma_f32_16x16x32_bf16 a[0:3], v[16:19], v[144:147], a[0:3]
    ds_read_b128 v[56:59], v3 offset:10240
    v_mfma_f32_16x16x32_bf16 a[4:7], v[16:19], v[148:151], a[4:7]
    s_mov_b32 m0, s35
    s_nop 0
    buffer_load_dwordx4 v1, s[4:7], s34 offen offset:0 sc1 lds
    s_waitcnt lgkmcnt(9)
    v_mfma_f32_16x16x32_bf16 a[8:11], v[20:23], v[144:147], a[8:11]
    ds_read_b128 v[60:63], v3 offset:11264
    v_mfma_f32_16x16x32_bf16 a[12:15], v[20:23], v[148:151], a[12:15]
    s_waitcnt lgkmcnt(9)
    v_mfma_f32_16x16x32_bf16 a[16:19], v[24:27], v[144:147], a[16:19]
    ds_read_b128 v[64:67], v3 offset:12288
    v_mfma_f32_16x16x32_bf16 a[20:23], v[24:27], v[148:151], a[20:23]
    buffer_load_dwordx4 v1, s[4:7], s34 offen offset:1024 sc1 lds
    s_waitcnt lgkmcnt(9)
    v_mfma_f32_16x16x32_bf16 a[24:27], v[28:31], v[144:147], a[24:27]
    ds_read_b128 v[68:71], v3 offset:13312
    v_mfma_f32_16x16x32_bf16 a[28:31], v[28:31], v[148:151], a[28:31]
    s_waitcnt lgkmcnt(9)
    v_mfma_f32_16x16x32_bf16 a[32:35], v[32:35], v[144:147], a[32:35]
    ds_read_b128 v[72:75], v3 offset:14336
    v_mfma_f32_16x16x32_bf16 a[36:39], v[32:35], v[148:151], a[36:39]
    buffer_load_dwordx4 v1, s[4:7], s34 offen offset:2048 sc1 lds
    s_waitcnt lgkmcnt(9)
    v_mfma_f32_16x16x32_bf16 a[40:43], v[36:39], v[144:147], a[40:43]
    ds_read_b128 v[76:79], v3 offset:15360
    v_mfma_f32_16x16x32_bf16 a[44:47], v[36:39], v[148:151], a[44:47]
    s_waitcnt lgkmcnt(9)
    v_mfma_f32_16x16x32_bf16 a[48:51], v[40:43], v[144:147], a[48:51]
    ds_read_b128 v[80:83], v3 offset:16384
    v_mfma_f32_16x16x32_bf16 a[52:55], v[40:43], v[148:151], a[52:55]
    buffer_load_dwordx4 v1, s[4:7], s34 offen offset:3072 sc1 lds
    s_waitcnt lgkmcnt(9)
    v_mfma_f32_16x16x32_bf16 a[56:59], v[44:47], v[144:147], a[56:59]
    ds_read_b128 v[84:87], v3 offset:17408
    v_mfma_f32_16x16x32_bf16 a[60:63], v[44:47], v[148:151], a[60:63]
    s_waitcnt lgkmcnt(9)
    v_mfma_f32_16x16x32_bf16 a[64:67], v[48:51], v[144:147], a[64:67]
    ds_read_b128 v[88:91], v3 offset:18432
    v_mfma_f32_16x16x32_bf16 a[68:71], v[48:51], v[148:151], a[68:71]
    s_add_u32 m0, s35, 4096
    s_add_u32 s29, s34, 4096
    buffer_load_dwordx4 v1, s[4:7], s29 offen offset:0 sc1 lds
    s_add_u32 s34, s34, 81920
    s_add_u32 s35, s35, 20480
    s_add_u32 s29, s41, 122880
    s_cmp_ge_u32 s35, s29
    s_cselect_b32 s35, s41, s35
    s_cmp_ge_u32 s34, s48
    s_cselect_b32 s34, 0x7f000000, s34
    s_waitcnt lgkmcnt(9)
    v_mfma_f32_16x16x32_bf16 a[72:75], v[52:55], v[144:147], a[72:75]
    ds_read_b128 v[92:95], v3 offset:19456
    v_mfma_f32_16x16x32_bf16 a[76:79], v[52:55], v[148:151], a[76:79]
    s_waitcnt vmcnt(27)
    s_barrier
    s_waitcnt lgkmcnt(9)
    v_mfma_f32_16x16x32_bf16 a[0:3], v[56:59], v[152:155], a[0:3]
    ds_read_b128 v[16:19], v4 offset:0
    v_mfma_f32_16x16x32_bf16 a[4:7], v[56:59], v[156:159], a[4:7]
    s_waitcnt lgkmcnt(9)
    v_mfma_f32_16x16x32_bf16 a[8:11], v[60:63], v[152:155], a[8:11]
    ds_read_b128 v[20:23], v4 offset:1024
    v_mfma_f32_16x16x32_bf16 a[12:15], v[60:63], v[156:159], a[12:15]
    buffer_load_dwordx4 v[128:131], v1, s[4:7], s42 offen offset:0 sc1
    s_waitcnt lgkmcnt(9)
    v_mfma_f32_16x16x32_bf16 a[16:19], v[64:67], v[152:155], a[16:19]
    ds_read_b128 v[24:27], v4 offset:2048
    v_mfma_f32_16x16x32_bf16 a[20:23], v[64:67], v[156:159], a[20:23]
    s_waitcnt lgkmcnt(9)
    v_mfma_f32_16x16x32_bf16 a[24:27], v[68:71], v[152:155], a[24:27]
    ds_read_b128 v[28:31], v4 offset:3072
    v_mfma_f32_16x16x32_bf16 a[28:31], v[68:71], v[156:159], a[28:31]
    buffer_load_dwordx4 v[136:139], v1, s[4:7], s42 offen offset:1024 sc1
    s_add_u32 s42, s42, 2048
    s_waitcnt lgkmcnt(9)
    v_mfma_f32_16x16x32_bf16 a[32:35], v[72:75], v[152:155], a[32:35]
    ds_read_b128 v[32:35], v4 offset:4096
    v_mfma_f32_16x16x32_bf16 a[36:39], v[72:75], v[156:159], a[36:39]
    s_waitcnt lgkmcnt(9)
    v_mfma_f32_16x16x32_bf16 a[40:43], v[76:79], v[152:155], a[40:43]
    ds_read_b128 v[36:39], v4 offset:5120
    v_mfma_f32_16x16x32_bf16 a[44:47], v[76:79], v[156:159], a[44:47]
    buffer_load_dwordx4 v[132:135], v1, s[4:7], s43 offen offset:0 sc1
    s_waitcnt lgkmcnt(9)
    v_mfma_f32_16x16x32_bf16 a[48:51], v[80:83], v[152:155], a[48:51]
    ds_read_b128 v[40:43], v4 offset:6144
    v_mfma_f32_16x16x32_bf16 a[52:55], v[80:83], v[156:159], a[52:55]
    s_waitcnt lgkmcnt(9)
    v_mfma_f32_16x16x32_bf16 a[56:59], v[84:87], v[152:155], a[56:59]
    ds_read_b128 v[44:47], v4 offset:7168
    v_mfma_f32_16x16x32_bf16 a[60:63], v[84:87], v[156:159], a[60:63]
    buffer_load_dwordx4 v[140:143], v1, s[4:7], s43 offen offset:1024 sc1
    s_add_u32 s43, s43, 2048
    s_cmp_ge_u32 s42, s49
    s_cselect_b32 s42, 0x7f000000, s42
    s_cselect_b32 s43, 0x7f000000, s43
    s_waitcnt lgkmcnt(9)
    v_mfma_f32_16x16x32_bf16 a[64:67], v[88:91], v[152:155], a[64:67]
    ds_read_b128 v[48:51], v4 offset:8192
    v_mfma_f32_16x16x32_bf16 a[68:71], v[88:91], v[156:159], a[68:71]
    s_waitcnt lgkmcnt(9)
    v_mfma_f32_16x16x32_bf16 a[72:75], v[92:95], v[152:155], a[72:75]
    ds_read_b128 v[52:55], v4 offset:9216
    v_mfma_f32_16x16x32_bf16 a[76:79], v[92:95], v[156:159], a[76:79]
    v_mov_b32 v3, v4
    v_add_u32 v4, 20480, v4
    v_subrev_u32 v6, 122880, v4
    v_min_u32 v4, v4, v6
    s_sub_u32 s24, s24, 1
    s_cmp_lg_u32 s24, 0
    s_cbranch_scc1 L_op2_loop
    s_nop 7
    s_mov_b32 s30, s46
    s_mul_i32 s29, s22, 81920
    s_add_u32 s30, s30, s29
    s_mul_i32 s29, s16, 20480
    s_add_u32 s30, s30, s29
    s_add_u32 s29, s30, 0
    buffer_store_dwordx4 a[0:3], v1, s[4:7], s29 offen offset:0 sc1
    buffer_store_dwordx4 a[4:7], v1, s[4:7], s29 offen offset:1024 sc1
    buffer_store_dwordx4 a[8:11], v1, s[4:7], s29 offen offset:2048 sc1
    buffer_store_dwordx4 a[12:15], v1, s[4:7], s29 offen offset:3072 sc1
    s_add_u32 s29, s30, 4096
    buffer_store_dwordx4 a[16:19], v1, s[4:7], s29 offen offset:0 sc1
    buffer_store_dwordx4 a[20:23], v1, s[4:7], s29 offen offset:1024 sc1
    buffer_store_dwordx4 a[24:27], v1, s[4:7], s29 offen offset:2048 sc1
    buffer_store_dwordx4 a[28:31], v1, s[4:7], s29 offen offset:3072 sc1
    s_add_u32 s29, s30, 8192
    buffer_store_dwordx4 a[32:35], v1, s[4:7], s29 offen offset:0 sc1
    buffer_store_dwordx4 a[36:39], v1, s[4:7], s29 offen offset:1024 sc1
    buffer_store_dwordx4 a[40:43], v1, s[4:7], s29 offen offset:2048 sc1
    buffer_store_dwordx4 a[44:47], v1, s[4:7], s29 offen offset:3072 sc1
    s_add_u32 s29, s30, 12288
    buffer_store_dwordx4 a[48:51], v1, s[4:7], s29 offen offset:0 sc1
    buffer_store_dwordx4 a[52:55], v1, s[4:7], s29 offen offset:1024 sc1
    buffer_store_dwordx4 a[56:59], v1, s[4:7], s29 offen offset:2048 sc1
    buffer_store_dwordx4 a[60:63], v1, s[4:7], s29 offen offset:3072 sc1
    s_add_u32 s29, s30, 16384
    buffer_store_dwordx4 a[64:67], v1, s[4:7], s29 offen offset:0 sc1
    buffer_store_dwordx4 a[68:71], v1, s[4:7], s29 offen offset:1024 sc1
    buffer_store_dwordx4 a[72:75], v1, s[4:7], s29 offen offset:2048 sc1
    buffer_store_dwordx4 a[76:79], v1, s[4:7], s29 offen offset:3072 sc1
    s_waitcnt vmcnt(0)
    s_barrier
    s_mul_i32 s31, s47, 128
    s_add_u32 s31, s31, 184500224
    s_cmp_lg_u32 s16, 0
    s_cbranch_scc1 L_105
    v_mov_b32 v6, 1
    s_mov_b64 exec, 1
    buffer_atomic_add v6, v2, s[4:7], s31 offen
    s_mov_b64 exec, -1
L_105:
    s_cmp_lg_u32 s16, 0
    s_cbranch_scc1 L_107
L_106:
    buffer_load_dword v6, v2, s[4:7], s31 offen offset:0 sc1
    s_waitcnt vmcnt(0)
    v_cmp_gt_u32 vcc, 6, v6
    s_cbranch_vccz L_107
    s_sleep 4
    s_branch L_spin_108
L_107:
    s_barrier
    s_mul_i32 s34, s22, 27
    s_add_u32 s35, s34, 29
    s_lshr_b32 s35, s35, 2
    s_min_u32 s35, s35, 40
    s_add_u32 s34, s34, 2
    s_lshr_b32 s34, s34, 2
    s_add_u32 s34, s34, s16
L_op_red:
    s_cmp_ge_u32 s34, s35
    s_cbranch_scc1 L_op_next
    s_mul_i32 s30, s34, 26
    s_lshr_b32 s30, s30, 8
    s_mul_i32 s31, s30, 10
    s_sub_u32 s31, s34, s31
    s_lshr_b32 s32, s31, 1
    s_and_b32 s31, s31, 1
    s_mov_b32 s42, s46
    s_mul_i32 s29, s30, 20480
    s_add_u32 s42, s42, s29
    s_mul_i32 s29, s32, 4096
    s_add_u32 s42, s42, s29
    s_mul_i32 s29, s31, 1024
    s_add_u32 s42, s42, s29
    s_add_u32 s29, s42, 0
    buffer_load_dwordx4 v[16:19], v1, s[4:7], s29 offen offset:0 sc1
    buffer_load_dwordx4 v[20:23], v1, s[4:7], s29 offen offset:2048 sc1
    s_add_u32 s29, s42, 81920
    buffer_load_dwordx4 v[24:27], v1, s[4:7], s29 offen offset:0 sc1
    buffer_load_dwordx4 v[28:31], v1, s[4:7], s29 offen offset:2048 sc1
    s_add_u32 s29, s42, 163840
    buffer_load_dwordx4 v[32:35], v1, s[4:7], s29 offen offset:0 sc1
    buffer_load_dwordx4 v[36:39], v1, s[4:7], s29 offen offset:2048 sc1
    s_add_u32 s29, s42, 245760
    buffer_load_dwordx4 v[40:43], v1, s[4:7], s29 offen offset:0 sc1
    buffer_load_dwordx4 v[44:47], v1, s[4:7], s29 offen offset:2048 sc1
    s_add_u32 s29, s42, 327680
    buffer_load_dwordx4 v[48:51], v1, s[4:7], s29 offen offset:0 sc1
    buffer_load_dwordx4 v[52:55], v1, s[4:7], s29 offen offset:2048 sc1
    s_add_u32 s29, s42, 409600
    buffer_load_dwordx4 v[56:59], v1, s[4:7], s29 offen offset:0 sc1
    buffer_load_dwordx4 v[60:63], v1, s[4:7], s29 offen offset:2048 sc1
    s_mul_i32 s30, s30, 81920
    s_mul_i32 s29, s31, 40960
    s_add_u32 s30, s30, s29
    s_mul_i32 s29, s32, 64
    s_add_u32 s30, s30, s29
    s_mul_i32 s29, s20, 327680
    s_add_u32 s30, s30, s29
    s_mul_i32 s29, s17, 1280
    s_add_u32 s30, s30, s29
    s_mul_i32 s29, s21, 320
    s_add_u32 s30, s30, s29
    s_waitcnt vmcnt(8)
    v_pk_add_f32 v[16:17], v[16:17], v[24:25]
    v_pk_add_f32 v[18:19], v[18:19], v[26:27]
    v_pk_add_f32 v[20:21], v[20:21], v[28:29]
    v_pk_add_f32 v[22:23], v[22:23], v[30:31]
    s_waitcnt vmcnt(6)
    v_pk_add_f32 v[16:17], v[16:17], v[32:33]
    v_pk_add_f32 v[18:19], v[18:19], v[34:35]
    v_pk_add_f32 v[20:21], v[20:21], v[36:37]
    v_pk_add_f32 v[22:23], v[22:23], v[38:39]
    s_waitcnt vmcnt(4)
    v_pk_add_f32 v[16:17], v[16:17], v[40:41]
    v_pk_add_f32 v[18:19], v[18:19], v[42:43]
    v_pk_add_f32 v[20:21], v[20:21], v[44:45]
    v_pk_add_f32 v[22:23], v[22:23], v[46:47]
    s_waitcnt vmcnt(2)
    v_pk_add_f32 v[16:17], v[16:17], v[48:49]
    v_pk_add_f32 v[18:19], v[18:19], v[50:51]
    v_pk_add_f32 v[20:21], v[20:21], v[52:53]
    v_pk_add_f32 v[22:23], v[22:23], v[54:55]
    s_waitcnt vmcnt(0)
    v_pk_add_f32 v[16:17], v[16:17], v[56:57]
    v_pk_add_f32 v[18:19], v[18:19], v[58:59]
    v_pk_add_f32 v[20:21], v[20:21], v[60:61]
    v_pk_add_f32 v[22:23], v[22:23], v[62:63]
    v_cvt_pk_bf16_f32 v8, v16, v17
    v_cvt_pk_bf16_f32 v9, v18, v19
    v_cvt_pk_bf16_f32 v10, v20, v21
    v_cvt_pk_bf16_f32 v11, v22, v23
    s_nop 1
    v_permlane16_swap_b32 v8, v10
    v_permlane16_swap_b32 v9, v11
    buffer_store_dwordx4 v[8:11], v5, s[8:11], s30 offen
    s_add_u32 s34, s34, 4
    s_branch L_op_red
L_op_done:
L_end:
    s_endpgm
L_spin_1:
    s_add_u32 s3, s3, 1
    s_cmp_le_u32 s3, 20000000
    s_cbranch_scc1 L_ov_2
    s_movk_i32 s3, 1
    s_branch L_abort
L_spin_17:
    s_add_u32 s3, s3, 1
    s_cmp_le_u32 s3, 20000000
    s_cbranch_scc1 L_ch_wait
    s_movk_i32 s3, 2
    s_branch L_abort
L_spin_22:
    s_add_u32 s3, s3, 1
    s_cmp_le_u32 s3, 20000000
    s_cbranch_scc1 L_19
    s_movk_i32 s3, 3
    s_branch L_abort
L_spin_27:
    s_add_u32 s3, s3, 1
    s_cmp_le_u32 s3, 20000000
    s_cbranch_scc1 L_24
    s_movk_i32 s3, 4
    s_branch L_abort
L_spin_30:
    s_add_u32 s3, s3, 1
    s_cmp_le_u32 s3, 20000000
    s_cbranch_scc1 L_pa
    s_movk_i32 s3, 5
    s_branch L_abort
L_spin_33:
    s_add_u32 s3, s3, 1
    s_cmp_le_u32 s3, 20000000
    s_cbranch_scc1 L_pb1
    s_movk_i32 s3, 6
    s_branch L_abort
L_spin_36:
    s_add_u32 s3, s3, 1
    s_cmp_le_u32 s3, 20000000
    s_cbranch_scc1 L_pb0
    s_movk_i32 s3, 7
    s_branch L_abort
L_spin_44:
    s_add_u32 s3, s3, 1
    s_cmp_le_u32 s3, 20000000
    s_cbranch_scc1 L_41
    s_movk_i32 s3, 8
    s_branch L_abort
L_spin_45:
    s_add_u32 s3, s3, 1
    s_cmp_le_u32 s3, 20000000
    s_cbranch_scc1 L_pc
    s_movk_i32 s3, 9
    s_branch L_abort
L_spin_48:
    s_add_u32 s3, s3, 1
    s_cmp_le_u32 s3, 20000000
    s_cbranch_scc1 L_pr
    s_movk_i32 s3, 10
    s_branch L_abort
L_spin_30_S:
    s_add_u32 s3, s3, 1
    s_cmp_le_u32 s3, 20000000
    s_cbranch_scc1 L_pa_S
    s_movk_i32 s3, 11
    s_branch L_abort
L_spin_33_S:
    s_add_u32 s3, s3, 1
    s_cmp_le_u32 s3, 20000000
    s_cbranch_scc1 L_pb1_S
    s_movk_i32 s3, 12
    s_branch L_abort
L_spin_36_S:
    s_add_u32 s3, s3, 1
    s_cmp_le_u32 s3, 20000000
    s_cbranch_scc1 L_pb0_S
    s_movk_i32 s3, 13
    s_branch L_abort
L_spin_44_S:
    s_add_u32 s3, s3, 1
    s_cmp_le_u32 s3, 20000000
    s_cbranch_scc1 L_41_S
    s_movk_i32 s3, 14
    s_branch L_abort
L_spin_45_S:
    s_add_u32 s3, s3, 1
    s_cmp_le_u32 s3, 20000000
    s_cbranch_scc1 L_pc_S
    s_movk_i32 s3, 15
    s_branch L_abort
L_spin_48_S:
    s_add_u32 s3, s3, 1
    s_cmp_le_u32 s3, 20000000
    s_cbranch_scc1 L_pr_S
    s_movk_i32 s3, 16
    s_branch L_abort
L_spin_63:
    s_add_u32 s3, s3, 1
    s_cmp_le_u32 s3, 20000000
    s_cbranch_scc1 L_61
    s_movk_i32 s3, 17
    s_branch L_abort
L_spin_67:
    s_add_u32 s3, s3, 1
    s_cmp_le_u32 s3, 20000000
    s_cbranch_scc1 L_64
    s_movk_i32 s3, 18
    s_branch L_abort
L_spin_87:
    s_add_u32 s3, s3, 1
    s_cmp_le_u32 s3, 20000000
    s_cbranch_scc1 L_84
    s_movk_i32 s3, 19
    s_branch L_abort
L_spin_90:
    s_add_u32 s3, s3, 1
    s_cmp_le_u32 s3, 20000000
    s_cbranch_scc1 L_88
    s_movk_i32 s3, 20
    s_branch L_abort
L_spin_94:
    s_add_u32 s3, s3, 1
    s_cmp_le_u32 s3, 20000000
    s_cbranch_scc1 L_92
    s_movk_i32 s3, 21
    s_branch L_abort
L_spin_97:
    s_add_u32 s3, s3, 1
    s_cmp_le_u32 s3, 20000000
    s_cbranch_scc1 L_95
    s_movk_i32 s3, 22
    s_branch L_abort
L_spin_101:
    s_add_u32 s3, s3, 1
    s_cmp_le_u32 s3, 20000000
    s_cbranch_scc1 L_99
    s_movk_i32 s3, 23
    s_branch L_abort
L_spin_104:
    s_add_u32 s3, s3, 1
    s_cmp_le_u32 s3, 20000000
    s_cbranch_scc1 L_102
    s_movk_i32 s3, 24
    s_branch L_abort
L_spin_108:
    s_add_u32 s3, s3, 1
    s_cmp_le_u32 s3, 20000000
    s_cbranch_scc1 L_106
    s_movk_i32 s3, 25
    s_branch L_abort
L_abort:
    s_mov_b64 exec, 1
    v_mov_b32 v1, 1
    v_mov_b32 v2, 60
    buffer_atomic_add v1, v2, s[12:15], 0 offen
    s_lshl_b32 s29, s24, 8
    s_or_b32 s3, s3, s29
    s_lshl_b32 s3, s3, 8
    s_or_b32 s3, s3, s27
    s_lshl_b32 s3, s3, 4
    s_or_b32 s3, s3, s16
    s_not_b32 s3, s3
    v_mov_b32 v3, s3
    v_mov_b32 v2, 56
    buffer_atomic_umax v3, v2, s[12:15], 0 offen
    s_endpgm
.section .rodata,"a"
.p2align 6
.amdhsa_kernel concat_heads__memory_aug_recurrent_mem_tr__memory_aug_recurrent_mem_tr__prompt_kernel
  .amdhsa_next_free_vgpr 512
  .amdhsa_next_free_sgpr 102
  .amdhsa_accum_offset 256
  .amdhsa_group_segment_fixed_size 0
  .amdhsa_kernarg_size 136
  .amdhsa_user_sgpr_count 2
  .amdhsa_user_sgpr_kernarg_segment_ptr 1
  .amdhsa_system_sgpr_workgroup_id_x 1
.end_amdhsa_kernel
```
